```python
import torch

def _softmax(x, axis=-1):
    return torch.softmax(x, dim=axis)

def _gelu(x):
    return torch.nn.functional.gelu(x, approximate='tanh')

def _silu(x):
    return torch.nn.functional.silu(x)

def _sigmoid(x):
    return torch.sigmoid(x)

def _layernorm(x, axis=-1, eps=1e-05):
    m = x.mean(dim=axis, keepdim=True)
    v = x.var(dim=axis, keepdim=True, unbiased=False)
    return (x - m) / torch.sqrt(v + eps)

def _scatter_add(tgt, idx, src, axis=0):
    return tgt.clone().index_add_(axis, idx, src)

def _segment_sum(src, seg, n):
    out = torch.zeros((n,) + src.shape[1:], dtype=src.dtype)
    return out.index_add_(0, seg, src)

def _pad(x, pw):
    flat = tuple((v for pair in reversed(pw) for v in pair))
    return torch.nn.functional.pad(x, flat)
kernel_name = 'concat_heads__sliding_local_dilated__memory_aug_recurrent_mem_tr__prompt'

def setup_inputs():

    _w = lambda a: (lambda t: t.to(torch.bfloat16) if t.is_floating_point() else t)(torch.as_tensor(a))

    def _A_setup():
        B, S, D = (1, 2048, 512)
        return {'x': _w((lambda *s: torch.randn(*s, dtype=torch.bfloat16) * 0.2)(B, S, D)), 'wqkv': _w((lambda *s: torch.randn(*s, dtype=torch.bfloat16) * 0.2)(D, 3 * D)), 'wo': _w((lambda *s: torch.randn(*s, dtype=torch.bfloat16) * 0.05)(D, D))}
    _A_in = _A_setup()

    def _B_setup():
        B, S, Dm = (1, 2048, 512)
        H, Dh = (32, 128)
        M, seg = (8, 32)
        seg = min(seg, S)
        S = S // seg * seg
        return {'x': _w((lambda *s: torch.randn(*s, dtype=torch.bfloat16) * 0.05)(B, S, Dm)), 'mem0': _w((lambda *s: torch.randn(*s, dtype=torch.bfloat16) * 1.6)(B, M, Dm)), 'Wq': _w((lambda *s: torch.randn(*s, dtype=torch.bfloat16) * 0.8)(Dm, H, Dh) * Dm ** (-0.5)), 'Wk': _w((lambda *s: torch.randn(*s, dtype=torch.bfloat16) * 0.8)(Dm, H, Dh) * Dm ** (-0.5)), 'Wv': _w((lambda *s: torch.randn(*s, dtype=torch.bfloat16) * 1.6)(Dm, H, Dh) * Dm ** (-0.5)), 'Wo': _w((lambda *s: torch.randn(*s, dtype=torch.bfloat16) * 1.6)(H, Dh, Dm) * (H * Dh) ** (-0.5)), 'seg_len': seg}
    _B_in = _B_setup()
    return {'A_x': _A_in['x'], 'A_wqkv': _A_in['wqkv'], 'A_wo': _A_in['wo'], 'B_x': _B_in['x'], 'B_mem0': _B_in['mem0'], 'B_Wq': _B_in['Wq'], 'B_Wk': _B_in['Wk'], 'B_Wv': _B_in['Wv'], 'B_Wo': _B_in['Wo'], 'B_seg_len': _B_in['seg_len']}

def reference(A_x, A_wqkv, A_wo, B_x, B_mem0, B_Wq, B_Wk, B_Wv, B_Wo, B_seg_len):

    def _A_ref(x, wqkv, wo):
        B, S, D = x.shape
        H = 32
        Dh = D // H
        W, dil = (8, 2)
        qkv = (lambda x, *d: x.permute(*d))((x @ wqkv).reshape(B, S, 3, H, Dh), 2, 0, 3, 1, 4)
        q, k, v = (qkv[0], qkv[1], qkv[2])
        scale = Dh ** (-0.5)
        pos = torch.arange(S)
        off = torch.arange(W) * dil
        idx = pos[:, None] - off[None, :]
        mask = idx >= 0
        idx_c = torch.where(mask, idx, 0).reshape(-1)
        kg = k[:, :, idx_c, :].reshape(B, H, S, W, Dh)
        vg = v[:, :, idx_c, :].reshape(B, H, S, W, Dh)
        logits = torch.einsum('bhsd,bhswd->bhsw', q, kg) * scale
        logits = torch.where(mask[None, None, :, :], logits, -1000000000.0)
        attn = _softmax(logits, axis=-1)
        o = torch.einsum('bhsw,bhswd->bhsd', attn, vg)
        return (lambda x, *d: x.permute(*d))(o, 0, 2, 1, 3).reshape(B, S, D) @ wo

    def _B_ref(x, mem0, Wq, Wk, Wv, Wo, seg_len):
        B, S, Dm = x.shape
        H, Dh = (Wq.shape[1], Wq.shape[2])
        M = mem0.shape[1]
        scale = Dh ** (-0.5)
        n_seg = S // seg_len
        L = M + seg_len
        idx = torch.arange(L)
        mask = (idx[:, None] < M) | (idx[:, None] >= idx[None, :])
        mem = mem0
        outs = []
        for s in range(n_seg):
            xs = x[:, s * seg_len:(s + 1) * seg_len, :].clone()
            h = torch.concatenate([mem, xs], axis=1)
            q = torch.einsum('btd,dhe->bhte', h, Wq)
            k = torch.einsum('btd,dhe->bhte', h, Wk)
            v = torch.einsum('btd,dhe->bhte', h, Wv)
            scores = torch.einsum('bhqe,bhke->bhqk', q, k) * scale
            scores = torch.where(mask[None, None], scores, -1000000000.0)
            p = _softmax(scores, axis=-1)
            o = torch.einsum('bhqk,bhke->bhqe', p, v)
            o = torch.einsum('bhte,hed->btd', o, Wo)
            mem = o[:, :M, :].clone()
            outs.append(o[:, M:, :])
        return torch.concatenate(outs, axis=1)
    a = _A_ref(A_x, A_wqkv, A_wo)
    b = _B_ref(B_x, B_mem0, B_Wq, B_Wk, B_Wv, B_Wo, B_seg_len)
    return torch.concatenate([a, b], axis=-1)
```

```asm
; @launch grid=(256,1,1) block=(256,1,1) lds=163840
.amdgcn_target "amdgcn-amd-amdhsa--gfx950"
.text
.globl concat_heads__sliding_local_dilated__memory_aug_recurrent_mem_tr__prompt_kernel
.p2align 8
.type concat_heads__sliding_local_dilated__memory_aug_recurrent_mem_tr__prompt_kernel,@function
concat_heads__sliding_local_dilated__memory_aug_recurrent_mem_tr__prompt_kernel:
  s_cmp_ge_u32 s2, 256
  s_cbranch_scc1 L_end
  s_load_dwordx16 s[16:31], s[0:1], 0
  s_load_dwordx8 s[32:39], s[0:1], 64
  s_load_dwordx2 s[40:41], s[0:1], 96
  s_and_b32 s42, s2, 7
  s_lshr_b32 s43, s2, 3
  v_lshrrev_b32 v1, 6, v0
  v_and_b32 v0, 63, v0
  v_readfirstlane_b32 s3, v1
  s_lshl_b32 s42, s42, 2
  s_lshr_b32 s42, 0x26310754, s42
  s_and_b32 s42, s42, 7
  s_cmp_gt_u32 s42, 1
  s_cbranch_scc1 L_work
  s_cmp_eq_u32 s42, 1
  s_cbranch_scc1 L_apart
  v_and_b32 v110, 7, v0
  v_lshlrev_b32 v110, 4, v110
  v_bfe_u32 v111, v0, 5, 1
  v_bfe_u32 v112, v0, 4, 1
  v_bfe_u32 v113, v0, 2, 1
  v_bfe_u32 v114, v0, 3, 1
  v_lshl_add_u32 v96, v111, 15, v110
  v_lshl_add_u32 v96, v114, 13, v96
  v_lshl_add_u32 v96, v112, 16, v96
  s_lshl_b32 s50, s43, 8
  s_lshr_b32 s52, s3, 1
  s_lshl_b32 s52, s52, 7
  s_add_u32 s50, s50, s52
  s_lshl_b32 s100, s3, 1
  s_mul_i32 s67, s3, 20480
  s_waitcnt lgkmcnt(0)
  s_mov_b32 s68, s26
  s_and_b32 s69, s27, 0xffff
  s_mov_b32 s70, 0x400000
  s_mov_b32 s71, 0x20000
  s_add_u32 m0, s67, 0
  s_xor_b32 s52, s100, 0
  s_lshl_b32 s52, s52, 19
  s_add_u32 s52, s52, s50
  buffer_load_dwordx4 v96, s[68:71], s52 offen lds
  s_add_u32 s52, s52, 0x20000
  s_add_u32 m0, m0, 1024
  s_nop 0
  buffer_load_dwordx4 v96, s[68:71], s52 offen lds
  s_add_u32 s52, s52, 0xfffe4000
  s_add_u32 m0, m0, 1024
  s_nop 0
  buffer_load_dwordx4 v96, s[68:71], s52 offen lds
  s_add_u32 s52, s52, 0x20000
  s_add_u32 m0, m0, 1024
  s_nop 0
  buffer_load_dwordx4 v96, s[68:71], s52 offen lds
  s_add_u32 m0, s67, 4096
  s_xor_b32 s52, s100, 0
  s_lshl_b32 s52, s52, 19
  s_add_u32 s52, s52, s50
  s_add_u32 s52, s52, 262144
  buffer_load_dwordx4 v96, s[68:71], s52 offen lds
  s_add_u32 s52, s52, 0x20000
  s_add_u32 m0, m0, 1024
  s_nop 0
  buffer_load_dwordx4 v96, s[68:71], s52 offen lds
  s_add_u32 s52, s52, 0xfffe4000
  s_add_u32 m0, m0, 1024
  s_nop 0
  buffer_load_dwordx4 v96, s[68:71], s52 offen lds
  s_add_u32 s52, s52, 0x20000
  s_add_u32 m0, m0, 1024
  s_nop 0
  buffer_load_dwordx4 v96, s[68:71], s52 offen lds
  s_add_u32 m0, s67, 8192
  s_xor_b32 s52, s100, 1
  s_lshl_b32 s52, s52, 19
  s_add_u32 s52, s52, s50
  buffer_load_dwordx4 v96, s[68:71], s52 offen lds
  s_add_u32 s52, s52, 0x20000
  s_add_u32 m0, m0, 1024
  s_nop 0
  buffer_load_dwordx4 v96, s[68:71], s52 offen lds
  s_add_u32 s52, s52, 0xfffe4000
  s_add_u32 m0, m0, 1024
  s_nop 0
  buffer_load_dwordx4 v96, s[68:71], s52 offen lds
  s_add_u32 s52, s52, 0x20000
  s_add_u32 m0, m0, 1024
  s_nop 0
  buffer_load_dwordx4 v96, s[68:71], s52 offen lds
  s_add_u32 m0, s67, 12288
  s_xor_b32 s52, s100, 1
  s_lshl_b32 s52, s52, 19
  s_add_u32 s52, s52, s50
  s_add_u32 s52, s52, 262144
  buffer_load_dwordx4 v96, s[68:71], s52 offen lds
  s_add_u32 s52, s52, 0x20000
  s_add_u32 m0, m0, 1024
  s_nop 0
  buffer_load_dwordx4 v96, s[68:71], s52 offen lds
  s_add_u32 s52, s52, 0xfffe4000
  s_add_u32 m0, m0, 1024
  s_nop 0
  buffer_load_dwordx4 v96, s[68:71], s52 offen lds
  s_add_u32 s52, s52, 0x20000
  s_add_u32 m0, m0, 1024
  s_nop 0
  buffer_load_dwordx4 v96, s[68:71], s52 offen lds
  s_waitcnt lgkmcnt(0)
  s_mov_b32 s4, s40
  s_and_b32 s5, s41, 0xffff
  s_mov_b32 s6, 0x10000000
  s_mov_b32 s7, 0x20000
  s_mov_b32 s8, s38
  s_and_b32 s9, s39, 0xffff
  s_mov_b32 s10, 0x100
  s_mov_b32 s11, 0x20000
  s_mov_b32 s72, s28
  s_and_b32 s73, s29, 0xffff
  s_mov_b32 s74, 0x400000
  s_mov_b32 s75, 0x20000
  s_mov_b32 s76, s30
  s_and_b32 s77, s31, 0xffff
  s_mov_b32 s78, 0x400000
  s_mov_b32 s79, 0x20000
  s_mov_b32 s12, s32
  s_and_b32 s13, s33, 0xffff
  s_mov_b32 s14, 0x400000
  s_mov_b32 s15, 0x20000
  v_lshlrev_b32 v94, 13, v0
  s_lshl_b32 s51, s43, 17
  s_lshl_b32 s52, s3, 8
  s_add_u32 s51, s51, s52
  v_lshlrev_b32 v1, 4, v0
  v_and_b32 v7, 1, v0
  v_xor_b32 v7, 1, v7
  s_lshl_b32 s52, s3, 11
  v_add_u32 v3, s52, v1
  v_add_u32 v4, 0x10000, v3
  v_add_u32 v5, 0x20000, v3
  v_lshl_add_u32 v97, v112, 14, v110
  v_lshl_add_u32 v97, v111, 12, v97
  v_lshl_add_u32 v97, v114, 10, v97
  v_and_b32 v115, 3, v0
  v_lshlrev_b32 v115, 3, v115
  v_lshrrev_b32 v116, 4, v0
  v_lshl_add_u32 v98, v116, 8, v115
  v_lshl_add_u32 v98, v113, 7, v98
  v_lshl_add_u32 v98, v114, 6, v98
  v_add_u32 v98, s67, v98
  v_lshrrev_b32 v116, 2, v0
  v_lshl_add_u32 v115, v116, 7, v115
  v_lshl_add_u32 v115, v114, 5, v115
  s_and_b32 s52, s3, 1
  s_lshl_b32 s52, s52, 6
  v_add_u32 v115, s52, v115
  v_xor_b32 v116, 256, v115
  s_xor_b32 s52, s3, 1
  s_mul_i32 s52, s52, 20480
  v_add_u32 v100, s67, v115
  v_add_u32 v101, s67, v116
  v_add_u32 v102, s52, v115
  v_add_u32 v103, s52, v116
  v_and_b32 v110, 15, v0
  v_lshrrev_b32 v111, 4, v0
  s_lshl_b32 s52, s3, 10
  v_bfe_u32 v113, v0, 4, 1
  v_bfe_u32 v114, v0, 5, 1
  v_bfe_u32 v112, v0, 2, 1
  v_xor_b32 v112, v112, v113
  v_lshlrev_b32 v112, 4, v112
  v_lshl_add_u32 v6, v110, 5, v112
  v_lshl_add_u32 v6, v114, 9, v6
  v_add_u32 v6, s52, v6
  v_and_b32 v112, 1, v0
  v_xor_b32 v112, v112, v113
  v_lshlrev_b32 v112, 4, v112
  v_bfe_u32 v115, v0, 1, 1
  v_lshl_add_u32 v112, v115, 3, v112
  v_lshrrev_b32 v115, 2, v0
  v_lshl_add_u32 v2, v115, 5, v112
  v_and_b32 v115, 7, v0
  v_bfe_u32 v116, v0, 3, 1
  v_lshlrev_b32 v8, 7, v111
  v_lshl_add_u32 v8, v115, 4, v8
  v_lshl_add_u32 v8, v116, 3, v8
  s_lshl_b32 s52, s3, 9
  v_add_u32 v8, s52, v8
  v_lshlrev_b32 v9, 3, v115
  v_lshl_add_u32 v9, v113, 11, v9
  v_lshl_add_u32 v9, v116, 12, v9
  v_lshl_add_u32 v9, v114, 14, v9
  s_lshl_b32 s52, s3, 16
  s_lshl_b32 s53, s43, 6
  s_add_u32 s52, s52, s53
  v_add_u32 v9, s52, v9
  v_and_b32 v116, 3, v0
  v_lshlrev_b32 v10, 2, v116
  v_lshl_add_u32 v10, v111, 4, v10
  v_mov_b32 v11, 0x4444
  v_mov_b32 v117, 0xeeee
  v_cmp_lt_u32 vcc, 7, v110
  s_nop 1
  v_cndmask_b32 v11, v11, v117, vcc
  v_bfe_u32 v117, v0, 2, 1
  v_lshlrev_b32 v117, 4, v117
  v_mov_b32 v118, 0x3f80
  v_lshlrev_b32 v117, v117, v118
  v_cmp_eq_u32 vcc, 0, v116
  s_nop 1
  v_cndmask_b32 v12, 0, v117, vcc
  v_cndmask_b32 v14, 0, v117, vcc
  v_cmp_eq_u32 vcc, 1, v116
  s_nop 1
  v_cndmask_b32 v13, 0, v117, vcc
  v_cndmask_b32 v15, 0, v117, vcc
  s_lshr_b32 s52, s43, 3
  s_lshl_b32 s52, s52, 5
  s_and_b32 s53, s43, 4
  s_lshl_b32 s53, s53, 1
  s_add_u32 s52, s52, s53
  s_and_b32 s53, s43, 3
  s_add_u32 s52, s52, s53
  s_and_b32 s53, s3, 2
  s_lshl_b32 s53, s53, 3
  s_add_u32 s52, s52, s53
  s_and_b32 s53, s3, 1
  s_lshl_b32 s53, s53, 2
  s_add_u32 s52, s52, s53
  s_lshl_b32 s58, s52, 11
  s_add_u32 s58, s58, 0x5000000
  s_lshl_b32 s59, s52, 6
  s_add_u32 s59, s59, 0x5080000
  s_mov_b32 s55, 0x5080000
  s_mov_b32 s56, 0x5000000
  s_mov_b32 s57, 0x5008000
  s_mov_b32 s48, 0x5002000
  s_mov_b32 s49, 0x500a000
  s_mov_b32 s44, s24
  s_and_b32 s45, s25, 0xffff
  s_mov_b32 s46, 0x2000
  s_mov_b32 s47, 0x20000
  v_mov_b32 v84, -1
  v_mov_b32 v85, -1
  v_mov_b32 v86, -1
  v_mov_b32 v87, -1
  s_lshr_b32 s53, s52, 1
  s_lshl_b32 s53, s53, 4
  s_and_b32 s54, s52, 1
  s_lshl_b32 s54, s54, 12
  s_add_u32 s53, s53, s54
  v_lshlrev_b32 v117, 2, v116
  v_lshl_add_u32 v117, v111, 10, v117
  buffer_load_dword v80, v117, s[44:47], s53 offen
  buffer_store_dwordx2 v[84:85], v9, s[4:7], s56 offen sc1
  buffer_store_dwordx2 v[84:85], v9, s[4:7], s48 offen sc1
  buffer_store_dwordx2 v[84:85], v9, s[4:7], s57 offen sc1
  buffer_store_dwordx2 v[84:85], v9, s[4:7], s49 offen sc1
  s_mov_b32 s64, 0x3e0293ee
  s_mov_b32 s65, 0xbe0293ee
  s_lshl_b32 s52, s43, 21
  s_add_u32 s63, s52, 0xf000
  s_add_u32 s60, s52, 0x2000
  s_add_u32 s61, s52, 0x4000
  s_add_u32 s62, s52, 0x7000
  s_lshl_b32 s52, s3, 10
  s_add_u32 s62, s62, s52
  s_mov_b32 s82, 0
  s_waitcnt vmcnt(17)
  s_barrier
  s_add_u32 m0, s67, 16384
  s_xor_b32 s52, s100, 4
  s_lshl_b32 s52, s52, 19
  s_add_u32 s52, s52, s50
  buffer_load_dwordx4 v96, s[68:71], s52 offen lds
  s_add_u32 s52, s52, 0x20000
  s_add_u32 m0, m0, 1024
  s_nop 0
  buffer_load_dwordx4 v96, s[68:71], s52 offen lds
  s_add_u32 s52, s52, 0xfffe4000
  s_add_u32 m0, m0, 1024
  s_nop 0
  buffer_load_dwordx4 v96, s[68:71], s52 offen lds
  s_add_u32 s52, s52, 0x20000
  s_add_u32 m0, m0, 1024
  s_nop 0
  buffer_load_dwordx4 v96, s[68:71], s52 offen lds
  ds_read_b64_tr_b16 v[112:113], v100 offset:0
  ds_read_b64_tr_b16 v[114:115], v100 offset:2048
  ds_read_b64_tr_b16 v[116:117], v101 offset:0
  ds_read_b64_tr_b16 v[118:119], v101 offset:2048
  ds_read_b64_tr_b16 a[16:17], v102 offset:0
  ds_read_b64_tr_b16 a[18:19], v102 offset:2048
  ds_read_b64_tr_b16 a[48:49], v103 offset:0
  ds_read_b64_tr_b16 a[50:51], v103 offset:2048
  s_waitcnt lgkmcnt(0)
  ds_write_b128 v4, v[112:115] offset:16384
  ds_write_b128 v5, v[116:119] offset:0
  s_waitcnt lgkmcnt(0)
  s_waitcnt vmcnt(17)
  s_barrier
  s_add_u32 m0, s67, 0
  s_xor_b32 s52, s100, 4
  s_lshl_b32 s52, s52, 19
  s_add_u32 s52, s52, s50
  s_add_u32 s52, s52, 262144
  buffer_load_dwordx4 v96, s[68:71], s52 offen lds
  s_add_u32 s52, s52, 0x20000
  s_add_u32 m0, m0, 1024
  s_nop 0
  buffer_load_dwordx4 v96, s[68:71], s52 offen lds
  s_add_u32 s52, s52, 0xfffe4000
  s_add_u32 m0, m0, 1024
  s_nop 0
  buffer_load_dwordx4 v96, s[68:71], s52 offen lds
  s_add_u32 s52, s52, 0x20000
  s_add_u32 m0, m0, 1024
  s_nop 0
  buffer_load_dwordx4 v96, s[68:71], s52 offen lds
  ds_read_b64_tr_b16 v[112:113], v100 offset:4096
  ds_read_b64_tr_b16 v[114:115], v100 offset:6144
  ds_read_b64_tr_b16 v[116:117], v101 offset:4096
  ds_read_b64_tr_b16 v[118:119], v101 offset:6144
  ds_read_b64_tr_b16 a[20:21], v102 offset:4096
  ds_read_b64_tr_b16 a[22:23], v102 offset:6144
  ds_read_b64_tr_b16 a[52:53], v103 offset:4096
  ds_read_b64_tr_b16 a[54:55], v103 offset:6144
  s_waitcnt lgkmcnt(0)
  ds_write_b128 v4, v[112:115] offset:17408
  ds_write_b128 v5, v[116:119] offset:1024
  s_waitcnt lgkmcnt(0)
  s_waitcnt vmcnt(17)
  s_barrier
  s_add_u32 m0, s67, 4096
  s_xor_b32 s52, s100, 5
  s_lshl_b32 s52, s52, 19
  s_add_u32 s52, s52, s50
  buffer_load_dwordx4 v96, s[68:71], s52 offen lds
  s_add_u32 s52, s52, 0x20000
  s_add_u32 m0, m0, 1024
  s_nop 0
  buffer_load_dwordx4 v96, s[68:71], s52 offen lds
  s_add_u32 s52, s52, 0xfffe4000
  s_add_u32 m0, m0, 1024
  s_nop 0
  buffer_load_dwordx4 v96, s[68:71], s52 offen lds
  s_add_u32 s52, s52, 0x20000
  s_add_u32 m0, m0, 1024
  s_nop 0
  buffer_load_dwordx4 v96, s[68:71], s52 offen lds
  s_waitcnt vmcnt(16)
  v_min_u32 v80, -2, v80
  s_mov_b32 exec_lo, 0x000f000f
  s_mov_b32 exec_hi, 0x000f000f
  buffer_store_dword v80, v10, s[4:7], s59 offen sc1
  s_add_u32 s54, s59, 0x2000
  buffer_store_dword v84, v10, s[4:7], s54 offen sc1
  s_mov_b64 exec, -1
  ds_read_b64_tr_b16 v[112:113], v100 offset:8192
  ds_read_b64_tr_b16 v[114:115], v100 offset:10240
  ds_read_b64_tr_b16 v[116:117], v101 offset:8192
  ds_read_b64_tr_b16 v[118:119], v101 offset:10240
  ds_read_b64_tr_b16 a[32:33], v102 offset:8192
  ds_read_b64_tr_b16 a[34:35], v102 offset:10240
  ds_read_b64_tr_b16 a[64:65], v103 offset:8192
  ds_read_b64_tr_b16 a[66:67], v103 offset:10240
  s_waitcnt lgkmcnt(0)
  ds_write_b128 v4, v[112:115] offset:40960
  ds_write_b128 v5, v[116:119] offset:24576
  s_waitcnt lgkmcnt(0)
  s_waitcnt vmcnt(19)
  s_barrier
  s_add_u32 m0, s67, 8192
  s_xor_b32 s52, s100, 5
  s_lshl_b32 s52, s52, 19
  s_add_u32 s52, s52, s50
  s_add_u32 s52, s52, 262144
  buffer_load_dwordx4 v96, s[68:71], s52 offen lds
  s_add_u32 s52, s52, 0x20000
  s_add_u32 m0, m0, 1024
  s_nop 0
  buffer_load_dwordx4 v96, s[68:71], s52 offen lds
  s_add_u32 s52, s52, 0xfffe4000
  s_add_u32 m0, m0, 1024
  s_nop 0
  buffer_load_dwordx4 v96, s[68:71], s52 offen lds
  s_add_u32 s52, s52, 0x20000
  s_add_u32 m0, m0, 1024
  s_nop 0
  buffer_load_dwordx4 v96, s[68:71], s52 offen lds
  ds_read_b64_tr_b16 v[112:113], v100 offset:12288
  ds_read_b64_tr_b16 v[114:115], v100 offset:14336
  ds_read_b64_tr_b16 v[116:117], v101 offset:12288
  ds_read_b64_tr_b16 v[118:119], v101 offset:14336
  ds_read_b64_tr_b16 a[36:37], v102 offset:12288
  ds_read_b64_tr_b16 a[38:39], v102 offset:14336
  ds_read_b64_tr_b16 a[68:69], v103 offset:12288
  ds_read_b64_tr_b16 a[70:71], v103 offset:14336
  s_waitcnt lgkmcnt(0)
  ds_write_b128 v4, v[112:115] offset:41984
  ds_write_b128 v5, v[116:119] offset:25600
  s_waitcnt lgkmcnt(0)
  s_waitcnt vmcnt(14)
  s_barrier
  s_add_u32 m0, s67, 12288
  s_xor_b32 s52, s100, 0
  s_lshl_b32 s52, s52, 19
  s_add_u32 s52, s52, s50
  buffer_load_dwordx4 v96, s[72:75], s52 offen lds
  s_add_u32 s52, s52, 0x20000
  s_add_u32 m0, m0, 1024
  s_nop 0
  buffer_load_dwordx4 v96, s[72:75], s52 offen lds
  s_add_u32 s52, s52, 0xfffe4000
  s_add_u32 m0, m0, 1024
  s_nop 0
  buffer_load_dwordx4 v96, s[72:75], s52 offen lds
  s_add_u32 s52, s52, 0x20000
  s_add_u32 m0, m0, 1024
  s_nop 0
  buffer_load_dwordx4 v96, s[72:75], s52 offen lds
  ds_read_b64_tr_b16 a[80:81], v100 offset:16384
  ds_read_b64_tr_b16 a[82:83], v100 offset:18432
  ds_read_b64_tr_b16 a[112:113], v101 offset:16384
  ds_read_b64_tr_b16 a[114:115], v101 offset:18432
  ds_read_b64_tr_b16 a[144:145], v102 offset:16384
  ds_read_b64_tr_b16 a[146:147], v102 offset:18432
  ds_read_b64_tr_b16 a[176:177], v103 offset:16384
  ds_read_b64_tr_b16 a[178:179], v103 offset:18432
  s_waitcnt lgkmcnt(0)
  s_waitcnt vmcnt(14)
  s_barrier
  s_add_u32 m0, s67, 16384
  s_xor_b32 s52, s100, 0
  s_lshl_b32 s52, s52, 19
  s_add_u32 s52, s52, s50
  s_add_u32 s52, s52, 262144
  buffer_load_dwordx4 v96, s[72:75], s52 offen lds
  s_add_u32 s52, s52, 0x20000
  s_add_u32 m0, m0, 1024
  s_nop 0
  buffer_load_dwordx4 v96, s[72:75], s52 offen lds
  s_add_u32 s52, s52, 0xfffe4000
  s_add_u32 m0, m0, 1024
  s_nop 0
  buffer_load_dwordx4 v96, s[72:75], s52 offen lds
  s_add_u32 s52, s52, 0x20000
  s_add_u32 m0, m0, 1024
  s_nop 0
  buffer_load_dwordx4 v96, s[72:75], s52 offen lds
  ds_read_b64_tr_b16 a[84:85], v100 offset:0
  ds_read_b64_tr_b16 a[86:87], v100 offset:2048
  ds_read_b64_tr_b16 a[116:117], v101 offset:0
  ds_read_b64_tr_b16 a[118:119], v101 offset:2048
  ds_read_b64_tr_b16 a[148:149], v102 offset:0
  ds_read_b64_tr_b16 a[150:151], v102 offset:2048
  ds_read_b64_tr_b16 a[180:181], v103 offset:0
  ds_read_b64_tr_b16 a[182:183], v103 offset:2048
  s_waitcnt lgkmcnt(0)
  s_waitcnt vmcnt(14)
  s_barrier
  s_add_u32 m0, s67, 0
  s_xor_b32 s52, s100, 1
  s_lshl_b32 s52, s52, 19
  s_add_u32 s52, s52, s50
  buffer_load_dwordx4 v96, s[72:75], s52 offen lds
  s_add_u32 s52, s52, 0x20000
  s_add_u32 m0, m0, 1024
  s_nop 0
  buffer_load_dwordx4 v96, s[72:75], s52 offen lds
  s_add_u32 s52, s52, 0xfffe4000
  s_add_u32 m0, m0, 1024
  s_nop 0
  buffer_load_dwordx4 v96, s[72:75], s52 offen lds
  s_add_u32 s52, s52, 0x20000
  s_add_u32 m0, m0, 1024
  s_nop 0
  buffer_load_dwordx4 v96, s[72:75], s52 offen lds
  ds_read_b64_tr_b16 a[96:97], v100 offset:4096
  ds_read_b64_tr_b16 a[98:99], v100 offset:6144
  ds_read_b64_tr_b16 a[128:129], v101 offset:4096
  ds_read_b64_tr_b16 a[130:131], v101 offset:6144
  ds_read_b64_tr_b16 a[160:161], v102 offset:4096
  ds_read_b64_tr_b16 a[162:163], v102 offset:6144
  ds_read_b64_tr_b16 a[192:193], v103 offset:4096
  ds_read_b64_tr_b16 a[194:195], v103 offset:6144
  s_waitcnt lgkmcnt(0)
  s_waitcnt vmcnt(12)
  s_barrier
  s_add_u32 m0, s67, 4096
  s_xor_b32 s52, s100, 1
  s_lshl_b32 s52, s52, 19
  s_add_u32 s52, s52, s50
  s_add_u32 s52, s52, 262144
  buffer_load_dwordx4 v96, s[72:75], s52 offen lds
  s_add_u32 s52, s52, 0x20000
  s_add_u32 m0, m0, 1024
  s_nop 0
  buffer_load_dwordx4 v96, s[72:75], s52 offen lds
  s_add_u32 s52, s52, 0xfffe4000
  s_add_u32 m0, m0, 1024
  s_nop 0
  buffer_load_dwordx4 v96, s[72:75], s52 offen lds
  s_add_u32 s52, s52, 0x20000
  s_add_u32 m0, m0, 1024
  s_nop 0
  buffer_load_dwordx4 v96, s[72:75], s52 offen lds
  ds_read_b64_tr_b16 a[100:101], v100 offset:8192
  ds_read_b64_tr_b16 a[102:103], v100 offset:10240
  ds_read_b64_tr_b16 a[132:133], v101 offset:8192
  ds_read_b64_tr_b16 a[134:135], v101 offset:10240
  ds_read_b64_tr_b16 a[164:165], v102 offset:8192
  ds_read_b64_tr_b16 a[166:167], v102 offset:10240
  ds_read_b64_tr_b16 a[196:197], v103 offset:8192
  ds_read_b64_tr_b16 a[198:199], v103 offset:10240
  s_waitcnt lgkmcnt(0)
  s_waitcnt vmcnt(12)
  s_barrier
  s_add_u32 m0, s67, 8192
  s_xor_b32 s52, s100, 4
  s_lshl_b32 s52, s52, 19
  s_add_u32 s52, s52, s50
  buffer_load_dwordx4 v96, s[72:75], s52 offen lds
  s_add_u32 s52, s52, 0x20000
  s_add_u32 m0, m0, 1024
  s_nop 0
  buffer_load_dwordx4 v96, s[72:75], s52 offen lds
  s_add_u32 s52, s52, 0xfffe4000
  s_add_u32 m0, m0, 1024
  s_nop 0
  buffer_load_dwordx4 v96, s[72:75], s52 offen lds
  s_add_u32 s52, s52, 0x20000
  s_add_u32 m0, m0, 1024
  s_nop 0
  buffer_load_dwordx4 v96, s[72:75], s52 offen lds
  s_waitcnt vmcnt(24)
  s_barrier
  s_getreg_b32 s52, hwreg(HW_REG_XCC_ID)
  s_and_b32 s52, s52, 0xf
  s_add_u32 s52, s52, 1
  s_lshl_b32 s53, s43, 2
  v_mov_b32 v80, s52
  v_mov_b32 v81, 0
  s_cmp_lg_u32 s3, 0
  s_cbranch_scc1 L_c_noid
  s_mov_b64 exec, 1
  buffer_store_dword v80, v81, s[8:11], s53 offen offset:128 sc1
  s_mov_b64 exec, -1
L_c_noid:
  ds_read_b64_tr_b16 v[112:113], v100 offset:12288
  ds_read_b64_tr_b16 v[114:115], v100 offset:14336
  ds_read_b64_tr_b16 v[116:117], v101 offset:12288
  ds_read_b64_tr_b16 v[118:119], v101 offset:14336
  ds_read_b64_tr_b16 a[24:25], v102 offset:12288
  ds_read_b64_tr_b16 a[26:27], v102 offset:14336
  ds_read_b64_tr_b16 a[56:57], v103 offset:12288
  ds_read_b64_tr_b16 a[58:59], v103 offset:14336
  s_waitcnt lgkmcnt(0)
  ds_write_b128 v4, v[112:115] offset:24576
  ds_write_b128 v5, v[116:119] offset:8192
  s_waitcnt lgkmcnt(0)
  s_waitcnt vmcnt(12)
  s_barrier
  s_add_u32 m0, s67, 12288
  s_xor_b32 s52, s100, 4
  s_lshl_b32 s52, s52, 19
  s_add_u32 s52, s52, s50
  s_add_u32 s52, s52, 262144
  buffer_load_dwordx4 v96, s[72:75], s52 offen lds
  s_add_u32 s52, s52, 0x20000
  s_add_u32 m0, m0, 1024
  s_nop 0
  buffer_load_dwordx4 v96, s[72:75], s52 offen lds
  s_add_u32 s52, s52, 0xfffe4000
  s_add_u32 m0, m0, 1024
  s_nop 0
  buffer_load_dwordx4 v96, s[72:75], s52 offen lds
  s_add_u32 s52, s52, 0x20000
  s_add_u32 m0, m0, 1024
  s_nop 0
  buffer_load_dwordx4 v96, s[72:75], s52 offen lds
  ds_read_b64_tr_b16 v[112:113], v100 offset:16384
  ds_read_b64_tr_b16 v[114:115], v100 offset:18432
  ds_read_b64_tr_b16 v[116:117], v101 offset:16384
  ds_read_b64_tr_b16 v[118:119], v101 offset:18432
  ds_read_b64_tr_b16 a[28:29], v102 offset:16384
  ds_read_b64_tr_b16 a[30:31], v102 offset:18432
  ds_read_b64_tr_b16 a[60:61], v103 offset:16384
  ds_read_b64_tr_b16 a[62:63], v103 offset:18432
  s_waitcnt lgkmcnt(0)
  ds_write_b128 v4, v[112:115] offset:25600
  ds_write_b128 v5, v[116:119] offset:9216
  s_waitcnt lgkmcnt(0)
  s_waitcnt vmcnt(12)
  s_barrier
  s_add_u32 m0, s67, 16384
  s_xor_b32 s52, s100, 5
  s_lshl_b32 s52, s52, 19
  s_add_u32 s52, s52, s50
  buffer_load_dwordx4 v96, s[72:75], s52 offen lds
  s_add_u32 s52, s52, 0x20000
  s_add_u32 m0, m0, 1024
  s_nop 0
  buffer_load_dwordx4 v96, s[72:75], s52 offen lds
  s_add_u32 s52, s52, 0xfffe4000
  s_add_u32 m0, m0, 1024
  s_nop 0
  buffer_load_dwordx4 v96, s[72:75], s52 offen lds
  s_add_u32 s52, s52, 0x20000
  s_add_u32 m0, m0, 1024
  s_nop 0
  buffer_load_dwordx4 v96, s[72:75], s52 offen lds
  ds_read_b64_tr_b16 v[112:113], v100 offset:0
  ds_read_b64_tr_b16 v[114:115], v100 offset:2048
  ds_read_b64_tr_b16 a[0:1], v101 offset:0
  ds_read_b64_tr_b16 a[2:3], v101 offset:2048
  ds_read_b64_tr_b16 a[40:41], v102 offset:0
  ds_read_b64_tr_b16 a[42:43], v102 offset:2048
  ds_read_b64_tr_b16 a[72:73], v103 offset:0
  ds_read_b64_tr_b16 a[74:75], v103 offset:2048
  s_waitcnt lgkmcnt(0)
  ds_write_b128 v4, v[112:115] offset:49152
  s_waitcnt lgkmcnt(0)
  s_waitcnt vmcnt(12)
  s_barrier
  s_add_u32 m0, s67, 0
  s_xor_b32 s52, s100, 5
  s_lshl_b32 s52, s52, 19
  s_add_u32 s52, s52, s50
  s_add_u32 s52, s52, 262144
  buffer_load_dwordx4 v96, s[72:75], s52 offen lds
  s_add_u32 s52, s52, 0x20000
  s_add_u32 m0, m0, 1024
  s_nop 0
  buffer_load_dwordx4 v96, s[72:75], s52 offen lds
  s_add_u32 s52, s52, 0xfffe4000
  s_add_u32 m0, m0, 1024
  s_nop 0
  buffer_load_dwordx4 v96, s[72:75], s52 offen lds
  s_add_u32 s52, s52, 0x20000
  s_add_u32 m0, m0, 1024
  s_nop 0
  buffer_load_dwordx4 v96, s[72:75], s52 offen lds
  ds_read_b64_tr_b16 v[112:113], v100 offset:4096
  ds_read_b64_tr_b16 v[114:115], v100 offset:6144
  ds_read_b64_tr_b16 a[4:5], v101 offset:4096
  ds_read_b64_tr_b16 a[6:7], v101 offset:6144
  ds_read_b64_tr_b16 a[44:45], v102 offset:4096
  ds_read_b64_tr_b16 a[46:47], v102 offset:6144
  ds_read_b64_tr_b16 a[76:77], v103 offset:4096
  ds_read_b64_tr_b16 a[78:79], v103 offset:6144
  s_waitcnt lgkmcnt(0)
  ds_write_b128 v4, v[112:115] offset:50176
  s_waitcnt lgkmcnt(0)
  s_waitcnt vmcnt(12)
  s_barrier
  s_add_u32 m0, s67, 4096
  s_xor_b32 s52, s100, 0
  s_lshl_b32 s52, s52, 19
  s_add_u32 s52, s52, s50
  buffer_load_dwordx4 v96, s[76:79], s52 offen lds
  s_add_u32 s52, s52, 0x20000
  s_add_u32 m0, m0, 1024
  s_nop 0
  buffer_load_dwordx4 v96, s[76:79], s52 offen lds
  s_add_u32 s52, s52, 0xfffe4000
  s_add_u32 m0, m0, 1024
  s_nop 0
  buffer_load_dwordx4 v96, s[76:79], s52 offen lds
  s_add_u32 s52, s52, 0x20000
  s_add_u32 m0, m0, 1024
  s_nop 0
  buffer_load_dwordx4 v96, s[76:79], s52 offen lds
  ds_read_b64_tr_b16 a[88:89], v100 offset:8192
  ds_read_b64_tr_b16 a[90:91], v100 offset:10240
  ds_read_b64_tr_b16 a[120:121], v101 offset:8192
  ds_read_b64_tr_b16 a[122:123], v101 offset:10240
  ds_read_b64_tr_b16 a[152:153], v102 offset:8192
  ds_read_b64_tr_b16 a[154:155], v102 offset:10240
  ds_read_b64_tr_b16 a[184:185], v103 offset:8192
  ds_read_b64_tr_b16 a[186:187], v103 offset:10240
  s_waitcnt lgkmcnt(0)
  s_waitcnt vmcnt(12)
  s_barrier
  s_add_u32 m0, s67, 8192
  s_xor_b32 s52, s100, 0
  s_lshl_b32 s52, s52, 19
  s_add_u32 s52, s52, s50
  s_add_u32 s52, s52, 262144
  buffer_load_dwordx4 v96, s[76:79], s52 offen lds
  s_add_u32 s52, s52, 0x20000
  s_add_u32 m0, m0, 1024
  s_nop 0
  buffer_load_dwordx4 v96, s[76:79], s52 offen lds
  s_add_u32 s52, s52, 0xfffe4000
  s_add_u32 m0, m0, 1024
  s_nop 0
  buffer_load_dwordx4 v96, s[76:79], s52 offen lds
  s_add_u32 s52, s52, 0x20000
  s_add_u32 m0, m0, 1024
  s_nop 0
  buffer_load_dwordx4 v96, s[76:79], s52 offen lds
  ds_read_b64_tr_b16 a[92:93], v100 offset:12288
  ds_read_b64_tr_b16 a[94:95], v100 offset:14336
  ds_read_b64_tr_b16 a[124:125], v101 offset:12288
  ds_read_b64_tr_b16 a[126:127], v101 offset:14336
  ds_read_b64_tr_b16 a[156:157], v102 offset:12288
  ds_read_b64_tr_b16 a[158:159], v102 offset:14336
  ds_read_b64_tr_b16 a[188:189], v103 offset:12288
  ds_read_b64_tr_b16 a[190:191], v103 offset:14336
  s_waitcnt lgkmcnt(0)
  s_waitcnt vmcnt(12)
  s_barrier
  s_add_u32 m0, s67, 12288
  s_xor_b32 s52, s100, 1
  s_lshl_b32 s52, s52, 19
  s_add_u32 s52, s52, s50
  buffer_load_dwordx4 v96, s[76:79], s52 offen lds
  s_add_u32 s52, s52, 0x20000
  s_add_u32 m0, m0, 1024
  s_nop 0
  buffer_load_dwordx4 v96, s[76:79], s52 offen lds
  s_add_u32 s52, s52, 0xfffe4000
  s_add_u32 m0, m0, 1024
  s_nop 0
  buffer_load_dwordx4 v96, s[76:79], s52 offen lds
  s_add_u32 s52, s52, 0x20000
  s_add_u32 m0, m0, 1024
  s_nop 0
  buffer_load_dwordx4 v96, s[76:79], s52 offen lds
  ds_read_b64_tr_b16 a[104:105], v100 offset:16384
  ds_read_b64_tr_b16 a[106:107], v100 offset:18432
  ds_read_b64_tr_b16 a[136:137], v101 offset:16384
  ds_read_b64_tr_b16 a[138:139], v101 offset:18432
  ds_read_b64_tr_b16 a[168:169], v102 offset:16384
  ds_read_b64_tr_b16 a[170:171], v102 offset:18432
  ds_read_b64_tr_b16 a[200:201], v103 offset:16384
  ds_read_b64_tr_b16 a[202:203], v103 offset:18432
  s_waitcnt lgkmcnt(0)
  s_waitcnt vmcnt(12)
  s_barrier
  s_add_u32 m0, s67, 16384
  s_xor_b32 s52, s100, 1
  s_lshl_b32 s52, s52, 19
  s_add_u32 s52, s52, s50
  s_add_u32 s52, s52, 262144
  buffer_load_dwordx4 v96, s[76:79], s52 offen lds
  s_add_u32 s52, s52, 0x20000
  s_add_u32 m0, m0, 1024
  s_nop 0
  buffer_load_dwordx4 v96, s[76:79], s52 offen lds
  s_add_u32 s52, s52, 0xfffe4000
  s_add_u32 m0, m0, 1024
  s_nop 0
  buffer_load_dwordx4 v96, s[76:79], s52 offen lds
  s_add_u32 s52, s52, 0x20000
  s_add_u32 m0, m0, 1024
  s_nop 0
  buffer_load_dwordx4 v96, s[76:79], s52 offen lds
  ds_read_b64_tr_b16 a[108:109], v100 offset:0
  ds_read_b64_tr_b16 a[110:111], v100 offset:2048
  ds_read_b64_tr_b16 a[140:141], v101 offset:0
  ds_read_b64_tr_b16 a[142:143], v101 offset:2048
  ds_read_b64_tr_b16 a[172:173], v102 offset:0
  ds_read_b64_tr_b16 a[174:175], v102 offset:2048
  ds_read_b64_tr_b16 a[204:205], v103 offset:0
  ds_read_b64_tr_b16 a[206:207], v103 offset:2048
  s_waitcnt lgkmcnt(0)
  s_waitcnt vmcnt(12)
  s_barrier
  s_add_u32 m0, s67, 0
  s_xor_b32 s52, s100, 4
  s_lshl_b32 s52, s52, 19
  s_add_u32 s52, s52, s50
  buffer_load_dwordx4 v96, s[76:79], s52 offen lds
  s_add_u32 s52, s52, 0x20000
  s_add_u32 m0, m0, 1024
  s_nop 0
  buffer_load_dwordx4 v96, s[76:79], s52 offen lds
  s_add_u32 s52, s52, 0xfffe4000
  s_add_u32 m0, m0, 1024
  s_nop 0
  buffer_load_dwordx4 v96, s[76:79], s52 offen lds
  s_add_u32 s52, s52, 0x20000
  s_add_u32 m0, m0, 1024
  s_nop 0
  buffer_load_dwordx4 v96, s[76:79], s52 offen lds
  ds_read_b64_tr_b16 v[112:113], v100 offset:4096
  ds_read_b64_tr_b16 v[114:115], v100 offset:6144
  ds_read_b64_tr_b16 v[116:117], v101 offset:4096
  ds_read_b64_tr_b16 v[118:119], v101 offset:6144
  ds_read_b64_tr_b16 a[208:209], v102 offset:4096
  ds_read_b64_tr_b16 a[210:211], v102 offset:6144
  ds_read_b64_tr_b16 a[224:225], v103 offset:4096
  ds_read_b64_tr_b16 a[226:227], v103 offset:6144
  s_waitcnt lgkmcnt(0)
  ds_write_b128 v4, v[112:115] offset:32768
  ds_write_b128 v5, v[116:119] offset:16384
  s_waitcnt lgkmcnt(0)
  s_waitcnt vmcnt(12)
  s_barrier
  s_add_u32 m0, s67, 4096
  s_xor_b32 s52, s100, 4
  s_lshl_b32 s52, s52, 19
  s_add_u32 s52, s52, s50
  s_add_u32 s52, s52, 262144
  buffer_load_dwordx4 v96, s[76:79], s52 offen lds
  s_add_u32 s52, s52, 0x20000
  s_add_u32 m0, m0, 1024
  s_nop 0
  buffer_load_dwordx4 v96, s[76:79], s52 offen lds
  s_add_u32 s52, s52, 0xfffe4000
  s_add_u32 m0, m0, 1024
  s_nop 0
  buffer_load_dwordx4 v96, s[76:79], s52 offen lds
  s_add_u32 s52, s52, 0x20000
  s_add_u32 m0, m0, 1024
  s_nop 0
  buffer_load_dwordx4 v96, s[76:79], s52 offen lds
  ds_read_b64_tr_b16 v[112:113], v100 offset:8192
  ds_read_b64_tr_b16 v[114:115], v100 offset:10240
  ds_read_b64_tr_b16 v[116:117], v101 offset:8192
  ds_read_b64_tr_b16 v[118:119], v101 offset:10240
  ds_read_b64_tr_b16 a[212:213], v102 offset:8192
  ds_read_b64_tr_b16 a[214:215], v102 offset:10240
  ds_read_b64_tr_b16 a[228:229], v103 offset:8192
  ds_read_b64_tr_b16 a[230:231], v103 offset:10240
  s_waitcnt lgkmcnt(0)
  ds_write_b128 v4, v[112:115] offset:33792
  ds_write_b128 v5, v[116:119] offset:17408
  s_waitcnt lgkmcnt(0)
  s_waitcnt vmcnt(12)
  s_barrier
  s_add_u32 m0, s67, 8192
  s_xor_b32 s52, s100, 5
  s_lshl_b32 s52, s52, 19
  s_add_u32 s52, s52, s50
  buffer_load_dwordx4 v96, s[76:79], s52 offen lds
  s_add_u32 s52, s52, 0x20000
  s_add_u32 m0, m0, 1024
  s_nop 0
  buffer_load_dwordx4 v96, s[76:79], s52 offen lds
  s_add_u32 s52, s52, 0xfffe4000
  s_add_u32 m0, m0, 1024
  s_nop 0
  buffer_load_dwordx4 v96, s[76:79], s52 offen lds
  s_add_u32 s52, s52, 0x20000
  s_add_u32 m0, m0, 1024
  s_nop 0
  buffer_load_dwordx4 v96, s[76:79], s52 offen lds
  v_lshrrev_b32 v83, 2, v1
  v_add_u32 v83, 128, v83
  v_mov_b32 v90, 1
  s_mov_b32 exec_lo, 0
  v_mov_b32 v83, 0
  v_mov_b32 v90, 192
  s_mov_b32 exec_lo, -1
  buffer_load_dword v82, v83, s[8:11], 0 offen sc1
  ds_read_b64_tr_b16 v[112:113], v100 offset:12288
  ds_read_b64_tr_b16 v[114:115], v100 offset:14336
  ds_read_b64_tr_b16 a[8:9], v101 offset:12288
  ds_read_b64_tr_b16 a[10:11], v101 offset:14336
  ds_read_b64_tr_b16 a[216:217], v102 offset:12288
  ds_read_b64_tr_b16 a[218:219], v102 offset:14336
  ds_read_b64_tr_b16 a[232:233], v103 offset:12288
  ds_read_b64_tr_b16 a[234:235], v103 offset:14336
  s_waitcnt lgkmcnt(0)
  ds_write_b128 v4, v[112:115] offset:57344
  s_waitcnt lgkmcnt(0)
  s_waitcnt vmcnt(13)
  s_barrier
  s_add_u32 m0, s67, 12288
  s_xor_b32 s52, s100, 5
  s_lshl_b32 s52, s52, 19
  s_add_u32 s52, s52, s50
  s_add_u32 s52, s52, 262144
  buffer_load_dwordx4 v96, s[76:79], s52 offen lds
  s_add_u32 s52, s52, 0x20000
  s_add_u32 m0, m0, 1024
  s_nop 0
  buffer_load_dwordx4 v96, s[76:79], s52 offen lds
  s_add_u32 s52, s52, 0xfffe4000
  s_add_u32 m0, m0, 1024
  s_nop 0
  buffer_load_dwordx4 v96, s[76:79], s52 offen lds
  s_add_u32 s52, s52, 0x20000
  s_add_u32 m0, m0, 1024
  s_nop 0
  buffer_load_dwordx4 v96, s[76:79], s52 offen lds
  ds_read_b64_tr_b16 v[112:113], v100 offset:16384
  ds_read_b64_tr_b16 v[114:115], v100 offset:18432
  ds_read_b64_tr_b16 a[12:13], v101 offset:16384
  ds_read_b64_tr_b16 a[14:15], v101 offset:18432
  ds_read_b64_tr_b16 a[220:221], v102 offset:16384
  ds_read_b64_tr_b16 a[222:223], v102 offset:18432
  ds_read_b64_tr_b16 a[236:237], v103 offset:16384
  ds_read_b64_tr_b16 a[238:239], v103 offset:18432
  s_waitcnt lgkmcnt(0)
  ds_write_b128 v4, v[112:115] offset:58368
  s_waitcnt lgkmcnt(0)
  s_waitcnt vmcnt(13)
  s_barrier
  s_add_u32 m0, s67, 16384
  s_xor_b32 s52, s3, 0
  s_lshl_b32 s52, s52, 15
  s_add_u32 s52, s52, s51
  buffer_load_dwordx4 v97, s[12:15], s52 offen lds
  s_add_u32 s52, s52, 0x800
  s_add_u32 m0, m0, 1024
  s_nop 0
  buffer_load_dwordx4 v97, s[12:15], s52 offen lds
  s_add_u32 s52, s52, 0x1800
  s_add_u32 m0, m0, 1024
  s_nop 0
  buffer_load_dwordx4 v97, s[12:15], s52 offen lds
  s_add_u32 s52, s52, 0x800
  s_add_u32 m0, m0, 1024
  s_nop 0
  buffer_load_dwordx4 v97, s[12:15], s52 offen lds
  ds_read_b64_tr_b16 a[240:241], v100 offset:0
  ds_read_b64_tr_b16 a[242:243], v100 offset:2048
  ds_read_b64_tr_b16 v[136:137], v101 offset:0
  ds_read_b64_tr_b16 v[138:139], v101 offset:2048
  ds_read_b64_tr_b16 v[152:153], v102 offset:0
  ds_read_b64_tr_b16 v[154:155], v102 offset:2048
  ds_read_b64_tr_b16 v[168:169], v103 offset:0
  ds_read_b64_tr_b16 v[170:171], v103 offset:2048
  s_waitcnt lgkmcnt(0)
  s_waitcnt vmcnt(13)
  s_barrier
  s_add_u32 m0, s67, 0
  s_xor_b32 s52, s3, 0
  s_lshl_b32 s52, s52, 15
  s_add_u32 s52, s52, s51
  s_add_u32 s52, s52, 128
  buffer_load_dwordx4 v97, s[12:15], s52 offen lds
  s_add_u32 s52, s52, 0x800
  s_add_u32 m0, m0, 1024
  s_nop 0
  buffer_load_dwordx4 v97, s[12:15], s52 offen lds
  s_add_u32 s52, s52, 0x1800
  s_add_u32 m0, m0, 1024
  s_nop 0
  buffer_load_dwordx4 v97, s[12:15], s52 offen lds
  s_add_u32 s52, s52, 0x800
  s_add_u32 m0, m0, 1024
  s_nop 0
  buffer_load_dwordx4 v97, s[12:15], s52 offen lds
  ds_read_b64_tr_b16 a[244:245], v100 offset:4096
  ds_read_b64_tr_b16 a[246:247], v100 offset:6144
  ds_read_b64_tr_b16 v[140:141], v101 offset:4096
  ds_read_b64_tr_b16 v[142:143], v101 offset:6144
  ds_read_b64_tr_b16 v[156:157], v102 offset:4096
  ds_read_b64_tr_b16 v[158:159], v102 offset:6144
  ds_read_b64_tr_b16 v[172:173], v103 offset:4096
  ds_read_b64_tr_b16 v[174:175], v103 offset:6144
  s_waitcnt lgkmcnt(0)
  s_waitcnt vmcnt(13)
  s_barrier
  s_add_u32 m0, s67, 4096
  s_xor_b32 s52, s3, 1
  s_lshl_b32 s52, s52, 15
  s_add_u32 s52, s52, s51
  buffer_load_dwordx4 v97, s[12:15], s52 offen lds
  s_add_u32 s52, s52, 0x800
  s_add_u32 m0, m0, 1024
  s_nop 0
  buffer_load_dwordx4 v97, s[12:15], s52 offen lds
  s_add_u32 s52, s52, 0x1800
  s_add_u32 m0, m0, 1024
  s_nop 0
  buffer_load_dwordx4 v97, s[12:15], s52 offen lds
  s_add_u32 s52, s52, 0x800
  s_add_u32 m0, m0, 1024
  s_nop 0
  buffer_load_dwordx4 v97, s[12:15], s52 offen lds
  ds_read_b64_tr_b16 a[248:249], v100 offset:8192
  ds_read_b64_tr_b16 a[250:251], v100 offset:10240
  ds_read_b64_tr_b16 v[144:145], v101 offset:8192
  ds_read_b64_tr_b16 v[146:147], v101 offset:10240
  ds_read_b64_tr_b16 v[160:161], v102 offset:8192
  ds_read_b64_tr_b16 v[162:163], v102 offset:10240
  ds_read_b64_tr_b16 v[176:177], v103 offset:8192
  ds_read_b64_tr_b16 v[178:179], v103 offset:10240
  s_waitcnt lgkmcnt(0)
  s_waitcnt vmcnt(12)
  s_barrier
  s_add_u32 m0, s67, 8192
  s_xor_b32 s52, s3, 1
  s_lshl_b32 s52, s52, 15
  s_add_u32 s52, s52, s51
  s_add_u32 s52, s52, 128
  buffer_load_dwordx4 v97, s[12:15], s52 offen lds
  s_add_u32 s52, s52, 0x800
  s_add_u32 m0, m0, 1024
  s_nop 0
  buffer_load_dwordx4 v97, s[12:15], s52 offen lds
  s_add_u32 s52, s52, 0x1800
  s_add_u32 m0, m0, 1024
  s_nop 0
  buffer_load_dwordx4 v97, s[12:15], s52 offen lds
  s_add_u32 s52, s52, 0x800
  s_add_u32 m0, m0, 1024
  s_nop 0
  buffer_load_dwordx4 v97, s[12:15], s52 offen lds
  s_waitcnt vmcnt(20)
  s_mov_b32 s66, 0
L_c_ids:
  v_cmp_gt_u32 vcc, v90, v82
  s_cbranch_vccz L_c_ids_ok
  s_sleep 2
  buffer_load_dword v82, v83, s[8:11], 0 offen sc1
  s_waitcnt vmcnt(0)
  s_add_u32 s66, s66, 1
  s_cmp_lt_u32 s66, 0x400000
  s_cbranch_scc1 L_c_ids
  s_branch L_end
L_c_ids_ok:
  v_readfirstlane_b32 s52, v82
  s_nop 1
  v_cmp_ne_u32 s[80:81], s52, v82
  v_bfe_u32 v89, v1, 4, 2
  v_lshlrev_b32 v89, 7, v89
  buffer_load_dword v88, v89, s[4:7], s63 offen sc1
  s_xor_b32 s52, s55, 0x2000
  buffer_load_dwordx4 v[84:87], v1, s[4:7], s58 offen offset:0 sc1
  buffer_load_dwordx4 v[84:87], v1, s[4:7], s58 offen offset:1024 sc1
  buffer_load_dwordx4 v[84:87], v3, s[4:7], s55 offen offset:0 sc1
  buffer_load_dwordx4 v[84:87], v3, s[4:7], s55 offen offset:1024 sc1
  buffer_load_dwordx4 v[84:87], v3, s[4:7], s52 offen offset:0 sc1
  buffer_load_dwordx4 v[84:87], v3, s[4:7], s52 offen offset:1024 sc1
  ds_read_b64_tr_b16 a[252:253], v100 offset:12288
  ds_read_b64_tr_b16 a[254:255], v100 offset:14336
  ds_read_b64_tr_b16 v[148:149], v101 offset:12288
  ds_read_b64_tr_b16 v[150:151], v101 offset:14336
  ds_read_b64_tr_b16 v[164:165], v102 offset:12288
  ds_read_b64_tr_b16 v[166:167], v102 offset:14336
  ds_read_b64_tr_b16 v[180:181], v103 offset:12288
  ds_read_b64_tr_b16 v[182:183], v103 offset:14336
  s_waitcnt lgkmcnt(0)
  s_waitcnt vmcnt(19)
  s_barrier
  s_add_u32 m0, s67, 12288
  s_xor_b32 s52, s3, 2
  s_lshl_b32 s52, s52, 15
  s_add_u32 s52, s52, s51
  buffer_load_dwordx4 v97, s[12:15], s52 offen lds
  s_add_u32 s52, s52, 0x800
  s_add_u32 m0, m0, 1024
  s_nop 0
  buffer_load_dwordx4 v97, s[12:15], s52 offen lds
  s_add_u32 s52, s52, 0x1800
  s_add_u32 m0, m0, 1024
  s_nop 0
  buffer_load_dwordx4 v97, s[12:15], s52 offen lds
  s_add_u32 s52, s52, 0x800
  s_add_u32 m0, m0, 1024
  s_nop 0
  buffer_load_dwordx4 v97, s[12:15], s52 offen lds
  ds_read_b64_tr_b16 v[184:185], v98 offset:16384
  ds_read_b64_tr_b16 v[186:187], v98 offset:17408
  ds_read_b64_tr_b16 v[188:189], v98 offset:18432
  ds_read_b64_tr_b16 v[190:191], v98 offset:19456
  ds_read_b64_tr_b16 v[192:193], v98 offset:16416
  ds_read_b64_tr_b16 v[194:195], v98 offset:17440
  ds_read_b64_tr_b16 v[196:197], v98 offset:18464
  ds_read_b64_tr_b16 v[198:199], v98 offset:19488
  s_waitcnt lgkmcnt(0)
  s_waitcnt vmcnt(19)
  s_add_u32 m0, s67, 16384
  s_xor_b32 s52, s3, 2
  s_lshl_b32 s52, s52, 15
  s_add_u32 s52, s52, s51
  s_add_u32 s52, s52, 128
  buffer_load_dwordx4 v97, s[12:15], s52 offen lds
  s_add_u32 s52, s52, 0x800
  s_add_u32 m0, m0, 1024
  s_nop 0
  buffer_load_dwordx4 v97, s[12:15], s52 offen lds
  s_add_u32 s52, s52, 0x1800
  s_add_u32 m0, m0, 1024
  s_nop 0
  buffer_load_dwordx4 v97, s[12:15], s52 offen lds
  s_add_u32 s52, s52, 0x800
  s_add_u32 m0, m0, 1024
  s_nop 0
  buffer_load_dwordx4 v97, s[12:15], s52 offen lds
  ds_read_b64_tr_b16 v[200:201], v98 offset:0
  ds_read_b64_tr_b16 v[202:203], v98 offset:1024
  ds_read_b64_tr_b16 v[204:205], v98 offset:2048
  ds_read_b64_tr_b16 v[206:207], v98 offset:3072
  ds_read_b64_tr_b16 v[208:209], v98 offset:32
  ds_read_b64_tr_b16 v[210:211], v98 offset:1056
  ds_read_b64_tr_b16 v[212:213], v98 offset:2080
  ds_read_b64_tr_b16 v[214:215], v98 offset:3104
  s_waitcnt lgkmcnt(0)
  s_waitcnt vmcnt(19)
  s_add_u32 m0, s67, 0
  s_xor_b32 s52, s3, 3
  s_lshl_b32 s52, s52, 15
  s_add_u32 s52, s52, s51
  buffer_load_dwordx4 v97, s[12:15], s52 offen lds
  s_add_u32 s52, s52, 0x800
  s_add_u32 m0, m0, 1024
  s_nop 0
  buffer_load_dwordx4 v97, s[12:15], s52 offen lds
  s_add_u32 s52, s52, 0x1800
  s_add_u32 m0, m0, 1024
  s_nop 0
  buffer_load_dwordx4 v97, s[12:15], s52 offen lds
  s_add_u32 s52, s52, 0x800
  s_add_u32 m0, m0, 1024
  s_nop 0
  buffer_load_dwordx4 v97, s[12:15], s52 offen lds
  ds_read_b64_tr_b16 v[216:217], v98 offset:4096
  ds_read_b64_tr_b16 v[218:219], v98 offset:5120
  ds_read_b64_tr_b16 v[220:221], v98 offset:6144
  ds_read_b64_tr_b16 v[222:223], v98 offset:7168
  ds_read_b64_tr_b16 v[240:241], v98 offset:4128
  ds_read_b64_tr_b16 v[242:243], v98 offset:5152
  ds_read_b64_tr_b16 v[244:245], v98 offset:6176
  ds_read_b64_tr_b16 v[246:247], v98 offset:7200
  s_waitcnt lgkmcnt(0)
  s_waitcnt vmcnt(19)
  s_add_u32 m0, s67, 4096
  s_xor_b32 s52, s3, 3
  s_lshl_b32 s52, s52, 15
  s_add_u32 s52, s52, s51
  s_add_u32 s52, s52, 128
  buffer_load_dwordx4 v97, s[12:15], s52 offen lds
  s_add_u32 s52, s52, 0x800
  s_add_u32 m0, m0, 1024
  s_nop 0
  buffer_load_dwordx4 v97, s[12:15], s52 offen lds
  s_add_u32 s52, s52, 0x1800
  s_add_u32 m0, m0, 1024
  s_nop 0
  buffer_load_dwordx4 v97, s[12:15], s52 offen lds
  s_add_u32 s52, s52, 0x800
  s_add_u32 m0, m0, 1024
  s_nop 0
  buffer_load_dwordx4 v97, s[12:15], s52 offen lds
  ds_read_b64_tr_b16 v[32:33], v98 offset:8192
  ds_read_b64_tr_b16 v[34:35], v98 offset:9216
  ds_read_b64_tr_b16 v[36:37], v98 offset:10240
  ds_read_b64_tr_b16 v[38:39], v98 offset:11264
  ds_read_b64_tr_b16 v[56:57], v98 offset:8224
  ds_read_b64_tr_b16 v[58:59], v98 offset:9248
  ds_read_b64_tr_b16 v[60:61], v98 offset:10272
  ds_read_b64_tr_b16 v[62:63], v98 offset:11296
  s_waitcnt lgkmcnt(0)
  s_waitcnt vmcnt(12)
  s_waitcnt vmcnt(22)
  s_mov_b32 s66, 0
L_c_g0:
  v_readlane_b32 s52, v88, 0
  v_readlane_b32 s83, v88, 1
  s_min_u32 s52, s52, s83
  v_readlane_b32 s83, v88, 2
  s_min_u32 s52, s52, s83
  v_readlane_b32 s83, v88, 3
  s_min_u32 s52, s52, s83
  s_lshl_b32 s52, s52, 1
  s_cmp_gt_u32 s52, 0
  s_cbranch_scc1 L_c_g0_ok
  s_sleep 2
  buffer_load_dword v88, v89, s[4:7], s63 offen sc1
  s_waitcnt vmcnt(0)
  s_add_u32 s66, s66, 1
  s_cmp_lt_u32 s66, 0x400000
  s_cbranch_scc1 L_c_g0
  s_branch L_end
L_c_g0_ok:
  s_and_b32 s83, s52, -8
  s_cmp_gt_u32 s83, 0
  s_cselect_b32 s83, s83, s52
  s_sub_u32 s83, s83, 1
  s_mov_b32 s66, 0
  v_lshlrev_b32 v83, 2, v1
  buffer_load_dword v88, v83, s[4:7], s60 offen sc1
  buffer_load_dword v88, v83, s[4:7], s60 offen offset:4032 sc1
  buffer_load_dword v88, v83, s[4:7], s61 offen sc1
  buffer_load_dword v88, v83, s[4:7], s61 offen offset:4032 sc1
  v_mov_b32 v105, v89
  buffer_load_dword v104, v105, s[4:7], s63 offen sc1
  ds_read_b64_tr_b16 v[224:225], v98 offset:12288
  ds_read_b64_tr_b16 v[226:227], v98 offset:13312
  ds_read_b64_tr_b16 v[228:229], v98 offset:14336
  ds_read_b64_tr_b16 v[230:231], v98 offset:15360
  ds_read_b64_tr_b16 v[248:249], v98 offset:12320
  ds_read_b64_tr_b16 v[250:251], v98 offset:13344
  ds_read_b64_tr_b16 v[252:253], v98 offset:14368
  ds_read_b64_tr_b16 v[254:255], v98 offset:15392
  s_waitcnt lgkmcnt(0)
  s_waitcnt vmcnt(13)
  ds_read_b64_tr_b16 v[40:41], v98 offset:16384
  ds_read_b64_tr_b16 v[42:43], v98 offset:17408
  ds_read_b64_tr_b16 v[44:45], v98 offset:18432
  ds_read_b64_tr_b16 v[46:47], v98 offset:19456
  ds_read_b64_tr_b16 v[64:65], v98 offset:16416
  ds_read_b64_tr_b16 v[66:67], v98 offset:17440
  ds_read_b64_tr_b16 v[68:69], v98 offset:18464
  ds_read_b64_tr_b16 v[70:71], v98 offset:19488
  s_waitcnt lgkmcnt(0)
  s_waitcnt vmcnt(9)
  ds_read_b64_tr_b16 v[232:233], v98 offset:0
  ds_read_b64_tr_b16 v[234:235], v98 offset:1024
  ds_read_b64_tr_b16 v[236:237], v98 offset:2048
  ds_read_b64_tr_b16 v[238:239], v98 offset:3072
  ds_read_b64_tr_b16 v[24:25], v98 offset:32
  ds_read_b64_tr_b16 v[26:27], v98 offset:1056
  ds_read_b64_tr_b16 v[28:29], v98 offset:2080
  ds_read_b64_tr_b16 v[30:31], v98 offset:3104
  s_waitcnt lgkmcnt(0)
  s_waitcnt vmcnt(5)
  ds_read_b64_tr_b16 v[48:49], v98 offset:4096
  ds_read_b64_tr_b16 v[50:51], v98 offset:5120
  ds_read_b64_tr_b16 v[52:53], v98 offset:6144
  ds_read_b64_tr_b16 v[54:55], v98 offset:7168
  ds_read_b64_tr_b16 v[72:73], v98 offset:4128
  ds_read_b64_tr_b16 v[74:75], v98 offset:5152
  ds_read_b64_tr_b16 v[76:77], v98 offset:6176
  ds_read_b64_tr_b16 v[78:79], v98 offset:7200
  s_waitcnt lgkmcnt(0)
  s_barrier
  s_lshl_b32 s52, s3, 11
  s_add_u32 s13, s52, 8192
  s_mov_b32 m0, s13
  s_nop 0
  buffer_load_dwordx4 v3, s[4:7], s60 offen sc1 lds
  buffer_load_dwordx4 v3, s[4:7], s60 offen offset:1024 sc1 lds
  s_add_u32 s60, s60, 0x8000
  s_mov_b32 s46, 0x000f000f
  s_mov_b32 s47, 0x000f000f
  s_mov_b32 s54, 0
  s_mov_b32 s14, 8192
  s_xor_b32 m0, m0, 24576
  s_mov_b32 s15, -0x1000
  ds_write_b128 v3, v[24:27] offset:24576
  ds_write_b128 v3, v[28:31] offset:25600
  ds_write_b128 v3, v[32:35] offset:32768
  ds_write_b128 v3, v[36:39] offset:33792
  ds_write_b128 v3, v[40:43] offset:40960
  ds_write_b128 v3, v[44:47] offset:41984
  ds_write_b128 v3, v[48:51] offset:49152
  ds_write_b128 v3, v[52:55] offset:50176
  ds_write_b128 v3, v[56:59] offset:57344
  ds_write_b128 v3, v[60:63] offset:58368
  ds_write_b128 v4, v[64:67] offset:0
  ds_write_b128 v4, v[68:71] offset:1024
  ds_write_b128 v4, v[72:75] offset:8192
  ds_write_b128 v4, v[76:79] offset:9216
  s_waitcnt vmcnt(2)
  ds_read_b128 v[24:27], v4 offset:16384
  ds_read_b128 v[28:31], v4 offset:17408
  ds_read_b128 v[32:35], v4 offset:24576
  ds_read_b128 v[36:39], v4 offset:25600
  ds_read_b128 v[40:43], v4 offset:32768
  ds_read_b128 v[44:47], v4 offset:33792
  ds_read_b128 v[48:51], v4 offset:40960
  ds_read_b128 v[52:55], v4 offset:41984
  ds_read_b128 v[56:59], v4 offset:49152
  ds_read_b128 v[60:63], v4 offset:50176
  ds_read_b128 v[64:67], v4 offset:57344
  ds_read_b128 v[68:71], v4 offset:58368
  ds_read_b128 v[72:75], v5 offset:0
  ds_read_b128 v[76:79], v5 offset:1024
  s_mov_b32 s66, 0
L_c_g1:
  v_readlane_b32 s52, v104, 0
  v_readlane_b32 s83, v104, 1
  s_min_u32 s52, s52, s83
  v_readlane_b32 s83, v104, 2
  s_min_u32 s52, s52, s83
  v_readlane_b32 s83, v104, 3
  s_min_u32 s52, s52, s83
  s_lshl_b32 s52, s52, 1
  s_cmp_gt_u32 s52, 11
  s_cbranch_scc1 L_c_g1_ok
  s_sleep 2
  buffer_load_dword v104, v105, s[4:7], s63 offen sc1
  s_waitcnt vmcnt(0)
  s_add_u32 s66, s66, 1
  s_cmp_lt_u32 s66, 0x400000
  s_cbranch_scc1 L_c_g1
  s_branch L_end
L_c_g1_ok:
  s_and_b32 s83, s52, -8
  s_cmp_gt_u32 s83, 11
  s_cselect_b32 s83, s83, s52
  s_cmp_ge_u32 s52, 12
  s_cselect_b32 s83, 12, s83
  s_cmp_eq_u32 s52, 64
  s_cselect_b32 s83, 64, s83
  s_sub_u32 s83, s83, 1
  s_mov_b32 s66, 0
  v_mov_b32 v120, 0
  v_mov_b32 v121, 0
  v_mov_b32 v122, 0
  v_mov_b32 v123, 0
  v_mov_b32 v124, 0
  v_mov_b32 v125, 0
  v_mov_b32 v126, 0
  v_mov_b32 v127, 0
  v_mov_b32 v128, 0
  v_mov_b32 v129, 0
  v_mov_b32 v130, 0
  v_mov_b32 v131, 0
  v_mov_b32 v132, 0
  v_mov_b32 v133, 0
  v_mov_b32 v134, 0
  v_mov_b32 v135, 0
  s_waitcnt lgkmcnt(0)
  s_cmp_lg_u32 s80, 0
  s_cbranch_scc1 L_cs_step
  s_branch L_cf_step
L_cf_pm0_loop:
  s_mov_b64 exec, vcc
  buffer_load_dwordx4 v[112:115], v0, s[4:7], s55 offen sc1
  buffer_load_dwordx4 v[116:119], v0, s[4:7], s55 offen offset:1024 sc1
  s_mov_b64 exec, -1
  s_waitcnt vmcnt(2)
  v_cmp_eq_u32 vcc, -1, v104
  v_cmp_eq_u32 s[50:51], -1, v108
  s_or_b64 vcc, vcc, s[50:51]
  s_cbranch_scc1 L_cf_pm0_b
  ds_write_b128 v3, v[104:107] offset:0
  ds_write_b128 v3, v[108:111] offset:1024
  s_branch L_cf_pm0_go
L_cf_pm0_retry:
  s_mov_b64 vcc, -1
L_cf_pm0_b:
  s_mov_b64 exec, vcc
  buffer_load_dwordx4 v[104:107], v3, s[4:7], s55 offen sc1
  buffer_load_dwordx4 v[108:111], v3, s[4:7], s55 offen offset:1024 sc1
  s_mov_b64 exec, -1
  s_waitcnt vmcnt(2)
  v_cmp_eq_u32 vcc, -1, v112
  v_cmp_eq_u32 s[50:51], -1, v116
  s_or_b64 vcc, vcc, s[50:51]
  s_cbranch_scc0 L_cf_pm0_bok
  s_add_u32 s66, s66, 1
  s_cmp_lt_u32 s66, 0x400000
  s_cbranch_scc1 L_cf_pm0_loop
  s_branch L_end
L_cf_pm0_bok:
L_cf_pm0_bok2:
  ds_write_b128 v0, v[112:115] offset:0
  ds_write_b128 v0, v[116:119] offset:1024
  v_mov_b32_dpp v104, v112 row_ror:8 row_mask:0xf bank_mask:0xf
  v_mov_b32_dpp v105, v113 row_ror:8 row_mask:0xf bank_mask:0xf
  v_mov_b32_dpp v106, v114 row_ror:8 row_mask:0xf bank_mask:0xf
  v_mov_b32_dpp v107, v115 row_ror:8 row_mask:0xf bank_mask:0xf
  v_mov_b32_dpp v108, v116 row_ror:8 row_mask:0xf bank_mask:0xf
  v_mov_b32_dpp v109, v117 row_ror:8 row_mask:0xf bank_mask:0xf
  v_mov_b32_dpp v110, v118 row_ror:8 row_mask:0xf bank_mask:0xf
  v_mov_b32_dpp v111, v119 row_ror:8 row_mask:0xf bank_mask:0xf
L_cf_pm0_go:
  v_smfmac_f32_16x16x64_bf16 v[128:131], v[104:107], v[24:31], v11
  v_smfmac_f32_16x16x64_bf16 v[124:127], v[104:107], v[32:39], v11
  v_smfmac_f32_16x16x64_bf16 v[120:123], v[104:107], v[40:47], v11
  s_branch L_cf_pm1_join
L_cf_pm1_first:
L_cf_pm1_retry:
  s_mov_b64 exec, vcc
  buffer_load_dwordx4 v[108:111], v3, s[4:7], s55 offen offset:1024 sc1
  s_mov_b64 exec, -1
  s_waitcnt vmcnt(1)
  v_cmp_eq_u32 vcc, -1, v116
  s_cbranch_vccnz L_cf_pm1_again
L_cf_pm1_tw:
  ds_write_b128 v0, v[116:119] offset:1024
  v_mov_b32_dpp v108, v116 row_ror:8 row_mask:0xf bank_mask:0xf
  v_mov_b32_dpp v109, v117 row_ror:8 row_mask:0xf bank_mask:0xf
  v_mov_b32_dpp v110, v118 row_ror:8 row_mask:0xf bank_mask:0xf
  v_mov_b32_dpp v111, v119 row_ror:8 row_mask:0xf bank_mask:0xf
  s_nop 0
  s_branch L_cf_pm1_join
L_cf_pm1_again:
  s_mov_b64 exec, vcc
  buffer_load_dwordx4 v[116:119], v0, s[4:7], s55 offen offset:1024 sc1
  s_mov_b64 exec, -1
  s_waitcnt vmcnt(1)
  v_cmp_eq_u32 vcc, -1, v108
  s_cbranch_vccnz L_cf_pm1_more
  ds_write_b128 v3, v[108:111] offset:1024
  s_branch L_cf_pm1_join
L_cf_pm1_more:
  s_add_u32 s66, s66, 1
  s_cmp_lt_u32 s66, 0x400000
  s_cbranch_scc1 L_cf_pm1_retry
  s_branch L_end
L_cf_pp_retry:
  s_mov_b64 exec, vcc
  buffer_load_dwordx4 v[112:115], v1, s[4:7], s58 offen sc1
  buffer_load_dwordx4 v[116:119], v1, s[4:7], s58 offen offset:1024 sc1
  s_mov_b64 exec, -1
  s_nop 3
  v_mov_b64 v[104:105], 0
  v_mov_b64 v[106:107], 0
  s_waitcnt vmcnt(2)
  s_nop 0
  v_smfmac_f32_16x16x64_bf16 v[104:107], v[12:15], v[96:103], v11
  v_bitop3_b32 v0, v96, v100, s82 bitop3:0x7e
  v_and_b32 v0, 1, v0
  v_cmp_ne_u32 vcc, 0, v0
  s_cbranch_vccz L_cf_pp_join
  s_mov_b64 exec, vcc
  buffer_load_dwordx4 v[96:99], v1, s[4:7], s58 offen sc1
  buffer_load_dwordx4 v[100:103], v1, s[4:7], s58 offen offset:1024 sc1
  s_mov_b64 exec, -1
  s_nop 3
  v_mov_b64 v[104:105], 0
  v_mov_b64 v[106:107], 0
  s_add_u32 s66, s66, 1
  s_cmp_lt_u32 s66, 0x400000
  s_cbranch_scc1 L_cf_pp
  s_branch L_end
L_cf_special:
  s_waitcnt vmcnt(2)
  s_cmp_eq_u32 s54, 63
  s_cbranch_scc1 L_c_last
  v_bfe_u32 v105, v1, 4, 2
  v_lshlrev_b32 v105, 7, v105
  buffer_load_dword v104, v105, s[4:7], s63 offen sc1
  s_add_u32 s53, s54, 1
  s_waitcnt vmcnt(0)
  s_mov_b32 s66, 0
L_cf_gw:
  v_readlane_b32 s52, v104, 0
  v_readlane_b32 s83, v104, 1
  s_min_u32 s52, s52, s83
  v_readlane_b32 s83, v104, 2
  s_min_u32 s52, s52, s83
  v_readlane_b32 s83, v104, 3
  s_min_u32 s52, s52, s83
  s_lshl_b32 s52, s52, 1
  s_cmp_gt_u32 s52, s53
  s_cbranch_scc1 L_cf_gw_ok
  s_sleep 2
  buffer_load_dword v104, v105, s[4:7], s63 offen sc1
  s_waitcnt vmcnt(0)
  s_add_u32 s66, s66, 1
  s_cmp_lt_u32 s66, 0x400000
  s_cbranch_scc1 L_cf_gw
  s_branch L_end
L_cf_gw_ok:
  s_and_b32 s83, s52, -8
  s_cmp_gt_u32 s83, s53
  s_cselect_b32 s83, s83, s52
  s_sub_u32 s83, s83, 1
  s_mov_b32 s66, 0
  s_branch L_cf_step
.p2align 6
L_cf_step:
  v_xor_b32 v0, 128, v3
  ds_read_b128 v[80:83], v5 offset:8192
  s_waitcnt lgkmcnt(0)
  buffer_load_dwordx4 v[104:107], v3, s[4:7], s55 offen offset:0 sc1
  ds_read_b128 v[84:87], v5 offset:9216
  s_waitcnt lgkmcnt(0)
  buffer_load_dwordx4 v[108:111], v3, s[4:7], s55 offen offset:1024 sc1
  s_waitcnt vmcnt(4)
  ds_read_b128 v[88:91], v5 offset:16384
  ds_read_b128 v[92:95], v5 offset:17408
  ds_read_b128 v[96:99], v5 offset:24576
  ds_read_b128 v[100:103], v5 offset:25600
  s_waitcnt lgkmcnt(0)
  buffer_load_dwordx4 v[112:115], v0, s[4:7], s55 offen offset:0 sc1
  buffer_load_dwordx4 v[116:119], v0, s[4:7], s55 offen offset:1024 sc1
  s_waitcnt vmcnt(3) lgkmcnt(6)
  ds_write_b128 v3, v[104:107] offset:0
  v_cmp_eq_u32 vcc, -1, v104
  s_cbranch_vccnz L_cf_pm0_retry
  v_smfmac_f32_16x16x64_bf16 v[128:131], v[104:107], v[24:31], v11
  v_smfmac_f32_16x16x64_bf16 v[124:127], v[104:107], v[32:39], v11
  v_smfmac_f32_16x16x64_bf16 v[120:123], v[104:107], v[40:47], v11
  s_waitcnt vmcnt(2)
  ds_write_b128 v3, v[108:111] offset:1024
  v_cmp_eq_u32 vcc, -1, v108
  s_cbranch_vccnz L_cf_pm1_first
L_cf_pm1_join:
  v_smfmac_f32_16x16x64_bf16 v[128:131], v[108:111], v[48:55], v11
  v_xor_b32 v0, 2048, v3
  v_smfmac_f32_16x16x64_bf16 v[124:127], v[108:111], v[56:63], v11
  v_smfmac_f32_16x16x64_bf16 v[120:123], v[108:111], v[64:71], v11
  s_waitcnt lgkmcnt(0)
  s_barrier
  ds_read_b128 v[24:27], v0 offset:0
  ds_read_b128 v[28:31], v0 offset:1024
  s_waitcnt vmcnt(0)
  v_smfmac_f32_16x16x64_bf16 v[128:131], v[112:115], v[72:79], v11
  buffer_load_dwordx4 v[16:19], v3, s[4:7], s61 offen sc1
  v_smfmac_f32_16x16x64_bf16 v[124:127], v[112:115], v[80:87], v11
  v_xor_b32 v0, 2176, v3
  v_smfmac_f32_16x16x64_bf16 v[120:123], v[112:115], v[88:95], v11
  ds_read_b128 v[32:35], v0 offset:0
  v_smfmac_f32_16x16x64_bf16 v[128:131], v[116:119], v[96:103], v11
  buffer_load_dwordx4 v[20:23], v3, s[4:7], s61 offen offset:1024 sc1
  v_smfmac_f32_16x16x64_bf16 v[124:127], v[116:119], a[0:7], v11
  ds_read_b128 v[36:39], v0 offset:1024
  v_smfmac_f32_16x16x64_bf16 v[120:123], v[116:119], a[8:15], v11
  v_xor_b32 v0, 4096, v3
  s_waitcnt lgkmcnt(2)
  v_smfmac_f32_16x16x64_bf16 v[128:131], v[24:27], a[16:23], v11
  buffer_load_dwordx4 v3, s[4:7], s60 offen sc1 lds
  v_smfmac_f32_16x16x64_bf16 v[124:127], v[24:27], a[24:31], v11
  ds_read_b128 v[40:43], v0 offset:0
  v_smfmac_f32_16x16x64_bf16 v[128:131], v[28:31], a[32:39], v11
  ds_read_b128 v[44:47], v0 offset:1024
  v_smfmac_f32_16x16x64_bf16 v[124:127], v[28:31], a[40:47], v11
  buffer_load_dwordx4 v3, s[4:7], s60 offen offset:1024 sc1 lds
  s_waitcnt lgkmcnt(2)
  v_smfmac_f32_16x16x64_bf16 v[128:131], v[32:35], a[48:55], v11
  v_xor_b32 v0, 4224, v3
  v_smfmac_f32_16x16x64_bf16 v[124:127], v[32:35], a[56:63], v11
  ds_read_b128 v[48:51], v0 offset:0
  v_smfmac_f32_16x16x64_bf16 v[128:131], v[36:39], a[64:71], v11
  buffer_store_dwordx4 v[132:135], v1, s[4:7], s62 offen sc1
  v_smfmac_f32_16x16x64_bf16 v[124:127], v[36:39], a[72:79], v11
  ds_read_b128 v[52:55], v0 offset:1024
  s_waitcnt lgkmcnt(2)
  v_smfmac_f32_16x16x64_bf16 v[128:131], v[40:43], a[80:87], v11
  v_xor_b32 v0, 6144, v3
  v_smfmac_f32_16x16x64_bf16 v[124:127], v[40:43], a[88:95], v11
  ds_read_b128 v[56:59], v0 offset:0
  v_smfmac_f32_16x16x64_bf16 v[128:131], v[44:47], a[96:103], v11
  ds_read_b128 v[60:63], v0 offset:1024
  v_smfmac_f32_16x16x64_bf16 v[124:127], v[44:47], a[104:111], v11
  v_xor_b32 v0, 6272, v3
  s_waitcnt lgkmcnt(2)
  v_smfmac_f32_16x16x64_bf16 v[128:131], v[48:51], a[112:119], v11
  ds_read_b128 v[64:67], v0 offset:0
  v_smfmac_f32_16x16x64_bf16 v[124:127], v[48:51], a[120:127], v11
  ds_read_b128 v[68:71], v0 offset:1024
  v_smfmac_f32_16x16x64_bf16 v[128:131], v[52:55], a[128:135], v11
  v_add_u32 v0, s14, v1
  v_smfmac_f32_16x16x64_bf16 v[124:127], v[52:55], a[136:143], v11
  ds_read_b128 v[72:75], v0 offset:0
  s_waitcnt lgkmcnt(3)
  v_smfmac_f32_16x16x64_bf16 v[128:131], v[56:59], a[144:151], v11
  ds_read_b128 v[76:79], v0 offset:4096
  v_smfmac_f32_16x16x64_bf16 v[124:127], v[56:59], a[152:159], v11
  ds_read_b128 v[80:83], v0 offset:1024
  v_smfmac_f32_16x16x64_bf16 v[128:131], v[60:63], a[160:167], v11
  ds_read_b128 v[84:87], v0 offset:5120
  v_smfmac_f32_16x16x64_bf16 v[124:127], v[60:63], a[168:175], v11
  ds_read_b128 v[88:91], v0 offset:2048
  s_waitcnt lgkmcnt(5)
  v_smfmac_f32_16x16x64_bf16 v[128:131], v[64:67], a[176:183], v11
  ds_read_b128 v[92:95], v0 offset:6144
  v_smfmac_f32_16x16x64_bf16 v[124:127], v[64:67], a[184:191], v11
  ds_read_b128 v[96:99], v0 offset:3072
  v_smfmac_f32_16x16x64_bf16 v[128:131], v[68:71], a[192:199], v11
  ds_read_b128 v[100:103], v0 offset:7168
  v_smfmac_f32_16x16x64_bf16 v[124:127], v[68:71], a[200:207], v11
  v_smfmac_f32_16x16x64_bf16 v[120:123], v[24:27], a[208:215], v11
  s_barrier
  v_smfmac_f32_16x16x64_bf16 v[120:123], v[28:31], a[216:223], v11
  s_nop 0
  v_smfmac_f32_16x16x64_bf16 v[120:123], v[32:35], a[224:231], v11
  s_nop 0
  v_cvt_pk_bf16_f32 v131, v130, v131
  v_cvt_pk_bf16_f32 v130, v128, v129
  v_cvt_pk_bf16_f32 v132, v124, v125
  v_cvt_pk_bf16_f32 v133, v126, v127
  ds_write_b128 v6, v[130:133] offset:0
  v_smfmac_f32_16x16x64_bf16 v[120:123], v[36:39], a[232:239], v11
  v_smfmac_f32_16x16x64_bf16 v[120:123], v[40:43], a[240:247], v11
  v_smfmac_f32_16x16x64_bf16 v[120:123], v[44:47], a[248:255], v11
  v_smfmac_f32_16x16x64_bf16 v[120:123], v[48:51], v[136:143], v11
  v_smfmac_f32_16x16x64_bf16 v[120:123], v[52:55], v[144:151], v11
  s_waitcnt lgkmcnt(0)
  s_barrier
  ds_read_b64_tr_b16 v[104:105], v2 offset:0
  ds_read_b64_tr_b16 v[106:107], v2 offset:512
  v_smfmac_f32_16x16x64_bf16 v[120:123], v[56:59], v[152:159], v11
  ds_read_b64_tr_b16 v[108:109], v2 offset:1024
  ds_read_b64_tr_b16 v[110:111], v2 offset:1536
  v_smfmac_f32_16x16x64_bf16 v[120:123], v[60:63], v[160:167], v11
  ds_read_b64_tr_b16 v[112:113], v2 offset:2048
  ds_read_b64_tr_b16 v[114:115], v2 offset:2560
  v_smfmac_f32_16x16x64_bf16 v[120:123], v[64:67], v[168:175], v11
  ds_read_b64_tr_b16 v[116:117], v2 offset:3072
  ds_read_b64_tr_b16 v[118:119], v2 offset:3584
  v_smfmac_f32_16x16x64_bf16 v[120:123], v[68:71], v[176:183], v11
  s_waitcnt lgkmcnt(4)
  v_mfma_f32_16x16x32_bf16 v[24:27], v[72:75], v[104:107], 0
  v_mov_b32 v129, 0
  v_mov_b32 v130, 0
  v_mfma_f32_16x16x32_bf16 v[28:31], v[76:79], v[104:107], 0
  ds_read_b128 v[40:43], v3 offset:24576
  v_min_u32 v132, -2, v132
  v_mfma_f32_16x16x32_bf16 v[24:27], v[80:83], v[108:111], v[24:27]
  ds_read_b128 v[44:47], v3 offset:25600
  v_mfma_f32_16x16x32_bf16 v[28:31], v[84:87], v[108:111], v[28:31]
  ds_read_b128 v[48:51], v3 offset:32768
  s_waitcnt lgkmcnt(3)
  v_mfma_f32_16x16x32_bf16 v[24:27], v[88:91], v[112:115], v[24:27]
  ds_read_b128 v[52:55], v3 offset:33792
  v_cvt_pk_bf16_f32 v134, v120, v121
  v_mfma_f32_16x16x32_bf16 v[28:31], v[92:95], v[112:115], v[28:31]
  ds_read_b128 v[56:59], v3 offset:40960
  v_cvt_pk_bf16_f32 v36, v122, v123
  v_mfma_f32_16x16x32_bf16 v[24:27], v[96:99], v[116:119], v[24:27]
  ds_read_b128 v[60:63], v3 offset:41984
  v_cvt_pk_bf16_f32 v37, v121, v120
  v_mfma_f32_16x16x32_bf16 v[28:31], v[100:103], v[116:119], v[28:31]
  ds_read_b128 v[64:67], v3 offset:49152
  v_cvt_pk_bf16_f32 v135, v123, v122
  v_mfma_f32_16x16x32_bf16 v[32:35], v[104:107], v[104:107], 0
  v_permlane32_swap_b32 v134, v36
  v_mfma_f32_16x16x32_bf16 v[32:35], v[108:111], v[108:111], v[32:35]
  v_permlane32_swap_b32 v37, v135
  v_mfma_f32_16x16x32_bf16 v[32:35], v[112:115], v[112:115], v[32:35]
  ds_read_b128 v[68:71], v3 offset:50176
  v_mov_b32_dpp v24, v28 row_ror:8 row_mask:0xf bank_mask:0xc
  v_mfma_f32_16x16x32_bf16 v[32:35], v[116:119], v[116:119], v[32:35]
  v_mov_b32_dpp v25, v29 row_ror:8 row_mask:0xf bank_mask:0xc
  v_mov_b32_dpp v26, v30 row_ror:8 row_mask:0xf bank_mask:0xc
  v_mov_b32_dpp v27, v31 row_ror:8 row_mask:0xf bank_mask:0xc
  ds_read_b128 v[72:75], v3 offset:57344
  v_max3_f32 v38, v24, v25, v26
  v_mov_b64 v[104:105], 0
  v_mov_b64 v[106:107], 0
  ds_read_b128 v[76:79], v3 offset:58368
  v_mov_b32_dpp v32, v33 row_ror:8 row_mask:0xf bank_mask:0xc
  v_mov_b32_dpp v34, v35 row_ror:8 row_mask:0xf bank_mask:0xc
  v_mov_b64 v[110:111], 0
  v_mov_b64 v[112:113], 0
  v_permlane32_swap_b32 v32, v34
  v_max3_f32 v38, v38, v27, v34
  v_mov_b64 v[114:115], 0
  v_mov_b64 v[116:117], 0
  v_max_f32_dpp v28, v38, v38 row_ror:8 row_mask:0xf bank_mask:0xf
  v_max_f32_dpp v29, v38, v38 row_ror:8 row_mask:0xf bank_mask:0xf
  v_mov_b64 v[118:119], 0
  v_and_b32 v0, -9, v8
  v_permlane32_swap_b32 v28, v29
  v_max_f32 v30, v28, v29
  v_max_f32 v31, v28, v29
  v_xor_b32 v121, 512, v0
  v_xor_b32 v122, 1024, v0
  v_permlane16_swap_b32 v30, v31
  v_max_f32 v28, v30, v31
  v_mul_f32 v39, s65, v28
  v_fma_f32 v24, v24, s64, v39
  v_fma_f32 v25, v25, s64, v39
  v_fma_f32 v26, v26, s64, v39
  v_fma_f32 v27, v27, s64, v39
  v_fma_f32 v34, v34, s64, v39
  v_exp_f32 v24, v24
  v_exp_f32 v25, v25
  v_exp_f32 v26, v26
  v_exp_f32 v27, v27
  v_exp_f32 v34, v34
  v_cvt_pk_bf16_f32 v124, v24, v25
  v_cvt_pk_bf16_f32 v125, v26, v27
  v_mov_b32_dpp v28, v34 row_ror:8 row_mask:0xf bank_mask:0xf
  v_mov_b32_dpp v126, v124 row_ror:8 row_mask:0xf bank_mask:0xf
  v_mov_b32_dpp v127, v125 row_ror:8 row_mask:0xf bank_mask:0xf
  v_cvt_pk_bf16_f32 v128, v34, v28
  v_cvt_pk_bf16_f32 v131, v34, v28
  s_waitcnt vmcnt(3)
  v_mfma_f32_16x16x32_bf16 v[96:99], v[16:19], v[124:127], 0
  v_add_f32 v36, v24, v25
  v_add_f32 v39, v26, v27
  v_mfma_f32_16x16x32_bf16 v[100:103], v[20:23], v[124:127], 0
  v_add_f32 v36, v36, v34
  v_add_f32 v36, v36, v39
  v_mfma_f32_16x16x16_bf16 v[96:99], v[134:135], v[128:129], v[96:99]
  ds_read_b128 v[80:83], v4 offset:0
  v_add_f32_dpp v28, v36, v36 row_ror:8 row_mask:0xf bank_mask:0xf
  v_add_f32_dpp v29, v36, v36 row_ror:8 row_mask:0xf bank_mask:0xf
  v_mfma_f32_16x16x16_bf16 v[100:103], v[134:135], v[130:131], v[100:103]
  ds_read_b128 v[84:87], v4 offset:1024
  v_permlane32_swap_b32 v28, v29
  v_add_f32 v30, v28, v29
  v_add_f32 v31, v28, v29
  ds_read_b128 v[88:91], v4 offset:8192
  ds_read_b128 v[92:95], v4 offset:9216
  v_permlane16_swap_b32 v30, v31
  v_add_f32 v31, v30, v31
  v_rcp_f32 v31, v31
  v_mov_b32_dpp v96, v100 quad_perm:[0,1,2,3] row_mask:0xf bank_mask:0xc
  v_mov_b32_dpp v97, v101 quad_perm:[0,1,2,3] row_mask:0xf bank_mask:0xc
  v_mov_b32_dpp v98, v102 quad_perm:[0,1,2,3] row_mask:0xf bank_mask:0xc
  v_mov_b32_dpp v99, v103 quad_perm:[0,1,2,3] row_mask:0xf bank_mask:0xc
  v_mul_f32 v96, v96, v31
  v_mul_f32 v97, v97, v31
  v_mul_f32 v98, v98, v31
  v_mul_f32 v99, v99, v31
  v_cvt_pk_bf16_f32 v124, v96, v97
  v_cvt_pk_bf16_f32 v125, v98, v99
  ds_write_b64 v8, v[124:125] offset:4096
  v_mov_b64 v[24:25], v[124:125]
  v_mov_b64 v[26:27], v[124:125]
  v_xor_b32 v123, 1536, v0
  v_mov_b32_dpp v24, v124 row_ror:8 row_mask:0xf bank_mask:0xc
  v_mov_b32_dpp v26, v124 row_ror:8 row_mask:0xf bank_mask:0x3
  v_mov_b32_dpp v25, v125 row_ror:8 row_mask:0xf bank_mask:0xc
  v_mov_b32_dpp v27, v125 row_ror:8 row_mask:0xf bank_mask:0x3
  v_mov_b64 v[108:109], 0
  s_nop 0
  v_smfmac_f32_16x16x64_bf16 v[104:107], v[24:27], v[184:191], v11
  v_smfmac_f32_16x16x64_bf16 v[108:111], v[24:27], v[192:199], v11
  v_smfmac_f32_16x16x64_bf16 v[112:115], v[24:27], v[200:207], v11
  s_waitcnt lgkmcnt(0)
  s_barrier
  ds_read_b128 v[28:31], v121 offset:4096
  ds_read_b128 v[32:35], v122 offset:4096
  ds_read_b128 v[36:39], v123 offset:4096
  v_smfmac_f32_16x16x64_bf16 v[116:119], v[24:27], v[208:215], v11
  s_waitcnt lgkmcnt(2)
  v_smfmac_f32_16x16x64_bf16 v[104:107], v[28:31], v[216:223], v11
  s_waitcnt lgkmcnt(1)
  v_smfmac_f32_16x16x64_bf16 v[104:107], v[32:35], v[224:231], v11
  s_waitcnt lgkmcnt(0)
  v_smfmac_f32_16x16x64_bf16 v[104:107], v[36:39], v[232:239], v11
  v_smfmac_f32_16x16x64_bf16 v[108:111], v[28:31], v[240:247], v11
  s_nop 1
  v_smfmac_f32_16x16x64_bf16 v[108:111], v[32:35], v[248:255], v11
  s_nop 1
  v_smfmac_f32_16x16x64_bf16 v[108:111], v[36:39], v[40:47], v11
  s_nop 0
  v_cvt_pk_bf16_f32 v104, v104, v105
  v_smfmac_f32_16x16x64_bf16 v[112:115], v[28:31], v[48:55], v11
  v_cvt_pk_bf16_f32 v105, v106, v107
  v_bfi_b32 v104, v7, s82, v104
  buffer_store_dwordx2 v[104:105], v9, s[4:7], s56 offen
  v_smfmac_f32_16x16x64_bf16 v[112:115], v[32:35], v[56:63], v11
  s_nop 0
  v_smfmac_f32_16x16x64_bf16 v[112:115], v[36:39], v[64:71], v11
  v_cvt_pk_bf16_f32 v108, v108, v109
  s_nop 0
  v_smfmac_f32_16x16x64_bf16 v[116:119], v[28:31], v[72:79], v11
  v_cvt_pk_bf16_f32 v109, v110, v111
  v_bfi_b32 v108, v7, s82, v108
  buffer_store_dwordx2 v[108:109], v9, s[4:7], s48 offen
  v_smfmac_f32_16x16x64_bf16 v[116:119], v[32:35], v[80:87], v11
  s_nop 0
  v_smfmac_f32_16x16x64_bf16 v[116:119], v[36:39], v[88:95], v11
  v_cvt_pk_bf16_f32 v112, v112, v113
  v_cvt_pk_bf16_f32 v113, v114, v115
  v_bfi_b32 v112, v7, s82, v112
  buffer_store_dwordx2 v[112:113], v9, s[4:7], s57 offen
  v_mov_b64 v[104:105], 0
  v_mov_b64 v[106:107], 0
  v_mov_b32 v108, -1
  s_cmp_lt_u32 s3, 2
  v_cvt_pk_bf16_f32 v116, v116, v117
  v_cvt_pk_bf16_f32 v117, v118, v119
  v_bfi_b32 v116, v7, s82, v116
  buffer_store_dwordx2 v[116:117], v9, s[4:7], s49 offen
  s_mov_b32 s66, 0
  ds_read_b128 v[24:27], v4 offset:16384
  ds_read_b128 v[28:31], v4 offset:17408
  ds_read_b128 v[32:35], v4 offset:24576
  ds_read_b128 v[36:39], v4 offset:25600
  ds_read_b128 v[40:43], v4 offset:32768
  ds_read_b128 v[44:47], v4 offset:33792
  ds_read_b128 v[48:51], v4 offset:40960
  ds_read_b128 v[52:55], v4 offset:41984
  ds_read_b128 v[56:59], v4 offset:49152
  ds_read_b128 v[60:63], v4 offset:50176
  s_cbranch_scc1 L_cf_e1
  ds_read_b128 v[64:67], v4 offset:57344
  ds_read_b128 v[68:71], v4 offset:58368
  ds_read_b128 v[72:75], v5 offset:0
  s_waitcnt lgkmcnt(0)
L_cf_e1:
  buffer_load_dwordx4 v[112:115], v1, s[4:7], s58 offen sc1
  buffer_load_dwordx4 v[116:119], v1, s[4:7], s58 offen offset:1024 sc1
  s_cbranch_scc0 L_cf_e2
  ds_read_b128 v[64:67], v4 offset:57344
  ds_read_b128 v[68:71], v4 offset:58368
  ds_read_b128 v[72:75], v5 offset:0
L_cf_e2:
  s_xor_b32 s52, s59, 0x2000
  s_xor_b32 s55, s55, 0x2000
  s_add_u32 s54, s54, 1
  s_add_u32 s62, s62, s15
  s_mov_b32 s15, 0x8000
  s_add_u32 s60, s60, 0x8000
  s_add_u32 s61, s61, 0x8000
  s_xor_b32 m0, m0, 24576
  s_xor_b32 s14, s14, 24576
  ds_read_b128 v[76:79], v5 offset:1024
  s_waitcnt lgkmcnt(0)
  buffer_load_dwordx4 v[96:99], v1, s[4:7], s58 offen sc1
  buffer_load_dwordx4 v[100:103], v1, s[4:7], s58 offen offset:1024 sc1
  v_mov_b64 v[120:121], 0
  v_mov_b64 v[122:123], 0
  v_mov_b64 v[124:125], 0
  v_mov_b64 v[126:127], 0
  v_mov_b64 v[128:129], 0
  v_mov_b64 v[130:131], 0
L_cf_pp:
  s_waitcnt vmcnt(2)
  v_smfmac_f32_16x16x64_bf16 v[104:107], v[12:15], v[112:119], v11
  v_bitop3_b32 v0, v112, v116, s82 bitop3:0x7e
  v_and_b32 v0, 1, v0
  v_cmp_ne_u32 vcc, 0, v0
  s_cbranch_vccnz L_cf_pp_retry
L_cf_pp_join:
  s_xor_b32 s82, s82, 1
  s_nop 2
  v_add_f32_dpp v104, v104, v104 row_ror:4 row_mask:0xf bank_mask:0xf
  v_add_f32_dpp v105, v105, v105 row_ror:4 row_mask:0xf bank_mask:0xf
  s_nop 0
  v_add_f32_dpp v104, v104, v104 row_ror:8 row_mask:0xf bank_mask:0xf
  v_add_f32_dpp v105, v105, v105 row_ror:8 row_mask:0xf bank_mask:0xf
  s_mov_b64 exec, s[46:47]
  v_cvt_pk_bf16_f32 v104, v104, v105
  v_min_u32 v104, -2, v104
  buffer_store_dword v104, v10, s[4:7], s52 offen
  buffer_store_dword v108, v10, s[4:7], s59 offen
  s_mov_b64 exec, -1
  s_mov_b32 s59, s52
  s_barrier
  s_cmp_lg_u32 s54, s83
  s_cbranch_scc1 L_cf_step
  s_branch L_cf_special
L_cs_pm0_loop:
  s_mov_b64 exec, vcc
  buffer_load_dwordx4 v[112:115], v0, s[4:7], s55 offen sc1
  buffer_load_dwordx4 v[116:119], v0, s[4:7], s55 offen offset:1024 sc1
  s_mov_b64 exec, -1
  s_waitcnt vmcnt(2)
  v_cmp_eq_u32 vcc, -1, v104
  v_cmp_eq_u32 s[50:51], -1, v108
  s_or_b64 vcc, vcc, s[50:51]
  s_cbranch_scc1 L_cs_pm0_b
  ds_write_b128 v3, v[104:107] offset:0
  ds_write_b128 v3, v[108:111] offset:1024
  s_branch L_cs_pm0_go
L_cs_pm0_retry:
  s_mov_b64 vcc, -1
L_cs_pm0_b:
  s_mov_b64 exec, vcc
  buffer_load_dwordx4 v[104:107], v3, s[4:7], s55 offen sc1
  buffer_load_dwordx4 v[108:111], v3, s[4:7], s55 offen offset:1024 sc1
  s_mov_b64 exec, -1
  s_waitcnt vmcnt(2)
  v_cmp_eq_u32 vcc, -1, v112
  v_cmp_eq_u32 s[50:51], -1, v116
  s_or_b64 vcc, vcc, s[50:51]
  s_cbranch_scc0 L_cs_pm0_bok
  s_add_u32 s66, s66, 1
  s_cmp_lt_u32 s66, 0x400000
  s_cbranch_scc1 L_cs_pm0_loop
  s_branch L_end
L_cs_pm0_bok:
L_cs_pm0_bok2:
  ds_write_b128 v0, v[112:115] offset:0
  ds_write_b128 v0, v[116:119] offset:1024
  v_mov_b32_dpp v104, v112 row_ror:8 row_mask:0xf bank_mask:0xf
  v_mov_b32_dpp v105, v113 row_ror:8 row_mask:0xf bank_mask:0xf
  v_mov_b32_dpp v106, v114 row_ror:8 row_mask:0xf bank_mask:0xf
  v_mov_b32_dpp v107, v115 row_ror:8 row_mask:0xf bank_mask:0xf
  v_mov_b32_dpp v108, v116 row_ror:8 row_mask:0xf bank_mask:0xf
  v_mov_b32_dpp v109, v117 row_ror:8 row_mask:0xf bank_mask:0xf
  v_mov_b32_dpp v110, v118 row_ror:8 row_mask:0xf bank_mask:0xf
  v_mov_b32_dpp v111, v119 row_ror:8 row_mask:0xf bank_mask:0xf
L_cs_pm0_go:
  v_smfmac_f32_16x16x64_bf16 v[128:131], v[104:107], v[24:31], v11
  v_smfmac_f32_16x16x64_bf16 v[124:127], v[104:107], v[32:39], v11
  v_smfmac_f32_16x16x64_bf16 v[120:123], v[104:107], v[40:47], v11
  s_branch L_cs_pm1_join
L_cs_pm1_first:
L_cs_pm1_retry:
  s_mov_b64 exec, vcc
  buffer_load_dwordx4 v[108:111], v3, s[4:7], s55 offen offset:1024 sc1
  s_mov_b64 exec, -1
  s_waitcnt vmcnt(1)
  v_cmp_eq_u32 vcc, -1, v116
  s_cbranch_vccnz L_cs_pm1_again
L_cs_pm1_tw:
  ds_write_b128 v0, v[116:119] offset:1024
  v_mov_b32_dpp v108, v116 row_ror:8 row_mask:0xf bank_mask:0xf
  v_mov_b32_dpp v109, v117 row_ror:8 row_mask:0xf bank_mask:0xf
  v_mov_b32_dpp v110, v118 row_ror:8 row_mask:0xf bank_mask:0xf
  v_mov_b32_dpp v111, v119 row_ror:8 row_mask:0xf bank_mask:0xf
  s_nop 0
  s_branch L_cs_pm1_join
L_cs_pm1_again:
  s_mov_b64 exec, vcc
  buffer_load_dwordx4 v[116:119], v0, s[4:7], s55 offen offset:1024 sc1
  s_mov_b64 exec, -1
  s_waitcnt vmcnt(1)
  v_cmp_eq_u32 vcc, -1, v108
  s_cbranch_vccnz L_cs_pm1_more
  ds_write_b128 v3, v[108:111] offset:1024
  s_branch L_cs_pm1_join
L_cs_pm1_more:
  s_add_u32 s66, s66, 1
  s_cmp_lt_u32 s66, 0x400000
  s_cbranch_scc1 L_cs_pm1_retry
  s_branch L_end
L_cs_pp_retry:
  s_mov_b64 exec, vcc
  buffer_load_dwordx4 v[112:115], v1, s[4:7], s58 offen sc1
  buffer_load_dwordx4 v[116:119], v1, s[4:7], s58 offen offset:1024 sc1
  s_mov_b64 exec, -1
  s_nop 3
  v_mov_b64 v[104:105], 0
  v_mov_b64 v[106:107], 0
  s_waitcnt vmcnt(2)
  s_nop 0
  v_smfmac_f32_16x16x64_bf16 v[104:107], v[12:15], v[96:103], v11
  v_bitop3_b32 v0, v96, v100, s82 bitop3:0x7e
  v_and_b32 v0, 1, v0
  v_cmp_ne_u32 vcc, 0, v0
  s_cbranch_vccz L_cs_pp_join
  s_mov_b64 exec, vcc
  buffer_load_dwordx4 v[96:99], v1, s[4:7], s58 offen sc1
  buffer_load_dwordx4 v[100:103], v1, s[4:7], s58 offen offset:1024 sc1
  s_mov_b64 exec, -1
  s_nop 3
  v_mov_b64 v[104:105], 0
  v_mov_b64 v[106:107], 0
  s_add_u32 s66, s66, 1
  s_cmp_lt_u32 s66, 0x400000
  s_cbranch_scc1 L_cs_pp
  s_branch L_end
L_cs_special:
  s_waitcnt vmcnt(2)
  s_cmp_eq_u32 s54, 63
  s_cbranch_scc1 L_c_last
  v_bfe_u32 v105, v1, 4, 2
  v_lshlrev_b32 v105, 7, v105
  buffer_load_dword v104, v105, s[4:7], s63 offen sc1
  s_add_u32 s53, s54, 1
  s_waitcnt vmcnt(0)
  s_mov_b32 s66, 0
L_cs_gw:
  v_readlane_b32 s52, v104, 0
  v_readlane_b32 s83, v104, 1
  s_min_u32 s52, s52, s83
  v_readlane_b32 s83, v104, 2
  s_min_u32 s52, s52, s83
  v_readlane_b32 s83, v104, 3
  s_min_u32 s52, s52, s83
  s_lshl_b32 s52, s52, 1
  s_cmp_gt_u32 s52, s53
  s_cbranch_scc1 L_cs_gw_ok
  s_sleep 2
  buffer_load_dword v104, v105, s[4:7], s63 offen sc1
  s_waitcnt vmcnt(0)
  s_add_u32 s66, s66, 1
  s_cmp_lt_u32 s66, 0x400000
  s_cbranch_scc1 L_cs_gw
  s_branch L_end
L_cs_gw_ok:
  s_and_b32 s83, s52, -8
  s_cmp_gt_u32 s83, s53
  s_cselect_b32 s83, s83, s52
  s_sub_u32 s83, s83, 1
  s_mov_b32 s66, 0
  s_branch L_cs_step
.p2align 6
L_cs_step:
  v_xor_b32 v0, 128, v3
  ds_read_b128 v[80:83], v5 offset:8192
  s_waitcnt lgkmcnt(0)
  buffer_load_dwordx4 v[104:107], v3, s[4:7], s55 offen offset:0 sc1
  ds_read_b128 v[84:87], v5 offset:9216
  s_waitcnt lgkmcnt(0)
  buffer_load_dwordx4 v[108:111], v3, s[4:7], s55 offen offset:1024 sc1
  s_waitcnt vmcnt(4)
  ds_read_b128 v[88:91], v5 offset:16384
  ds_read_b128 v[92:95], v5 offset:17408
  ds_read_b128 v[96:99], v5 offset:24576
  ds_read_b128 v[100:103], v5 offset:25600
  s_waitcnt lgkmcnt(0)
  buffer_load_dwordx4 v[112:115], v0, s[4:7], s55 offen offset:0 sc1
  buffer_load_dwordx4 v[116:119], v0, s[4:7], s55 offen offset:1024 sc1
  s_waitcnt vmcnt(3) lgkmcnt(6)
  ds_write_b128 v3, v[104:107] offset:0
  v_cmp_eq_u32 vcc, -1, v104
  s_cbranch_vccnz L_cs_pm0_retry
  v_smfmac_f32_16x16x64_bf16 v[128:131], v[104:107], v[24:31], v11
  v_smfmac_f32_16x16x64_bf16 v[124:127], v[104:107], v[32:39], v11
  v_smfmac_f32_16x16x64_bf16 v[120:123], v[104:107], v[40:47], v11
  s_waitcnt vmcnt(2)
  ds_write_b128 v3, v[108:111] offset:1024
  v_cmp_eq_u32 vcc, -1, v108
  s_cbranch_vccnz L_cs_pm1_first
L_cs_pm1_join:
  v_smfmac_f32_16x16x64_bf16 v[128:131], v[108:111], v[48:55], v11
  v_xor_b32 v0, 2048, v3
  v_smfmac_f32_16x16x64_bf16 v[124:127], v[108:111], v[56:63], v11
  v_smfmac_f32_16x16x64_bf16 v[120:123], v[108:111], v[64:71], v11
  s_waitcnt lgkmcnt(0)
  s_barrier
  ds_read_b128 v[24:27], v0 offset:0
  ds_read_b128 v[28:31], v0 offset:1024
  s_waitcnt vmcnt(0)
  v_smfmac_f32_16x16x64_bf16 v[128:131], v[112:115], v[72:79], v11
  buffer_load_dwordx4 v[16:19], v3, s[4:7], s61 offen sc1
  v_smfmac_f32_16x16x64_bf16 v[124:127], v[112:115], v[80:87], v11
  v_xor_b32 v0, 2176, v3
  v_smfmac_f32_16x16x64_bf16 v[120:123], v[112:115], v[88:95], v11
  ds_read_b128 v[32:35], v0 offset:0
  v_smfmac_f32_16x16x64_bf16 v[128:131], v[116:119], v[96:103], v11
  buffer_load_dwordx4 v[20:23], v3, s[4:7], s61 offen offset:1024 sc1
  v_smfmac_f32_16x16x64_bf16 v[124:127], v[116:119], a[0:7], v11
  ds_read_b128 v[36:39], v0 offset:1024
  v_smfmac_f32_16x16x64_bf16 v[120:123], v[116:119], a[8:15], v11
  v_xor_b32 v0, 4096, v3
  s_waitcnt lgkmcnt(2)
  v_smfmac_f32_16x16x64_bf16 v[128:131], v[24:27], a[16:23], v11
  buffer_load_dwordx4 v3, s[4:7], s60 offen sc1 lds
  v_smfmac_f32_16x16x64_bf16 v[124:127], v[24:27], a[24:31], v11
  ds_read_b128 v[40:43], v0 offset:0
  v_smfmac_f32_16x16x64_bf16 v[128:131], v[28:31], a[32:39], v11
  ds_read_b128 v[44:47], v0 offset:1024
  v_smfmac_f32_16x16x64_bf16 v[124:127], v[28:31], a[40:47], v11
  buffer_load_dwordx4 v3, s[4:7], s60 offen offset:1024 sc1 lds
  s_waitcnt lgkmcnt(2)
  v_smfmac_f32_16x16x64_bf16 v[128:131], v[32:35], a[48:55], v11
  v_xor_b32 v0, 4224, v3
  v_smfmac_f32_16x16x64_bf16 v[124:127], v[32:35], a[56:63], v11
  ds_read_b128 v[48:51], v0 offset:0
  v_smfmac_f32_16x16x64_bf16 v[128:131], v[36:39], a[64:71], v11
  buffer_store_dwordx4 v[132:135], v1, s[4:7], s62 offen sc1
  v_smfmac_f32_16x16x64_bf16 v[124:127], v[36:39], a[72:79], v11
  ds_read_b128 v[52:55], v0 offset:1024
  s_waitcnt lgkmcnt(2)
  v_smfmac_f32_16x16x64_bf16 v[128:131], v[40:43], a[80:87], v11
  v_xor_b32 v0, 6144, v3
  v_smfmac_f32_16x16x64_bf16 v[124:127], v[40:43], a[88:95], v11
  ds_read_b128 v[56:59], v0 offset:0
  v_smfmac_f32_16x16x64_bf16 v[128:131], v[44:47], a[96:103], v11
  ds_read_b128 v[60:63], v0 offset:1024
  v_smfmac_f32_16x16x64_bf16 v[124:127], v[44:47], a[104:111], v11
  v_xor_b32 v0, 6272, v3
  s_waitcnt lgkmcnt(2)
  v_smfmac_f32_16x16x64_bf16 v[128:131], v[48:51], a[112:119], v11
  ds_read_b128 v[64:67], v0 offset:0
  v_smfmac_f32_16x16x64_bf16 v[124:127], v[48:51], a[120:127], v11
  ds_read_b128 v[68:71], v0 offset:1024
  v_smfmac_f32_16x16x64_bf16 v[128:131], v[52:55], a[128:135], v11
  v_add_u32 v0, s14, v1
  v_smfmac_f32_16x16x64_bf16 v[124:127], v[52:55], a[136:143], v11
  ds_read_b128 v[72:75], v0 offset:0
  s_waitcnt lgkmcnt(3)
  v_smfmac_f32_16x16x64_bf16 v[128:131], v[56:59], a[144:151], v11
  ds_read_b128 v[76:79], v0 offset:4096
  v_smfmac_f32_16x16x64_bf16 v[124:127], v[56:59], a[152:159], v11
  ds_read_b128 v[80:83], v0 offset:1024
  v_smfmac_f32_16x16x64_bf16 v[128:131], v[60:63], a[160:167], v11
  ds_read_b128 v[84:87], v0 offset:5120
  v_smfmac_f32_16x16x64_bf16 v[124:127], v[60:63], a[168:175], v11
  ds_read_b128 v[88:91], v0 offset:2048
  s_waitcnt lgkmcnt(5)
  v_smfmac_f32_16x16x64_bf16 v[128:131], v[64:67], a[176:183], v11
  ds_read_b128 v[92:95], v0 offset:6144
  v_smfmac_f32_16x16x64_bf16 v[124:127], v[64:67], a[184:191], v11
  ds_read_b128 v[96:99], v0 offset:3072
  v_smfmac_f32_16x16x64_bf16 v[128:131], v[68:71], a[192:199], v11
  ds_read_b128 v[100:103], v0 offset:7168
  v_smfmac_f32_16x16x64_bf16 v[124:127], v[68:71], a[200:207], v11
  v_smfmac_f32_16x16x64_bf16 v[120:123], v[24:27], a[208:215], v11
  s_barrier
  v_smfmac_f32_16x16x64_bf16 v[120:123], v[28:31], a[216:223], v11
  s_nop 0
  v_smfmac_f32_16x16x64_bf16 v[120:123], v[32:35], a[224:231], v11
  s_nop 0
  v_cvt_pk_bf16_f32 v131, v130, v131
  v_cvt_pk_bf16_f32 v130, v128, v129
  v_cvt_pk_bf16_f32 v132, v124, v125
  v_cvt_pk_bf16_f32 v133, v126, v127
  ds_write_b128 v6, v[130:133] offset:0
  v_smfmac_f32_16x16x64_bf16 v[120:123], v[36:39], a[232:239], v11
  v_smfmac_f32_16x16x64_bf16 v[120:123], v[40:43], a[240:247], v11
  v_smfmac_f32_16x16x64_bf16 v[120:123], v[44:47], a[248:255], v11
  v_smfmac_f32_16x16x64_bf16 v[120:123], v[48:51], v[136:143], v11
  v_smfmac_f32_16x16x64_bf16 v[120:123], v[52:55], v[144:151], v11
  s_waitcnt lgkmcnt(0)
  s_barrier
  ds_read_b64_tr_b16 v[104:105], v2 offset:0
  ds_read_b64_tr_b16 v[106:107], v2 offset:512
  v_smfmac_f32_16x16x64_bf16 v[120:123], v[56:59], v[152:159], v11
  ds_read_b64_tr_b16 v[108:109], v2 offset:1024
  ds_read_b64_tr_b16 v[110:111], v2 offset:1536
  v_smfmac_f32_16x16x64_bf16 v[120:123], v[60:63], v[160:167], v11
  ds_read_b64_tr_b16 v[112:113], v2 offset:2048
  ds_read_b64_tr_b16 v[114:115], v2 offset:2560
  v_smfmac_f32_16x16x64_bf16 v[120:123], v[64:67], v[168:175], v11
  ds_read_b64_tr_b16 v[116:117], v2 offset:3072
  ds_read_b64_tr_b16 v[118:119], v2 offset:3584
  v_smfmac_f32_16x16x64_bf16 v[120:123], v[68:71], v[176:183], v11
  s_waitcnt lgkmcnt(4)
  v_mfma_f32_16x16x32_bf16 v[24:27], v[72:75], v[104:107], 0
  v_mov_b32 v129, 0
  v_mov_b32 v130, 0
  v_mfma_f32_16x16x32_bf16 v[28:31], v[76:79], v[104:107], 0
  ds_read_b128 v[40:43], v3 offset:24576
  v_min_u32 v132, -2, v132
  v_mfma_f32_16x16x32_bf16 v[24:27], v[80:83], v[108:111], v[24:27]
  ds_read_b128 v[44:47], v3 offset:25600
  v_mfma_f32_16x16x32_bf16 v[28:31], v[84:87], v[108:111], v[28:31]
  ds_read_b128 v[48:51], v3 offset:32768
  s_waitcnt lgkmcnt(3)
  v_mfma_f32_16x16x32_bf16 v[24:27], v[88:91], v[112:115], v[24:27]
  ds_read_b128 v[52:55], v3 offset:33792
  v_cvt_pk_bf16_f32 v134, v120, v121
  v_mfma_f32_16x16x32_bf16 v[28:31], v[92:95], v[112:115], v[28:31]
  ds_read_b128 v[56:59], v3 offset:40960
  v_cvt_pk_bf16_f32 v36, v122, v123
  v_mfma_f32_16x16x32_bf16 v[24:27], v[96:99], v[116:119], v[24:27]
  ds_read_b128 v[60:63], v3 offset:41984
  v_cvt_pk_bf16_f32 v37, v121, v120
  v_mfma_f32_16x16x32_bf16 v[28:31], v[100:103], v[116:119], v[28:31]
  ds_read_b128 v[64:67], v3 offset:49152
  v_cvt_pk_bf16_f32 v135, v123, v122
  v_mfma_f32_16x16x32_bf16 v[32:35], v[104:107], v[104:107], 0
  v_permlane32_swap_b32 v134, v36
  v_mfma_f32_16x16x32_bf16 v[32:35], v[108:111], v[108:111], v[32:35]
  v_permlane32_swap_b32 v37, v135
  v_mfma_f32_16x16x32_bf16 v[32:35], v[112:115], v[112:115], v[32:35]
  ds_read_b128 v[68:71], v3 offset:50176
  v_mov_b32_dpp v24, v28 row_ror:8 row_mask:0xf bank_mask:0xc
  v_mfma_f32_16x16x32_bf16 v[32:35], v[116:119], v[116:119], v[32:35]
  v_mov_b32_dpp v25, v29 row_ror:8 row_mask:0xf bank_mask:0xc
  v_mov_b32_dpp v26, v30 row_ror:8 row_mask:0xf bank_mask:0xc
  v_mov_b32_dpp v27, v31 row_ror:8 row_mask:0xf bank_mask:0xc
  ds_read_b128 v[72:75], v3 offset:57344
  v_max3_f32 v38, v24, v25, v26
  v_mov_b64 v[104:105], 0
  v_mov_b64 v[106:107], 0
  ds_read_b128 v[76:79], v3 offset:58368
  v_mov_b32_dpp v32, v33 row_ror:8 row_mask:0xf bank_mask:0xc
  v_mov_b32_dpp v34, v35 row_ror:8 row_mask:0xf bank_mask:0xc
  v_mov_b64 v[110:111], 0
  v_mov_b64 v[112:113], 0
  v_permlane32_swap_b32 v32, v34
  v_max3_f32 v38, v38, v27, v34
  v_mov_b64 v[114:115], 0
  v_mov_b64 v[116:117], 0
  v_max_f32_dpp v28, v38, v38 row_ror:8 row_mask:0xf bank_mask:0xf
  v_max_f32_dpp v29, v38, v38 row_ror:8 row_mask:0xf bank_mask:0xf
  v_mov_b64 v[118:119], 0
  v_and_b32 v0, -9, v8
  v_permlane32_swap_b32 v28, v29
  v_max_f32 v30, v28, v29
  v_max_f32 v31, v28, v29
  v_xor_b32 v121, 512, v0
  v_xor_b32 v122, 1024, v0
  v_permlane16_swap_b32 v30, v31
  v_max_f32 v28, v30, v31
  v_mul_f32 v39, s65, v28
  v_fma_f32 v24, v24, s64, v39
  v_fma_f32 v25, v25, s64, v39
  v_fma_f32 v26, v26, s64, v39
  v_fma_f32 v27, v27, s64, v39
  v_fma_f32 v34, v34, s64, v39
  v_exp_f32 v24, v24
  v_exp_f32 v25, v25
  v_exp_f32 v26, v26
  v_exp_f32 v27, v27
  v_exp_f32 v34, v34
  v_cvt_pk_bf16_f32 v124, v24, v25
  v_cvt_pk_bf16_f32 v125, v26, v27
  v_mov_b32_dpp v28, v34 row_ror:8 row_mask:0xf bank_mask:0xf
  v_mov_b32_dpp v126, v124 row_ror:8 row_mask:0xf bank_mask:0xf
  v_mov_b32_dpp v127, v125 row_ror:8 row_mask:0xf bank_mask:0xf
  v_cvt_pk_bf16_f32 v128, v34, v28
  v_cvt_pk_bf16_f32 v131, v34, v28
  s_waitcnt vmcnt(3)
  v_mfma_f32_16x16x32_bf16 v[96:99], v[16:19], v[124:127], 0
  v_add_f32 v36, v24, v25
  v_add_f32 v39, v26, v27
  v_mfma_f32_16x16x32_bf16 v[100:103], v[20:23], v[124:127], 0
  v_add_f32 v36, v36, v34
  v_add_f32 v36, v36, v39
  v_mfma_f32_16x16x16_bf16 v[96:99], v[134:135], v[128:129], v[96:99]
  ds_read_b128 v[80:83], v4 offset:0
  v_add_f32_dpp v28, v36, v36 row_ror:8 row_mask:0xf bank_mask:0xf
  v_add_f32_dpp v29, v36, v36 row_ror:8 row_mask:0xf bank_mask:0xf
  v_mfma_f32_16x16x16_bf16 v[100:103], v[134:135], v[130:131], v[100:103]
  ds_read_b128 v[84:87], v4 offset:1024
  v_permlane32_swap_b32 v28, v29
  v_add_f32 v30, v28, v29
  v_add_f32 v31, v28, v29
  ds_read_b128 v[88:91], v4 offset:8192
  ds_read_b128 v[92:95], v4 offset:9216
  v_permlane16_swap_b32 v30, v31
  v_add_f32 v31, v30, v31
  v_rcp_f32 v31, v31
  v_mov_b32_dpp v96, v100 quad_perm:[0,1,2,3] row_mask:0xf bank_mask:0xc
  v_mov_b32_dpp v97, v101 quad_perm:[0,1,2,3] row_mask:0xf bank_mask:0xc
  v_mov_b32_dpp v98, v102 quad_perm:[0,1,2,3] row_mask:0xf bank_mask:0xc
  v_mov_b32_dpp v99, v103 quad_perm:[0,1,2,3] row_mask:0xf bank_mask:0xc
  v_mul_f32 v96, v96, v31
  v_mul_f32 v97, v97, v31
  v_mul_f32 v98, v98, v31
  v_mul_f32 v99, v99, v31
  v_cvt_pk_bf16_f32 v124, v96, v97
  v_cvt_pk_bf16_f32 v125, v98, v99
  ds_write_b64 v8, v[124:125] offset:4096
  v_mov_b64 v[24:25], v[124:125]
  v_mov_b64 v[26:27], v[124:125]
  v_xor_b32 v123, 1536, v0
  v_mov_b32_dpp v24, v124 row_ror:8 row_mask:0xf bank_mask:0xc
  v_mov_b32_dpp v26, v124 row_ror:8 row_mask:0xf bank_mask:0x3
  v_mov_b32_dpp v25, v125 row_ror:8 row_mask:0xf bank_mask:0xc
  v_mov_b32_dpp v27, v125 row_ror:8 row_mask:0xf bank_mask:0x3
  v_mov_b64 v[108:109], 0
  s_nop 0
  v_smfmac_f32_16x16x64_bf16 v[104:107], v[24:27], v[184:191], v11
  v_smfmac_f32_16x16x64_bf16 v[108:111], v[24:27], v[192:199], v11
  v_smfmac_f32_16x16x64_bf16 v[112:115], v[24:27], v[200:207], v11
  s_waitcnt lgkmcnt(0)
  s_barrier
  ds_read_b128 v[28:31], v121 offset:4096
  ds_read_b128 v[32:35], v122 offset:4096
  ds_read_b128 v[36:39], v123 offset:4096
  v_smfmac_f32_16x16x64_bf16 v[116:119], v[24:27], v[208:215], v11
  s_waitcnt lgkmcnt(2)
  v_smfmac_f32_16x16x64_bf16 v[104:107], v[28:31], v[216:223], v11
  s_waitcnt lgkmcnt(1)
  v_smfmac_f32_16x16x64_bf16 v[104:107], v[32:35], v[224:231], v11
  s_waitcnt lgkmcnt(0)
  v_smfmac_f32_16x16x64_bf16 v[104:107], v[36:39], v[232:239], v11
  v_smfmac_f32_16x16x64_bf16 v[108:111], v[28:31], v[240:247], v11
  s_nop 1
  v_smfmac_f32_16x16x64_bf16 v[108:111], v[32:35], v[248:255], v11
  s_nop 1
  v_smfmac_f32_16x16x64_bf16 v[108:111], v[36:39], v[40:47], v11
  s_nop 0
  v_cvt_pk_bf16_f32 v104, v104, v105
  v_smfmac_f32_16x16x64_bf16 v[112:115], v[28:31], v[48:55], v11
  v_cvt_pk_bf16_f32 v105, v106, v107
  v_bfi_b32 v104, v7, s82, v104
  buffer_store_dwordx2 v[104:105], v9, s[4:7], s56 offen sc1
  v_smfmac_f32_16x16x64_bf16 v[112:115], v[32:35], v[56:63], v11
  s_nop 0
  v_smfmac_f32_16x16x64_bf16 v[112:115], v[36:39], v[64:71], v11
  v_cvt_pk_bf16_f32 v108, v108, v109
  s_nop 0
  v_smfmac_f32_16x16x64_bf16 v[116:119], v[28:31], v[72:79], v11
  v_cvt_pk_bf16_f32 v109, v110, v111
  v_bfi_b32 v108, v7, s82, v108
  buffer_store_dwordx2 v[108:109], v9, s[4:7], s48 offen sc1
  v_smfmac_f32_16x16x64_bf16 v[116:119], v[32:35], v[80:87], v11
  s_nop 0
  v_smfmac_f32_16x16x64_bf16 v[116:119], v[36:39], v[88:95], v11
  v_cvt_pk_bf16_f32 v112, v112, v113
  v_cvt_pk_bf16_f32 v113, v114, v115
  v_bfi_b32 v112, v7, s82, v112
  buffer_store_dwordx2 v[112:113], v9, s[4:7], s57 offen sc1
  v_mov_b64 v[104:105], 0
  v_mov_b64 v[106:107], 0
  v_mov_b32 v108, -1
  s_cmp_lt_u32 s3, 2
  v_cvt_pk_bf16_f32 v116, v116, v117
  v_cvt_pk_bf16_f32 v117, v118, v119
  v_bfi_b32 v116, v7, s82, v116
  buffer_store_dwordx2 v[116:117], v9, s[4:7], s49 offen sc1
  s_mov_b32 s66, 0
  ds_read_b128 v[24:27], v4 offset:16384
  ds_read_b128 v[28:31], v4 offset:17408
  ds_read_b128 v[32:35], v4 offset:24576
  ds_read_b128 v[36:39], v4 offset:25600
  ds_read_b128 v[40:43], v4 offset:32768
  ds_read_b128 v[44:47], v4 offset:33792
  ds_read_b128 v[48:51], v4 offset:40960
  ds_read_b128 v[52:55], v4 offset:41984
  ds_read_b128 v[56:59], v4 offset:49152
  ds_read_b128 v[60:63], v4 offset:50176
  s_cbranch_scc1 L_cs_e1
  ds_read_b128 v[64:67], v4 offset:57344
  ds_read_b128 v[68:71], v4 offset:58368
  ds_read_b128 v[72:75], v5 offset:0
  s_waitcnt lgkmcnt(0)
L_cs_e1:
  buffer_load_dwordx4 v[112:115], v1, s[4:7], s58 offen sc1
  buffer_load_dwordx4 v[116:119], v1, s[4:7], s58 offen offset:1024 sc1
  s_cbranch_scc0 L_cs_e2
  ds_read_b128 v[64:67], v4 offset:57344
  ds_read_b128 v[68:71], v4 offset:58368
  ds_read_b128 v[72:75], v5 offset:0
L_cs_e2:
  s_xor_b32 s52, s59, 0x2000
  s_xor_b32 s55, s55, 0x2000
  s_add_u32 s54, s54, 1
  s_add_u32 s62, s62, s15
  s_mov_b32 s15, 0x8000
  s_add_u32 s60, s60, 0x8000
  s_add_u32 s61, s61, 0x8000
  s_xor_b32 m0, m0, 24576
  s_xor_b32 s14, s14, 24576
  ds_read_b128 v[76:79], v5 offset:1024
  s_waitcnt lgkmcnt(0)
  buffer_load_dwordx4 v[96:99], v1, s[4:7], s58 offen sc1
  buffer_load_dwordx4 v[100:103], v1, s[4:7], s58 offen offset:1024 sc1
  v_mov_b64 v[120:121], 0
  v_mov_b64 v[122:123], 0
  v_mov_b64 v[124:125], 0
  v_mov_b64 v[126:127], 0
  v_mov_b64 v[128:129], 0
  v_mov_b64 v[130:131], 0
L_cs_pp:
  s_waitcnt vmcnt(2)
  v_smfmac_f32_16x16x64_bf16 v[104:107], v[12:15], v[112:119], v11
  v_bitop3_b32 v0, v112, v116, s82 bitop3:0x7e
  v_and_b32 v0, 1, v0
  v_cmp_ne_u32 vcc, 0, v0
  s_cbranch_vccnz L_cs_pp_retry
L_cs_pp_join:
  s_xor_b32 s82, s82, 1
  s_nop 2
  v_add_f32_dpp v104, v104, v104 row_ror:4 row_mask:0xf bank_mask:0xf
  v_add_f32_dpp v105, v105, v105 row_ror:4 row_mask:0xf bank_mask:0xf
  s_nop 0
  v_add_f32_dpp v104, v104, v104 row_ror:8 row_mask:0xf bank_mask:0xf
  v_add_f32_dpp v105, v105, v105 row_ror:8 row_mask:0xf bank_mask:0xf
  s_mov_b64 exec, s[46:47]
  v_cvt_pk_bf16_f32 v104, v104, v105
  v_min_u32 v104, -2, v104
  buffer_store_dword v104, v10, s[4:7], s52 offen sc1
  buffer_store_dword v108, v10, s[4:7], s59 offen sc1
  s_mov_b64 exec, -1
  s_mov_b32 s59, s52
  s_barrier
  s_cmp_lg_u32 s54, s83
  s_cbranch_scc1 L_cs_step
  s_branch L_cs_special
L_c_last:
  s_cmp_eq_u32 0, 1
  ds_read_b128 v[80:83], v5 offset:8192
  ds_read_b128 v[84:87], v5 offset:9216
  ds_read_b128 v[88:91], v5 offset:16384
  ds_read_b128 v[92:95], v5 offset:17408
  ds_read_b128 v[96:99], v5 offset:24576
  ds_read_b128 v[100:103], v5 offset:25600
  s_waitcnt lgkmcnt(0)
L_c_lp:
  buffer_load_dwordx4 v[104:107], v3, s[4:7], s55 offen offset:0 sc1
  buffer_load_dwordx4 v[108:111], v3, s[4:7], s55 offen offset:1024 sc1
  s_waitcnt vmcnt(0)
  v_max_u32 v0, v104, v108
  v_cmp_eq_u32 vcc, -1, v0
  s_cbranch_vccz L_c_lok
  s_add_u32 s66, s66, 1
  s_cmp_lt_u32 s66, 0x400000
  s_cbranch_scc1 L_c_lp
  s_branch L_end
L_c_lok:
  s_cmp_eq_u32 0, 1
  ds_write_b128 v3, v[104:107] offset:0
  ds_write_b128 v3, v[108:111] offset:1024
  v_mov_b32_dpp v112, v104 row_ror:8 row_mask:0xf bank_mask:0xf
  v_mov_b32_dpp v113, v105 row_ror:8 row_mask:0xf bank_mask:0xf
  v_mov_b32_dpp v114, v106 row_ror:8 row_mask:0xf bank_mask:0xf
  v_mov_b32_dpp v115, v107 row_ror:8 row_mask:0xf bank_mask:0xf
  v_mov_b32_dpp v116, v108 row_ror:8 row_mask:0xf bank_mask:0xf
  v_mov_b32_dpp v117, v109 row_ror:8 row_mask:0xf bank_mask:0xf
  v_mov_b32_dpp v118, v110 row_ror:8 row_mask:0xf bank_mask:0xf
  v_mov_b32_dpp v119, v111 row_ror:8 row_mask:0xf bank_mask:0xf
  s_waitcnt lgkmcnt(2)
  v_smfmac_f32_16x16x64_bf16 v[124:127], v[104:107], v[32:39], v11
  v_smfmac_f32_16x16x64_bf16 v[120:123], v[104:107], v[40:47], v11
  v_smfmac_f32_16x16x64_bf16 v[124:127], v[108:111], v[56:63], v11
  v_smfmac_f32_16x16x64_bf16 v[120:123], v[108:111], v[64:71], v11
  s_waitcnt lgkmcnt(0)
  s_barrier
  v_xor_b32 v0, 2048, v3
  ds_read_b128 v[24:27], v0 offset:0
  ds_read_b128 v[28:31], v0 offset:1024
  v_xor_b32 v0, 2176, v3
  ds_read_b128 v[32:35], v0 offset:0
  ds_read_b128 v[36:39], v0 offset:1024
  v_xor_b32 v0, 4096, v3
  ds_read_b128 v[40:43], v0 offset:0
  ds_read_b128 v[44:47], v0 offset:1024
  v_xor_b32 v0, 4224, v3
  ds_read_b128 v[48:51], v0 offset:0
  ds_read_b128 v[52:55], v0 offset:1024
  v_xor_b32 v0, 6144, v3
  ds_read_b128 v[56:59], v0 offset:0
  ds_read_b128 v[60:63], v0 offset:1024
  v_xor_b32 v0, 6272, v3
  ds_read_b128 v[64:67], v0 offset:0
  ds_read_b128 v[68:71], v0 offset:1024
  buffer_store_dwordx4 v[132:135], v1, s[4:7], s62 offen sc1
  s_add_u32 s62, s62, 0x8000
  v_smfmac_f32_16x16x64_bf16 v[124:127], v[112:115], v[80:87], v11
  v_smfmac_f32_16x16x64_bf16 v[120:123], v[112:115], v[88:95], v11
  v_smfmac_f32_16x16x64_bf16 v[124:127], v[116:119], a[0:7], v11
  v_smfmac_f32_16x16x64_bf16 v[120:123], v[116:119], a[8:15], v11
  s_waitcnt lgkmcnt(11)
  v_smfmac_f32_16x16x64_bf16 v[124:127], v[24:27], a[24:31], v11
  v_smfmac_f32_16x16x64_bf16 v[120:123], v[24:27], a[208:215], v11
  s_waitcnt lgkmcnt(10)
  v_smfmac_f32_16x16x64_bf16 v[124:127], v[28:31], a[40:47], v11
  v_smfmac_f32_16x16x64_bf16 v[120:123], v[28:31], a[216:223], v11
  s_waitcnt lgkmcnt(9)
  v_smfmac_f32_16x16x64_bf16 v[124:127], v[32:35], a[56:63], v11
  v_smfmac_f32_16x16x64_bf16 v[120:123], v[32:35], a[224:231], v11
  s_waitcnt lgkmcnt(8)
  v_smfmac_f32_16x16x64_bf16 v[124:127], v[36:39], a[72:79], v11
  v_smfmac_f32_16x16x64_bf16 v[120:123], v[36:39], a[232:239], v11
  s_waitcnt lgkmcnt(7)
  v_smfmac_f32_16x16x64_bf16 v[124:127], v[40:43], a[88:95], v11
  v_smfmac_f32_16x16x64_bf16 v[120:123], v[40:43], a[240:247], v11
  s_waitcnt lgkmcnt(6)
  v_smfmac_f32_16x16x64_bf16 v[124:127], v[44:47], a[104:111], v11
  v_smfmac_f32_16x16x64_bf16 v[120:123], v[44:47], a[248:255], v11
  s_waitcnt lgkmcnt(5)
  v_smfmac_f32_16x16x64_bf16 v[124:127], v[48:51], a[120:127], v11
  v_smfmac_f32_16x16x64_bf16 v[120:123], v[48:51], v[136:143], v11
  s_waitcnt lgkmcnt(4)
  v_smfmac_f32_16x16x64_bf16 v[124:127], v[52:55], a[136:143], v11
  v_smfmac_f32_16x16x64_bf16 v[120:123], v[52:55], v[144:151], v11
  s_waitcnt lgkmcnt(3)
  v_smfmac_f32_16x16x64_bf16 v[124:127], v[56:59], a[152:159], v11
  v_smfmac_f32_16x16x64_bf16 v[120:123], v[56:59], v[152:159], v11
  s_waitcnt lgkmcnt(2)
  v_smfmac_f32_16x16x64_bf16 v[124:127], v[60:63], a[168:175], v11
  v_smfmac_f32_16x16x64_bf16 v[120:123], v[60:63], v[160:167], v11
  s_waitcnt lgkmcnt(1)
  v_smfmac_f32_16x16x64_bf16 v[124:127], v[64:67], a[184:191], v11
  v_smfmac_f32_16x16x64_bf16 v[120:123], v[64:67], v[168:175], v11
  s_waitcnt lgkmcnt(0)
  v_smfmac_f32_16x16x64_bf16 v[124:127], v[68:71], a[200:207], v11
  v_smfmac_f32_16x16x64_bf16 v[120:123], v[68:71], v[176:183], v11
  s_nop 6
  v_cvt_pk_bf16_f32 v132, v124, v125
  v_cvt_pk_bf16_f32 v133, v126, v127
  v_min_u32 v132, -2, v132
  v_cvt_pk_bf16_f32 v134, v120, v121
  v_cvt_pk_bf16_f32 v36, v122, v123
  v_cvt_pk_bf16_f32 v37, v121, v120
  v_cvt_pk_bf16_f32 v135, v123, v122
  v_permlane32_swap_b32 v134, v36
  s_nop 0
  v_permlane32_swap_b32 v37, v135
  buffer_store_dwordx4 v[132:135], v1, s[4:7], s62 offen sc1
L_c_done:
  s_endpgm
L_work:
  s_sub_u32 s52, s42, 2
  s_lshr_b32 s53, s52, 1
  s_and_b32 s54, s52, 1
  v_lshrrev_b32 v8, 4, v0
  s_and_b32 s55, s3, 2
  s_lshl_b32 s55, s55, 1
  v_or_b32 v9, s55, v8
  v_lshlrev_b32 v9, 1, v9
  v_and_b32 v10, 15, v0
  v_xor_b32 v9, v9, v10
  v_lshlrev_b32 v9, 4, v9
  v_lshl_add_u32 v2, v8, 13, v9
  s_waitcnt lgkmcnt(0)
  s_mov_b32 s4, s40
  s_and_b32 s5, s41, 0xffff
  s_mov_b32 s6, 0x10000000
  s_mov_b32 s7, 0x20000
  s_mov_b32 s8, s38
  s_and_b32 s9, s39, 0xffff
  s_mov_b32 s10, 0x100
  s_mov_b32 s11, 0x20000
  s_cmp_eq_u32 s53, 0
  s_cselect_b32 s64, s28, s30
  s_cselect_b32 s65, s29, s31
  s_mov_b32 s61, 0x4000
  s_cselect_b32 s61, 0x2000, s61
  s_cmp_eq_u32 s53, 2
  s_cselect_b32 s64, s26, s64
  s_cselect_b32 s65, s27, s65
  s_cselect_b32 s61, 0x0, s61
  s_mov_b32 s12, s64
  s_and_b32 s13, s65, 0xffff
  s_mov_b32 s14, 0x400000
  s_mov_b32 s15, 0x20000
  s_mov_b32 s44, s22
  s_and_b32 s45, s23, 0xffff
  s_mov_b32 s46, 0x200000
  s_mov_b32 s47, 0x20000
  v_mov_b32 v6, 0
  s_lshl_b32 s62, s43, 21
  s_lshl_b32 s63, s52, 7
  s_add_u32 s62, s62, s63
  s_add_u32 s62, s62, 0xf000
  s_lshl_b32 s56, s52, 12
  s_add_u32 s56, s56, 0x5101000
  s_lshl_b32 s63, s43, 7
  s_add_u32 s56, s56, s63
  s_cmp_lg_u32 s3, 0
  s_cbranch_scc1 L_pz2
  s_getreg_b32 s63, hwreg(HW_REG_XCC_ID)
  s_and_b32 s63, s63, 15
  v_mov_b32 v7, s63
  buffer_store_dwordx2 v[6:7], v6, s[4:7], s56 offen sc1
  buffer_store_dword v6, v6, s[4:7], s62 offen sc1
L_pz2:
  s_lshl_b32 s55, s43, 8
  s_lshl_b32 s56, s3, 15
  s_add_u32 s55, s55, s56
  s_lshl_b32 m0, s3, 10
  s_nop 0
  buffer_load_dwordx4 v2, s[12:15], s55 offen lds
  s_add_u32 s55, s55, 0x20000
  s_add_u32 m0, m0, 4096
  s_nop 0
  buffer_load_dwordx4 v2, s[12:15], s55 offen lds
  s_add_u32 s55, s55, 0x20000
  s_add_u32 m0, m0, 4096
  s_nop 0
  buffer_load_dwordx4 v2, s[12:15], s55 offen lds
  s_add_u32 s55, s55, 0x20000
  s_add_u32 m0, m0, 4096
  s_nop 0
  buffer_load_dwordx4 v2, s[12:15], s55 offen lds
  s_add_u32 s55, s55, 0x20000
  s_add_u32 m0, m0, 4096
  s_nop 0
  buffer_load_dwordx4 v2, s[12:15], s55 offen lds
  s_add_u32 s55, s55, 0x20000
  s_add_u32 m0, m0, 4096
  s_nop 0
  buffer_load_dwordx4 v2, s[12:15], s55 offen lds
  s_add_u32 s55, s55, 0x20000
  s_add_u32 m0, m0, 4096
  s_nop 0
  buffer_load_dwordx4 v2, s[12:15], s55 offen lds
  s_add_u32 s55, s55, 0x20000
  s_add_u32 m0, m0, 4096
  s_nop 0
  buffer_load_dwordx4 v2, s[12:15], s55 offen lds
  s_add_u32 s55, s55, 0x20000
  s_add_u32 m0, m0, 4096
  s_nop 0
  buffer_load_dwordx4 v2, s[12:15], s55 offen lds
  s_add_u32 s55, s55, 0x20000
  s_add_u32 m0, m0, 4096
  s_nop 0
  buffer_load_dwordx4 v2, s[12:15], s55 offen lds
  s_add_u32 s55, s55, 0x20000
  s_add_u32 m0, m0, 4096
  s_nop 0
  buffer_load_dwordx4 v2, s[12:15], s55 offen lds
  s_add_u32 s55, s55, 0x20000
  s_add_u32 m0, m0, 4096
  s_nop 0
  buffer_load_dwordx4 v2, s[12:15], s55 offen lds
  s_add_u32 s55, s55, 0x20000
  s_add_u32 m0, m0, 4096
  s_nop 0
  buffer_load_dwordx4 v2, s[12:15], s55 offen lds
  s_add_u32 s55, s55, 0x20000
  s_add_u32 m0, m0, 4096
  s_nop 0
  buffer_load_dwordx4 v2, s[12:15], s55 offen lds
  s_add_u32 s55, s55, 0x20000
  s_add_u32 m0, m0, 4096
  s_nop 0
  buffer_load_dwordx4 v2, s[12:15], s55 offen lds
  s_add_u32 s55, s55, 0x20000
  s_add_u32 m0, m0, 4096
  s_nop 0
  buffer_load_dwordx4 v2, s[12:15], s55 offen lds
  s_add_u32 s55, s55, 0x20000
  s_add_u32 m0, m0, 4096
  s_nop 0
  buffer_load_dwordx4 v2, s[12:15], s55 offen lds
  s_add_u32 s55, s55, 0x20000
  s_add_u32 m0, m0, 4096
  s_nop 0
  buffer_load_dwordx4 v2, s[12:15], s55 offen lds
  s_add_u32 s55, s55, 0x20000
  s_add_u32 m0, m0, 4096
  s_nop 0
  buffer_load_dwordx4 v2, s[12:15], s55 offen lds
  s_add_u32 s55, s55, 0x20000
  s_add_u32 m0, m0, 4096
  s_nop 0
  buffer_load_dwordx4 v2, s[12:15], s55 offen lds
  s_add_u32 s55, s55, 0x20000
  s_add_u32 m0, m0, 4096
  s_nop 0
  buffer_load_dwordx4 v2, s[12:15], s55 offen lds
  s_add_u32 s55, s55, 0x20000
  s_add_u32 m0, m0, 4096
  s_nop 0
  buffer_load_dwordx4 v2, s[12:15], s55 offen lds
  s_add_u32 s55, s55, 0x20000
  s_add_u32 m0, m0, 4096
  s_nop 0
  buffer_load_dwordx4 v2, s[12:15], s55 offen lds
  s_add_u32 s55, s55, 0x20000
  s_add_u32 m0, m0, 4096
  s_nop 0
  buffer_load_dwordx4 v2, s[12:15], s55 offen lds
  s_add_u32 s55, s55, 0x20000
  s_add_u32 m0, m0, 4096
  s_nop 0
  buffer_load_dwordx4 v2, s[12:15], s55 offen lds
  s_add_u32 s55, s55, 0x20000
  s_add_u32 m0, m0, 4096
  s_nop 0
  buffer_load_dwordx4 v2, s[12:15], s55 offen lds
  s_add_u32 s55, s55, 0x20000
  s_add_u32 m0, m0, 4096
  s_nop 0
  buffer_load_dwordx4 v2, s[12:15], s55 offen lds
  s_add_u32 s55, s55, 0x20000
  s_add_u32 m0, m0, 4096
  s_nop 0
  buffer_load_dwordx4 v2, s[12:15], s55 offen lds
  s_add_u32 s55, s55, 0x20000
  s_add_u32 m0, m0, 4096
  s_nop 0
  buffer_load_dwordx4 v2, s[12:15], s55 offen lds
  s_add_u32 s55, s55, 0x20000
  s_add_u32 m0, m0, 4096
  s_nop 0
  buffer_load_dwordx4 v2, s[12:15], s55 offen lds
  s_add_u32 s55, s55, 0x20000
  s_add_u32 m0, m0, 4096
  s_nop 0
  buffer_load_dwordx4 v2, s[12:15], s55 offen lds
  s_add_u32 s55, s55, 0x20000
  s_add_u32 m0, m0, 4096
  s_nop 0
  buffer_load_dwordx4 v2, s[12:15], s55 offen lds
  s_add_u32 s55, s55, 0x20000
  s_add_u32 m0, m0, 4096
  v_lshlrev_b32 v1, 4, v0
  v_bfe_u32 v9, v0, 2, 2
  v_lshl_add_u32 v10, v8, 3, v9
  v_lshlrev_b32 v10, 8, v10
  v_and_b32 v8, 1, v8
  v_lshl_or_b32 v9, v8, 2, v9
  v_lshlrev_b32 v9, 1, v9
  v_bfe_u32 v8, v0, 1, 1
  s_lshl_b32 s55, s3, 2
  v_or_b32 v8, s55, v8
  v_xor_b32 v9, v9, v8
  v_lshl_add_u32 v10, v9, 4, v10
  v_and_b32 v8, 1, v0
  v_lshl_add_u32 v12, v8, 3, v10
  v_xor_b32 v14, 32, v12
  v_add_u32 v13, 0x10000, v12
  v_add_u32 v15, 0x10000, v14
  s_lshl_b32 s55, s3, 3
  s_and_b32 s56, s55, 15
  s_lshl_b32 s55, s55, 10
  s_add_u32 s63, s56, 0
  v_xor_b32 v8, s63, v0
  v_lshlrev_b32 v8, 4, v8
  s_add_u32 s63, s55, 0
  v_add_u32 v72, s63, v8
  s_add_u32 s63, s56, 1
  v_xor_b32 v8, s63, v0
  v_lshlrev_b32 v8, 4, v8
  s_add_u32 s63, s55, 0
  v_add_u32 v73, s63, v8
  s_add_u32 s63, s56, 2
  v_xor_b32 v8, s63, v0
  v_lshlrev_b32 v8, 4, v8
  s_add_u32 s63, s55, 0
  v_add_u32 v74, s63, v8
  s_add_u32 s63, s56, 3
  v_xor_b32 v8, s63, v0
  v_lshlrev_b32 v8, 4, v8
  s_add_u32 s63, s55, 0
  v_add_u32 v75, s63, v8
  s_add_u32 s63, s56, 4
  v_xor_b32 v8, s63, v0
  v_lshlrev_b32 v8, 4, v8
  s_add_u32 s63, s55, 4096
  v_add_u32 v76, s63, v8
  s_add_u32 s63, s56, 5
  v_xor_b32 v8, s63, v0
  v_lshlrev_b32 v8, 4, v8
  s_add_u32 s63, s55, 4096
  v_add_u32 v77, s63, v8
  s_add_u32 s63, s56, 6
  v_xor_b32 v8, s63, v0
  v_lshlrev_b32 v8, 4, v8
  s_add_u32 s63, s55, 4096
  v_add_u32 v78, s63, v8
  s_add_u32 s63, s56, 7
  v_xor_b32 v8, s63, v0
  v_lshlrev_b32 v8, 4, v8
  s_add_u32 s63, s55, 4096
  v_add_u32 v79, s63, v8
  v_lshrrev_b32 v8, 4, v0
  v_or_b32 v8, 0, v8
  v_and_b32 v9, 15, v0
  v_xor_b32 v8, v8, v9
  v_lshlrev_b32 v8, 4, v8
  v_lshlrev_b32 v9, 10, v9
  v_add_u32 v80, v8, v9
  v_lshrrev_b32 v8, 4, v0
  v_or_b32 v8, 4, v8
  v_and_b32 v9, 15, v0
  v_xor_b32 v8, v8, v9
  v_lshlrev_b32 v8, 4, v8
  v_lshlrev_b32 v9, 10, v9
  v_add_u32 v81, v8, v9
  v_lshrrev_b32 v8, 4, v0
  v_or_b32 v8, 8, v8
  v_and_b32 v9, 15, v0
  v_xor_b32 v8, v8, v9
  v_lshlrev_b32 v8, 4, v8
  v_lshlrev_b32 v9, 10, v9
  v_add_u32 v82, v8, v9
  v_lshrrev_b32 v8, 4, v0
  v_or_b32 v8, 12, v8
  v_and_b32 v9, 15, v0
  v_xor_b32 v8, v8, v9
  v_lshlrev_b32 v8, 4, v8
  v_lshlrev_b32 v9, 10, v9
  v_add_u32 v83, v8, v9
  s_mov_b32 s68, 0x10000
  s_mov_b32 s69, 32
  s_cmp_eq_u32 s53, 2
  s_cselect_b32 s68, 0x8000, s68
  s_cmp_eq_u32 s52, 4
  s_cselect_b32 s54, 12, s54
  s_cselect_b32 s69, 52, s69
  s_cmp_eq_u32 s52, 5
  s_cselect_b32 s54, 0, s54
  s_cselect_b32 s69, 12, s69
  s_lshl_b32 s58, s54, 15
  s_mov_b32 s59, 0x20000
  s_mov_b32 s60, 0x20000
  s_lshl_b32 s55, s3, 13
  s_add_u32 m0, s59, s55
  s_nop 0
  buffer_load_dwordx4 v72, s[44:47], s58 offen offset:0 lds
  buffer_load_dwordx4 v73, s[44:47], s58 offen offset:1024 lds
  buffer_load_dwordx4 v74, s[44:47], s58 offen offset:2048 lds
  buffer_load_dwordx4 v75, s[44:47], s58 offen offset:3072 lds
  s_add_u32 m0, m0, 4096
  s_nop 0
  buffer_load_dwordx4 v76, s[44:47], s58 offen offset:0 lds
  buffer_load_dwordx4 v77, s[44:47], s58 offen offset:1024 lds
  buffer_load_dwordx4 v78, s[44:47], s58 offen offset:2048 lds
  buffer_load_dwordx4 v79, s[44:47], s58 offen offset:3072 lds
  s_add_u32 s58, s58, s68
  s_min_u32 s58, s58, 0x1f8000
  s_add_u32 s59, s59, 0x8000
  s_cmp_eq_u32 s59, 0x28000
  s_cselect_b32 s59, 0, s59
  s_waitcnt vmcnt(32)
  s_barrier
  v_mov_b32 v7, 1
  s_cmp_lg_u32 s3, 0
  s_cbranch_scc1 L_p_ni
  s_mov_b64 exec, 1
  buffer_atomic_add v7, v6, s[8:11], 0 offen sc1
  s_mov_b64 exec, -1
L_p_ni:
  ds_read_b64_tr_b16 a[0:1], v12 offset:0
  ds_read_b64_tr_b16 a[64:65], v14 offset:0
  ds_read_b64_tr_b16 a[2:3], v12 offset:1024
  ds_read_b64_tr_b16 a[66:67], v14 offset:1024
  ds_read_b64_tr_b16 a[4:5], v12 offset:8192
  ds_read_b64_tr_b16 a[68:69], v14 offset:8192
  ds_read_b64_tr_b16 a[6:7], v12 offset:9216
  ds_read_b64_tr_b16 a[70:71], v14 offset:9216
  ds_read_b64_tr_b16 a[8:9], v12 offset:16384
  ds_read_b64_tr_b16 a[72:73], v14 offset:16384
  ds_read_b64_tr_b16 a[10:11], v12 offset:17408
  ds_read_b64_tr_b16 a[74:75], v14 offset:17408
  ds_read_b64_tr_b16 a[12:13], v12 offset:24576
  ds_read_b64_tr_b16 a[76:77], v14 offset:24576
  ds_read_b64_tr_b16 a[14:15], v12 offset:25600
  ds_read_b64_tr_b16 a[78:79], v14 offset:25600
  s_waitcnt vmcnt(24)
  s_barrier
  ds_read_b64_tr_b16 a[16:17], v12 offset:32768
  ds_read_b64_tr_b16 a[80:81], v14 offset:32768
  ds_read_b64_tr_b16 a[18:19], v12 offset:33792
  ds_read_b64_tr_b16 a[82:83], v14 offset:33792
  ds_read_b64_tr_b16 a[20:21], v12 offset:40960
  ds_read_b64_tr_b16 a[84:85], v14 offset:40960
  ds_read_b64_tr_b16 a[22:23], v12 offset:41984
  ds_read_b64_tr_b16 a[86:87], v14 offset:41984
  ds_read_b64_tr_b16 a[24:25], v12 offset:49152
  ds_read_b64_tr_b16 a[88:89], v14 offset:49152
  ds_read_b64_tr_b16 a[26:27], v12 offset:50176
  ds_read_b64_tr_b16 a[90:91], v14 offset:50176
  ds_read_b64_tr_b16 a[28:29], v12 offset:57344
  ds_read_b64_tr_b16 a[92:93], v14 offset:57344
  ds_read_b64_tr_b16 a[30:31], v12 offset:58368
  ds_read_b64_tr_b16 a[94:95], v14 offset:58368
  s_waitcnt vmcnt(16)
  s_barrier
  ds_read_b64_tr_b16 a[32:33], v13 offset:0
  ds_read_b64_tr_b16 a[96:97], v15 offset:0
  ds_read_b64_tr_b16 a[34:35], v13 offset:1024
  ds_read_b64_tr_b16 a[98:99], v15 offset:1024
  ds_read_b64_tr_b16 a[36:37], v13 offset:8192
  ds_read_b64_tr_b16 a[100:101], v15 offset:8192
  ds_read_b64_tr_b16 a[38:39], v13 offset:9216
  ds_read_b64_tr_b16 a[102:103], v15 offset:9216
  ds_read_b64_tr_b16 a[40:41], v13 offset:16384
  ds_read_b64_tr_b16 a[104:105], v15 offset:16384
  ds_read_b64_tr_b16 a[42:43], v13 offset:17408
  ds_read_b64_tr_b16 a[106:107], v15 offset:17408
  ds_read_b64_tr_b16 a[44:45], v13 offset:24576
  ds_read_b64_tr_b16 a[108:109], v15 offset:24576
  ds_read_b64_tr_b16 a[46:47], v13 offset:25600
  ds_read_b64_tr_b16 a[110:111], v15 offset:25600
  s_waitcnt vmcnt(8)
  s_barrier
  ds_read_b64_tr_b16 a[48:49], v13 offset:32768
  ds_read_b64_tr_b16 a[112:113], v15 offset:32768
  ds_read_b64_tr_b16 a[50:51], v13 offset:33792
  ds_read_b64_tr_b16 a[114:115], v15 offset:33792
  ds_read_b64_tr_b16 a[52:53], v13 offset:40960
  ds_read_b64_tr_b16 a[116:117], v15 offset:40960
  ds_read_b64_tr_b16 a[54:55], v13 offset:41984
  ds_read_b64_tr_b16 a[118:119], v15 offset:41984
  ds_read_b64_tr_b16 a[56:57], v13 offset:49152
  ds_read_b64_tr_b16 a[120:121], v15 offset:49152
  ds_read_b64_tr_b16 a[58:59], v13 offset:50176
  ds_read_b64_tr_b16 a[122:123], v15 offset:50176
  ds_read_b64_tr_b16 a[60:61], v13 offset:57344
  ds_read_b64_tr_b16 a[124:125], v15 offset:57344
  ds_read_b64_tr_b16 a[62:63], v13 offset:58368
  ds_read_b64_tr_b16 a[126:127], v15 offset:58368
  s_waitcnt lgkmcnt(0)
  s_barrier
  s_lshl_b32 s55, s3, 13
  s_add_u32 m0, s59, s55
  s_nop 0
  buffer_load_dwordx4 v72, s[44:47], s58 offen offset:0 lds
  buffer_load_dwordx4 v73, s[44:47], s58 offen offset:1024 lds
  buffer_load_dwordx4 v74, s[44:47], s58 offen offset:2048 lds
  buffer_load_dwordx4 v75, s[44:47], s58 offen offset:3072 lds
  s_add_u32 m0, m0, 4096
  s_nop 0
  buffer_load_dwordx4 v76, s[44:47], s58 offen offset:0 lds
  buffer_load_dwordx4 v77, s[44:47], s58 offen offset:1024 lds
  buffer_load_dwordx4 v78, s[44:47], s58 offen offset:2048 lds
  buffer_load_dwordx4 v79, s[44:47], s58 offen offset:3072 lds
  s_add_u32 s58, s58, s68
  s_min_u32 s58, s58, 0x1f8000
  s_add_u32 s59, s59, 0x8000
  s_cmp_eq_u32 s59, 0x28000
  s_cselect_b32 s59, 0, s59
  s_lshl_b32 s55, s3, 13
  s_add_u32 m0, s59, s55
  s_nop 0
  buffer_load_dwordx4 v72, s[44:47], s58 offen offset:0 lds
  buffer_load_dwordx4 v73, s[44:47], s58 offen offset:1024 lds
  buffer_load_dwordx4 v74, s[44:47], s58 offen offset:2048 lds
  buffer_load_dwordx4 v75, s[44:47], s58 offen offset:3072 lds
  s_add_u32 m0, m0, 4096
  s_nop 0
  buffer_load_dwordx4 v76, s[44:47], s58 offen offset:0 lds
  buffer_load_dwordx4 v77, s[44:47], s58 offen offset:1024 lds
  buffer_load_dwordx4 v78, s[44:47], s58 offen offset:2048 lds
  buffer_load_dwordx4 v79, s[44:47], s58 offen offset:3072 lds
  s_add_u32 s58, s58, s68
  s_min_u32 s58, s58, 0x1f8000
  s_add_u32 s59, s59, 0x8000
  s_cmp_eq_u32 s59, 0x28000
  s_cselect_b32 s59, 0, s59
  s_lshl_b32 s55, s54, 15
  s_add_u32 s61, s61, s55
  s_lshl_b32 s55, s43, 21
  s_add_u32 s61, s61, s55
  s_cmp_eq_u32 s53, 1
  s_cselect_b32 s56, 11, 10
  s_lshl_b32 s55, s3, s56
  s_add_u32 s61, s61, s55
  s_mov_b32 s57, 0
  v_mov_b32 v7, 1
  s_mov_b32 s63, 0
  s_cmp_eq_u32 s53, 1
  s_cselect_b32 s55, 1, 4
  s_lshl_b32 s55, s55, 10
  s_add_u32 s66, s61, s55
  v_mov_b32 v12, -1
  v_mov_b32 v13, -1
  v_mov_b32 v14, -1
  v_mov_b32 v15, -1
  s_lshl_b32 s55, s3, 10
  v_subrev_u32 v11, s55, v1
  v_add_u32 v11, 0x2000, v11
  s_waitcnt vmcnt(16)
  s_barrier
  v_add_u32 v84, s60, v80
  v_add_u32 v85, s60, v81
  v_add_u32 v86, s60, v82
  v_add_u32 v87, s60, v83
  s_add_u32 s60, s60, 0x8000
  s_cmp_eq_u32 s60, 0x28000
  s_cselect_b32 s60, 0, s60
  ds_read_b128 v[16:19], v84 offset:0
  ds_read_b128 v[20:23], v84 offset:16384
  ds_read_b128 v[24:27], v85 offset:0
  ds_read_b128 v[28:31], v85 offset:16384
  ds_read_b128 v[32:35], v86 offset:0
  ds_read_b128 v[36:39], v86 offset:16384
  ds_read_b128 v[40:43], v87 offset:0
  ds_read_b128 v[44:47], v87 offset:16384
  s_cmp_eq_u32 s53, 1
  s_cbranch_scc1 L_pv_loop
L_pk_loop:
  s_waitcnt lgkmcnt(6)
  v_mfma_f32_16x16x32_bf16 v[48:51], a[0:3], v[16:19], 0
  s_lshl_b32 s55, s3, 13
  s_add_u32 m0, s59, s55
  s_nop 0
  buffer_load_dwordx4 v72, s[44:47], s58 offen offset:0 lds
  v_mfma_f32_16x16x32_bf16 v[56:59], a[64:67], v[16:19], 0
  ds_read_b128 v[16:19], v84 offset:256
  v_mfma_f32_16x16x32_bf16 v[52:55], a[0:3], v[20:23], 0
  v_mfma_f32_16x16x32_bf16 v[60:63], a[64:67], v[20:23], 0
  ds_read_b128 v[20:23], v84 offset:16640
  s_waitcnt lgkmcnt(6)
  v_mfma_f32_16x16x32_bf16 v[48:51], a[4:7], v[24:27], v[48:51]
  v_mfma_f32_16x16x32_bf16 v[56:59], a[68:71], v[24:27], v[56:59]
  ds_read_b128 v[24:27], v85 offset:256
  v_mfma_f32_16x16x32_bf16 v[52:55], a[4:7], v[28:31], v[52:55]
  v_mfma_f32_16x16x32_bf16 v[60:63], a[68:71], v[28:31], v[60:63]
  ds_read_b128 v[28:31], v85 offset:16640
  s_waitcnt lgkmcnt(6)
  v_mfma_f32_16x16x32_bf16 v[48:51], a[8:11], v[32:35], v[48:51]
  buffer_load_dwordx4 v73, s[44:47], s58 offen offset:1024 lds
  v_cvt_pk_bf16_f32 v64, v88, v89
  v_mfma_f32_16x16x32_bf16 v[56:59], a[72:75], v[32:35], v[56:59]
  ds_read_b128 v[32:35], v86 offset:256
  v_mfma_f32_16x16x32_bf16 v[52:55], a[8:11], v[36:39], v[52:55]
  v_cvt_pk_bf16_f32 v65, v90, v91
  v_mfma_f32_16x16x32_bf16 v[60:63], a[72:75], v[36:39], v[60:63]
  ds_read_b128 v[36:39], v86 offset:16640
  s_waitcnt lgkmcnt(6)
  v_mfma_f32_16x16x32_bf16 v[48:51], a[12:15], v[40:43], v[48:51]
  v_cvt_pk_bf16_f32 v66, v96, v97
  v_mfma_f32_16x16x32_bf16 v[56:59], a[76:79], v[40:43], v[56:59]
  ds_read_b128 v[40:43], v87 offset:256
  v_mfma_f32_16x16x32_bf16 v[52:55], a[12:15], v[44:47], v[52:55]
  v_cvt_pk_bf16_f32 v67, v98, v99
  v_mfma_f32_16x16x32_bf16 v[60:63], a[76:79], v[44:47], v[60:63]
  ds_read_b128 v[44:47], v87 offset:16640
  s_waitcnt lgkmcnt(6)
  v_mfma_f32_16x16x32_bf16 v[48:51], a[16:19], v[16:19], v[48:51]
  buffer_load_dwordx4 v74, s[44:47], s58 offen offset:2048 lds
  buffer_store_dwordx4 v[64:67], v1, s[4:7], s61 offen sc1
  v_mfma_f32_16x16x32_bf16 v[56:59], a[80:83], v[16:19], v[56:59]
  ds_read_b128 v[16:19], v84 offset:512
  v_mfma_f32_16x16x32_bf16 v[52:55], a[16:19], v[20:23], v[52:55]
  v_cvt_pk_bf16_f32 v68, v92, v93
  v_mfma_f32_16x16x32_bf16 v[60:63], a[80:83], v[20:23], v[60:63]
  ds_read_b128 v[20:23], v84 offset:16896
  s_waitcnt lgkmcnt(6)
  v_mfma_f32_16x16x32_bf16 v[48:51], a[20:23], v[24:27], v[48:51]
  v_cvt_pk_bf16_f32 v69, v94, v95
  v_mfma_f32_16x16x32_bf16 v[56:59], a[84:87], v[24:27], v[56:59]
  ds_read_b128 v[24:27], v85 offset:512
  v_mfma_f32_16x16x32_bf16 v[52:55], a[20:23], v[28:31], v[52:55]
  v_cvt_pk_bf16_f32 v70, v100, v101
  v_mfma_f32_16x16x32_bf16 v[60:63], a[84:87], v[28:31], v[60:63]
  ds_read_b128 v[28:31], v85 offset:16896
  s_waitcnt lgkmcnt(6)
  v_mfma_f32_16x16x32_bf16 v[48:51], a[24:27], v[32:35], v[48:51]
  buffer_load_dwordx4 v75, s[44:47], s58 offen offset:3072 lds
  s_add_u32 m0, m0, 4096
  v_cvt_pk_bf16_f32 v71, v102, v103
  v_mfma_f32_16x16x32_bf16 v[56:59], a[88:91], v[32:35], v[56:59]
  ds_read_b128 v[32:35], v86 offset:512
  v_mfma_f32_16x16x32_bf16 v[52:55], a[24:27], v[36:39], v[52:55]
  buffer_store_dwordx4 v[68:71], v1, s[4:7], s66 offen sc1
  v_mfma_f32_16x16x32_bf16 v[60:63], a[88:91], v[36:39], v[60:63]
  ds_read_b128 v[36:39], v86 offset:16896
  s_waitcnt lgkmcnt(6)
  v_mfma_f32_16x16x32_bf16 v[48:51], a[28:31], v[40:43], v[48:51]
  s_add_u32 s61, s61, s63
  s_add_u32 s66, s66, s63
  s_mov_b32 s63, s68
  v_mfma_f32_16x16x32_bf16 v[56:59], a[92:95], v[40:43], v[56:59]
  ds_read_b128 v[40:43], v87 offset:512
  v_mfma_f32_16x16x32_bf16 v[52:55], a[28:31], v[44:47], v[52:55]
  v_mfma_f32_16x16x32_bf16 v[60:63], a[92:95], v[44:47], v[60:63]
  ds_read_b128 v[44:47], v87 offset:16896
  s_waitcnt lgkmcnt(6)
  v_mfma_f32_16x16x32_bf16 v[48:51], a[32:35], v[16:19], v[48:51]
  buffer_load_dwordx4 v76, s[44:47], s58 offen offset:0 lds
  v_mfma_f32_16x16x32_bf16 v[56:59], a[96:99], v[16:19], v[56:59]
  ds_read_b128 v[16:19], v84 offset:768
  v_mfma_f32_16x16x32_bf16 v[52:55], a[32:35], v[20:23], v[52:55]
  v_mfma_f32_16x16x32_bf16 v[60:63], a[96:99], v[20:23], v[60:63]
  ds_read_b128 v[20:23], v84 offset:17152
  s_waitcnt lgkmcnt(6)
  v_mfma_f32_16x16x32_bf16 v[48:51], a[36:39], v[24:27], v[48:51]
  v_mfma_f32_16x16x32_bf16 v[56:59], a[100:103], v[24:27], v[56:59]
  ds_read_b128 v[24:27], v85 offset:768
  v_mfma_f32_16x16x32_bf16 v[52:55], a[36:39], v[28:31], v[52:55]
  v_mfma_f32_16x16x32_bf16 v[60:63], a[100:103], v[28:31], v[60:63]
  ds_read_b128 v[28:31], v85 offset:17152
  s_waitcnt lgkmcnt(6)
  v_mfma_f32_16x16x32_bf16 v[48:51], a[40:43], v[32:35], v[48:51]
  buffer_load_dwordx4 v77, s[44:47], s58 offen offset:1024 lds
  v_mfma_f32_16x16x32_bf16 v[56:59], a[104:107], v[32:35], v[56:59]
  ds_read_b128 v[32:35], v86 offset:768
  v_mfma_f32_16x16x32_bf16 v[52:55], a[40:43], v[36:39], v[52:55]
  v_mfma_f32_16x16x32_bf16 v[60:63], a[104:107], v[36:39], v[60:63]
  ds_read_b128 v[36:39], v86 offset:17152
  s_waitcnt lgkmcnt(6)
  v_mfma_f32_16x16x32_bf16 v[48:51], a[44:47], v[40:43], v[48:51]
  v_mfma_f32_16x16x32_bf16 v[56:59], a[108:111], v[40:43], v[56:59]
  ds_read_b128 v[40:43], v87 offset:768
  v_mfma_f32_16x16x32_bf16 v[52:55], a[44:47], v[44:47], v[52:55]
  v_mfma_f32_16x16x32_bf16 v[60:63], a[108:111], v[44:47], v[60:63]
  ds_read_b128 v[44:47], v87 offset:17152
  s_waitcnt lgkmcnt(6)
  v_mfma_f32_16x16x32_bf16 v[48:51], a[48:51], v[16:19], v[48:51]
  buffer_load_dwordx4 v78, s[44:47], s58 offen offset:2048 lds
  s_waitcnt vmcnt(13)
  s_barrier
  v_add_u32 v84, s60, v80
  v_add_u32 v85, s60, v81
  v_add_u32 v86, s60, v82
  v_add_u32 v87, s60, v83
  s_add_u32 s60, s60, 0x8000
  s_cmp_eq_u32 s60, 0x28000
  s_cselect_b32 s60, 0, s60
  v_mfma_f32_16x16x32_bf16 v[56:59], a[112:115], v[16:19], v[56:59]
  ds_read_b128 v[16:19], v84 offset:0
  v_mfma_f32_16x16x32_bf16 v[52:55], a[48:51], v[20:23], v[52:55]
  v_mfma_f32_16x16x32_bf16 v[60:63], a[112:115], v[20:23], v[60:63]
  ds_read_b128 v[20:23], v84 offset:16384
  s_waitcnt lgkmcnt(6)
  v_mfma_f32_16x16x32_bf16 v[48:51], a[52:55], v[24:27], v[48:51]
  v_mfma_f32_16x16x32_bf16 v[56:59], a[116:119], v[24:27], v[56:59]
  ds_read_b128 v[24:27], v85 offset:0
  v_mfma_f32_16x16x32_bf16 v[52:55], a[52:55], v[28:31], v[52:55]
  s_cmp_lg_u32 s3, 0
  s_cbranch_scc1 L_pk_loop_nf0
  s_cmp_lg_u32 s57, 2
  s_cbranch_scc1 L_pk_loop_nf0
  v_mov_b32 v8, 1
  s_mov_b64 exec, 1
  buffer_store_dword v8, v6, s[4:7], s62 offen sc1
  s_mov_b64 exec, -1
L_pk_loop_nf0:
  v_mfma_f32_16x16x32_bf16 v[60:63], a[116:119], v[28:31], v[60:63]
  ds_read_b128 v[28:31], v85 offset:16384
  s_waitcnt lgkmcnt(6)
  v_mfma_f32_16x16x32_bf16 v[48:51], a[56:59], v[32:35], v[48:51]
  buffer_load_dwordx4 v79, s[44:47], s58 offen offset:3072 lds
  s_add_u32 s58, s58, s68
  s_min_u32 s58, s58, 0x1f8000
  s_add_u32 s59, s59, 0x8000
  s_cmp_eq_u32 s59, 0x28000
  s_cselect_b32 s59, 0, s59
  v_mfma_f32_16x16x32_bf16 v[56:59], a[120:123], v[32:35], v[56:59]
  ds_read_b128 v[32:35], v86 offset:0
  v_mfma_f32_16x16x32_bf16 v[52:55], a[56:59], v[36:39], v[52:55]
  v_mfma_f32_16x16x32_bf16 v[60:63], a[120:123], v[36:39], v[60:63]
  ds_read_b128 v[36:39], v86 offset:16384
  s_waitcnt lgkmcnt(6)
  v_mfma_f32_16x16x32_bf16 v[48:51], a[60:63], v[40:43], v[48:51]
  v_mfma_f32_16x16x32_bf16 v[56:59], a[124:127], v[40:43], v[56:59]
  ds_read_b128 v[40:43], v87 offset:0
  v_mfma_f32_16x16x32_bf16 v[52:55], a[60:63], v[44:47], v[52:55]
  v_mfma_f32_16x16x32_bf16 v[60:63], a[124:127], v[44:47], v[60:63]
  ds_read_b128 v[44:47], v87 offset:16384
  s_waitcnt lgkmcnt(6)
  v_mfma_f32_16x16x32_bf16 v[88:91], a[0:3], v[16:19], 0
  s_lshl_b32 s55, s3, 13
  s_add_u32 m0, s59, s55
  s_nop 0
  buffer_load_dwordx4 v72, s[44:47], s58 offen offset:0 lds
  v_mfma_f32_16x16x32_bf16 v[96:99], a[64:67], v[16:19], 0
  ds_read_b128 v[16:19], v84 offset:256
  v_mfma_f32_16x16x32_bf16 v[92:95], a[0:3], v[20:23], 0
  v_mfma_f32_16x16x32_bf16 v[100:103], a[64:67], v[20:23], 0
  ds_read_b128 v[20:23], v84 offset:16640
  s_waitcnt lgkmcnt(6)
  v_mfma_f32_16x16x32_bf16 v[88:91], a[4:7], v[24:27], v[88:91]
  v_mfma_f32_16x16x32_bf16 v[96:99], a[68:71], v[24:27], v[96:99]
  ds_read_b128 v[24:27], v85 offset:256
  v_mfma_f32_16x16x32_bf16 v[92:95], a[4:7], v[28:31], v[92:95]
  v_mfma_f32_16x16x32_bf16 v[100:103], a[68:71], v[28:31], v[100:103]
  ds_read_b128 v[28:31], v85 offset:16640
  s_waitcnt lgkmcnt(6)
  v_mfma_f32_16x16x32_bf16 v[88:91], a[8:11], v[32:35], v[88:91]
  buffer_load_dwordx4 v73, s[44:47], s58 offen offset:1024 lds
  v_cvt_pk_bf16_f32 v64, v48, v49
  v_mfma_f32_16x16x32_bf16 v[96:99], a[72:75], v[32:35], v[96:99]
  ds_read_b128 v[32:35], v86 offset:256
  v_mfma_f32_16x16x32_bf16 v[92:95], a[8:11], v[36:39], v[92:95]
  v_cvt_pk_bf16_f32 v65, v50, v51
  v_mfma_f32_16x16x32_bf16 v[100:103], a[72:75], v[36:39], v[100:103]
  ds_read_b128 v[36:39], v86 offset:16640
  s_waitcnt lgkmcnt(6)
  v_mfma_f32_16x16x32_bf16 v[88:91], a[12:15], v[40:43], v[88:91]
  v_cvt_pk_bf16_f32 v66, v56, v57
  v_mfma_f32_16x16x32_bf16 v[96:99], a[76:79], v[40:43], v[96:99]
  ds_read_b128 v[40:43], v87 offset:256
  v_mfma_f32_16x16x32_bf16 v[92:95], a[12:15], v[44:47], v[92:95]
  v_cvt_pk_bf16_f32 v67, v58, v59
  v_mfma_f32_16x16x32_bf16 v[100:103], a[76:79], v[44:47], v[100:103]
  ds_read_b128 v[44:47], v87 offset:16640
  s_waitcnt lgkmcnt(6)
  v_mfma_f32_16x16x32_bf16 v[88:91], a[16:19], v[16:19], v[88:91]
  buffer_load_dwordx4 v74, s[44:47], s58 offen offset:2048 lds
  buffer_store_dwordx4 v[64:67], v1, s[4:7], s61 offen sc1
  v_mfma_f32_16x16x32_bf16 v[96:99], a[80:83], v[16:19], v[96:99]
  ds_read_b128 v[16:19], v84 offset:512
  v_mfma_f32_16x16x32_bf16 v[92:95], a[16:19], v[20:23], v[92:95]
  v_cvt_pk_bf16_f32 v68, v52, v53
  v_mfma_f32_16x16x32_bf16 v[100:103], a[80:83], v[20:23], v[100:103]
  ds_read_b128 v[20:23], v84 offset:16896
  s_waitcnt lgkmcnt(6)
  v_mfma_f32_16x16x32_bf16 v[88:91], a[20:23], v[24:27], v[88:91]
  v_cvt_pk_bf16_f32 v69, v54, v55
  v_mfma_f32_16x16x32_bf16 v[96:99], a[84:87], v[24:27], v[96:99]
  ds_read_b128 v[24:27], v85 offset:512
  v_mfma_f32_16x16x32_bf16 v[92:95], a[20:23], v[28:31], v[92:95]
  v_cvt_pk_bf16_f32 v70, v60, v61
  v_mfma_f32_16x16x32_bf16 v[100:103], a[84:87], v[28:31], v[100:103]
  ds_read_b128 v[28:31], v85 offset:16896
  s_waitcnt lgkmcnt(6)
  v_mfma_f32_16x16x32_bf16 v[88:91], a[24:27], v[32:35], v[88:91]
  buffer_load_dwordx4 v75, s[44:47], s58 offen offset:3072 lds
  s_add_u32 m0, m0, 4096
  v_cvt_pk_bf16_f32 v71, v62, v63
  v_mfma_f32_16x16x32_bf16 v[96:99], a[88:91], v[32:35], v[96:99]
  ds_read_b128 v[32:35], v86 offset:512
  v_mfma_f32_16x16x32_bf16 v[92:95], a[24:27], v[36:39], v[92:95]
  buffer_store_dwordx4 v[68:71], v1, s[4:7], s66 offen sc1
  v_mfma_f32_16x16x32_bf16 v[100:103], a[88:91], v[36:39], v[100:103]
  ds_read_b128 v[36:39], v86 offset:16896
  s_waitcnt lgkmcnt(6)
  v_mfma_f32_16x16x32_bf16 v[88:91], a[28:31], v[40:43], v[88:91]
  s_add_u32 s61, s61, s63
  s_add_u32 s66, s66, s63
  s_mov_b32 s63, s68
  v_mfma_f32_16x16x32_bf16 v[96:99], a[92:95], v[40:43], v[96:99]
  ds_read_b128 v[40:43], v87 offset:512
  v_mfma_f32_16x16x32_bf16 v[92:95], a[28:31], v[44:47], v[92:95]
  v_mfma_f32_16x16x32_bf16 v[100:103], a[92:95], v[44:47], v[100:103]
  ds_read_b128 v[44:47], v87 offset:16896
  s_waitcnt lgkmcnt(6)
  v_mfma_f32_16x16x32_bf16 v[88:91], a[32:35], v[16:19], v[88:91]
  buffer_load_dwordx4 v76, s[44:47], s58 offen offset:0 lds
  v_mfma_f32_16x16x32_bf16 v[96:99], a[96:99], v[16:19], v[96:99]
  ds_read_b128 v[16:19], v84 offset:768
  v_mfma_f32_16x16x32_bf16 v[92:95], a[32:35], v[20:23], v[92:95]
  v_mfma_f32_16x16x32_bf16 v[100:103], a[96:99], v[20:23], v[100:103]
  ds_read_b128 v[20:23], v84 offset:17152
  s_waitcnt lgkmcnt(6)
  v_mfma_f32_16x16x32_bf16 v[88:91], a[36:39], v[24:27], v[88:91]
  v_mfma_f32_16x16x32_bf16 v[96:99], a[100:103], v[24:27], v[96:99]
  ds_read_b128 v[24:27], v85 offset:768
  v_mfma_f32_16x16x32_bf16 v[92:95], a[36:39], v[28:31], v[92:95]
  v_mfma_f32_16x16x32_bf16 v[100:103], a[100:103], v[28:31], v[100:103]
  ds_read_b128 v[28:31], v85 offset:17152
  s_waitcnt lgkmcnt(6)
  v_mfma_f32_16x16x32_bf16 v[88:91], a[40:43], v[32:35], v[88:91]
  buffer_load_dwordx4 v77, s[44:47], s58 offen offset:1024 lds
  v_mfma_f32_16x16x32_bf16 v[96:99], a[104:107], v[32:35], v[96:99]
  ds_read_b128 v[32:35], v86 offset:768
  v_mfma_f32_16x16x32_bf16 v[92:95], a[40:43], v[36:39], v[92:95]
  v_mfma_f32_16x16x32_bf16 v[100:103], a[104:107], v[36:39], v[100:103]
  ds_read_b128 v[36:39], v86 offset:17152
  s_waitcnt lgkmcnt(6)
  v_mfma_f32_16x16x32_bf16 v[88:91], a[44:47], v[40:43], v[88:91]
  v_mfma_f32_16x16x32_bf16 v[96:99], a[108:111], v[40:43], v[96:99]
  ds_read_b128 v[40:43], v87 offset:768
  v_mfma_f32_16x16x32_bf16 v[92:95], a[44:47], v[44:47], v[92:95]
  v_mfma_f32_16x16x32_bf16 v[100:103], a[108:111], v[44:47], v[100:103]
  ds_read_b128 v[44:47], v87 offset:17152
  s_waitcnt lgkmcnt(6)
  v_mfma_f32_16x16x32_bf16 v[88:91], a[48:51], v[16:19], v[88:91]
  buffer_load_dwordx4 v78, s[44:47], s58 offen offset:2048 lds
  s_waitcnt vmcnt(13)
  s_barrier
  v_add_u32 v84, s60, v80
  v_add_u32 v85, s60, v81
  v_add_u32 v86, s60, v82
  v_add_u32 v87, s60, v83
  s_add_u32 s60, s60, 0x8000
  s_cmp_eq_u32 s60, 0x28000
  s_cselect_b32 s60, 0, s60
  v_mfma_f32_16x16x32_bf16 v[96:99], a[112:115], v[16:19], v[96:99]
  ds_read_b128 v[16:19], v84 offset:0
  v_mfma_f32_16x16x32_bf16 v[92:95], a[48:51], v[20:23], v[92:95]
  v_mfma_f32_16x16x32_bf16 v[100:103], a[112:115], v[20:23], v[100:103]
  ds_read_b128 v[20:23], v84 offset:16384
  s_waitcnt lgkmcnt(6)
  v_mfma_f32_16x16x32_bf16 v[88:91], a[52:55], v[24:27], v[88:91]
  v_mfma_f32_16x16x32_bf16 v[96:99], a[116:119], v[24:27], v[96:99]
  ds_read_b128 v[24:27], v85 offset:0
  v_mfma_f32_16x16x32_bf16 v[92:95], a[52:55], v[28:31], v[92:95]
  s_cmp_lg_u32 s3, 0
  s_cbranch_scc1 L_pk_loop_nf1
  v_mov_b32 v8, s57
  s_mov_b64 exec, 1
  buffer_store_dword v8, v6, s[4:7], s62 offen sc1
  s_mov_b64 exec, -1
L_pk_loop_nf1:
  v_mfma_f32_16x16x32_bf16 v[100:103], a[116:119], v[28:31], v[100:103]
  ds_read_b128 v[28:31], v85 offset:16384
  s_waitcnt lgkmcnt(6)
  v_mfma_f32_16x16x32_bf16 v[88:91], a[56:59], v[32:35], v[88:91]
  buffer_load_dwordx4 v79, s[44:47], s58 offen offset:3072 lds
  s_add_u32 s58, s58, s68
  s_min_u32 s58, s58, 0x1f8000
  s_add_u32 s59, s59, 0x8000
  s_cmp_eq_u32 s59, 0x28000
  s_cselect_b32 s59, 0, s59
  v_mfma_f32_16x16x32_bf16 v[96:99], a[120:123], v[32:35], v[96:99]
  ds_read_b128 v[32:35], v86 offset:0
  v_mfma_f32_16x16x32_bf16 v[92:95], a[56:59], v[36:39], v[92:95]
  v_mfma_f32_16x16x32_bf16 v[100:103], a[120:123], v[36:39], v[100:103]
  ds_read_b128 v[36:39], v86 offset:16384
  s_waitcnt lgkmcnt(6)
  v_mfma_f32_16x16x32_bf16 v[88:91], a[60:63], v[40:43], v[88:91]
  v_mfma_f32_16x16x32_bf16 v[96:99], a[124:127], v[40:43], v[96:99]
  ds_read_b128 v[40:43], v87 offset:0
  v_mfma_f32_16x16x32_bf16 v[92:95], a[60:63], v[44:47], v[92:95]
  v_mfma_f32_16x16x32_bf16 v[100:103], a[124:127], v[44:47], v[100:103]
  ds_read_b128 v[44:47], v87 offset:16384
  s_add_u32 s57, s57, 2
  s_cmp_lt_u32 s57, s69
  s_cbranch_scc1 L_pk_loop
  s_nop 3
  s_nop 7
  v_cvt_pk_bf16_f32 v64, v88, v89
  v_cvt_pk_bf16_f32 v65, v90, v91
  v_cvt_pk_bf16_f32 v66, v96, v97
  v_cvt_pk_bf16_f32 v67, v98, v99
  buffer_store_dwordx4 v[64:67], v1, s[4:7], s61 offen sc1
  v_cvt_pk_bf16_f32 v68, v92, v93
  v_cvt_pk_bf16_f32 v69, v94, v95
  v_cvt_pk_bf16_f32 v70, v100, v101
  v_cvt_pk_bf16_f32 v71, v102, v103
  buffer_store_dwordx4 v[68:71], v1, s[4:7], s66 offen sc1
  s_add_u32 s61, s61, s63
  s_add_u32 s66, s66, s63
  s_mov_b32 s63, s68
  s_branch L_p_done
L_pv_loop:
  s_waitcnt lgkmcnt(6)
  v_mfma_f32_16x16x32_bf16 v[48:51], v[16:19], a[0:3], 0
  s_lshl_b32 s55, s3, 13
  s_add_u32 m0, s59, s55
  s_nop 0
  buffer_load_dwordx4 v72, s[44:47], s58 offen offset:0 lds
  v_mfma_f32_16x16x32_bf16 v[56:59], v[16:19], a[64:67], 0
  ds_read_b128 v[16:19], v84 offset:256
  v_mfma_f32_16x16x32_bf16 v[52:55], v[20:23], a[0:3], 0
  v_mfma_f32_16x16x32_bf16 v[60:63], v[20:23], a[64:67], 0
  ds_read_b128 v[20:23], v84 offset:16640
  s_waitcnt lgkmcnt(6)
  v_mfma_f32_16x16x32_bf16 v[48:51], v[24:27], a[4:7], v[48:51]
  v_mfma_f32_16x16x32_bf16 v[56:59], v[24:27], a[68:71], v[56:59]
  ds_read_b128 v[24:27], v85 offset:256
  v_mfma_f32_16x16x32_bf16 v[52:55], v[28:31], a[4:7], v[52:55]
  v_mfma_f32_16x16x32_bf16 v[60:63], v[28:31], a[68:71], v[60:63]
  ds_read_b128 v[28:31], v85 offset:16640
  s_waitcnt lgkmcnt(6)
  v_mfma_f32_16x16x32_bf16 v[48:51], v[32:35], a[8:11], v[48:51]
  buffer_load_dwordx4 v73, s[44:47], s58 offen offset:1024 lds
  v_cvt_pk_bf16_f32 v64, v88, v89
  v_mfma_f32_16x16x32_bf16 v[56:59], v[32:35], a[72:75], v[56:59]
  ds_read_b128 v[32:35], v86 offset:256
  v_mfma_f32_16x16x32_bf16 v[52:55], v[36:39], a[8:11], v[52:55]
  v_cvt_pk_bf16_f32 v65, v90, v91
  v_mfma_f32_16x16x32_bf16 v[60:63], v[36:39], a[72:75], v[60:63]
  ds_read_b128 v[36:39], v86 offset:16640
  s_waitcnt lgkmcnt(6)
  v_mfma_f32_16x16x32_bf16 v[48:51], v[40:43], a[12:15], v[48:51]
  v_cvt_pk_bf16_f32 v66, v92, v93
  v_mfma_f32_16x16x32_bf16 v[56:59], v[40:43], a[76:79], v[56:59]
  ds_read_b128 v[40:43], v87 offset:256
  v_mfma_f32_16x16x32_bf16 v[52:55], v[44:47], a[12:15], v[52:55]
  v_cvt_pk_bf16_f32 v67, v94, v95
  v_mfma_f32_16x16x32_bf16 v[60:63], v[44:47], a[76:79], v[60:63]
  ds_read_b128 v[44:47], v87 offset:16640
  s_waitcnt lgkmcnt(6)
  v_mfma_f32_16x16x32_bf16 v[48:51], v[16:19], a[16:19], v[48:51]
  buffer_load_dwordx4 v74, s[44:47], s58 offen offset:2048 lds
  buffer_store_dwordx4 v[64:67], v1, s[4:7], s61 offen sc1
  v_mfma_f32_16x16x32_bf16 v[56:59], v[16:19], a[80:83], v[56:59]
  ds_read_b128 v[16:19], v84 offset:512
  v_mfma_f32_16x16x32_bf16 v[52:55], v[20:23], a[16:19], v[52:55]
  v_cvt_pk_bf16_f32 v68, v100, v101
  v_mfma_f32_16x16x32_bf16 v[60:63], v[20:23], a[80:83], v[60:63]
  ds_read_b128 v[20:23], v84 offset:16896
  s_waitcnt lgkmcnt(6)
  v_mfma_f32_16x16x32_bf16 v[48:51], v[24:27], a[20:23], v[48:51]
  v_cvt_pk_bf16_f32 v69, v102, v103
  v_mfma_f32_16x16x32_bf16 v[56:59], v[24:27], a[84:87], v[56:59]
  ds_read_b128 v[24:27], v85 offset:512
  v_mfma_f32_16x16x32_bf16 v[52:55], v[28:31], a[20:23], v[52:55]
  v_cvt_pk_bf16_f32 v70, v96, v97
  v_mfma_f32_16x16x32_bf16 v[60:63], v[28:31], a[84:87], v[60:63]
  ds_read_b128 v[28:31], v85 offset:16896
  s_waitcnt lgkmcnt(6)
  v_mfma_f32_16x16x32_bf16 v[48:51], v[32:35], a[24:27], v[48:51]
  buffer_load_dwordx4 v75, s[44:47], s58 offen offset:3072 lds
  s_add_u32 m0, m0, 4096
  v_cvt_pk_bf16_f32 v71, v98, v99
  v_mfma_f32_16x16x32_bf16 v[56:59], v[32:35], a[88:91], v[56:59]
  ds_read_b128 v[32:35], v86 offset:512
  v_mfma_f32_16x16x32_bf16 v[52:55], v[36:39], a[24:27], v[52:55]
  buffer_store_dwordx4 v[68:71], v1, s[4:7], s66 offen sc1
  buffer_store_dwordx4 v[12:15], v11, s[4:7], s61 offen sc1
  v_mfma_f32_16x16x32_bf16 v[60:63], v[36:39], a[88:91], v[60:63]
  ds_read_b128 v[36:39], v86 offset:16896
  s_waitcnt lgkmcnt(6)
  v_mfma_f32_16x16x32_bf16 v[48:51], v[40:43], a[28:31], v[48:51]
  s_add_u32 s61, s61, s63
  s_add_u32 s66, s66, s63
  s_mov_b32 s63, s68
  v_mfma_f32_16x16x32_bf16 v[56:59], v[40:43], a[92:95], v[56:59]
  ds_read_b128 v[40:43], v87 offset:512
  v_mfma_f32_16x16x32_bf16 v[52:55], v[44:47], a[28:31], v[52:55]
  v_mfma_f32_16x16x32_bf16 v[60:63], v[44:47], a[92:95], v[60:63]
  ds_read_b128 v[44:47], v87 offset:16896
  s_waitcnt lgkmcnt(6)
  v_mfma_f32_16x16x32_bf16 v[48:51], v[16:19], a[32:35], v[48:51]
  buffer_load_dwordx4 v76, s[44:47], s58 offen offset:0 lds
  v_mfma_f32_16x16x32_bf16 v[56:59], v[16:19], a[96:99], v[56:59]
  ds_read_b128 v[16:19], v84 offset:768
  v_mfma_f32_16x16x32_bf16 v[52:55], v[20:23], a[32:35], v[52:55]
  v_mfma_f32_16x16x32_bf16 v[60:63], v[20:23], a[96:99], v[60:63]
  ds_read_b128 v[20:23], v84 offset:17152
  s_waitcnt lgkmcnt(6)
  v_mfma_f32_16x16x32_bf16 v[48:51], v[24:27], a[36:39], v[48:51]
  v_mfma_f32_16x16x32_bf16 v[56:59], v[24:27], a[100:103], v[56:59]
  ds_read_b128 v[24:27], v85 offset:768
  v_mfma_f32_16x16x32_bf16 v[52:55], v[28:31], a[36:39], v[52:55]
  v_mfma_f32_16x16x32_bf16 v[60:63], v[28:31], a[100:103], v[60:63]
  ds_read_b128 v[28:31], v85 offset:17152
  s_waitcnt lgkmcnt(6)
  v_mfma_f32_16x16x32_bf16 v[48:51], v[32:35], a[40:43], v[48:51]
  buffer_load_dwordx4 v77, s[44:47], s58 offen offset:1024 lds
  v_mfma_f32_16x16x32_bf16 v[56:59], v[32:35], a[104:107], v[56:59]
  ds_read_b128 v[32:35], v86 offset:768
  v_mfma_f32_16x16x32_bf16 v[52:55], v[36:39], a[40:43], v[52:55]
  v_mfma_f32_16x16x32_bf16 v[60:63], v[36:39], a[104:107], v[60:63]
  ds_read_b128 v[36:39], v86 offset:17152
  s_waitcnt lgkmcnt(6)
  v_mfma_f32_16x16x32_bf16 v[48:51], v[40:43], a[44:47], v[48:51]
  v_mfma_f32_16x16x32_bf16 v[56:59], v[40:43], a[108:111], v[56:59]
  ds_read_b128 v[40:43], v87 offset:768
  v_mfma_f32_16x16x32_bf16 v[52:55], v[44:47], a[44:47], v[52:55]
  v_mfma_f32_16x16x32_bf16 v[60:63], v[44:47], a[108:111], v[60:63]
  ds_read_b128 v[44:47], v87 offset:17152
  s_waitcnt lgkmcnt(6)
  v_mfma_f32_16x16x32_bf16 v[48:51], v[16:19], a[48:51], v[48:51]
  buffer_load_dwordx4 v78, s[44:47], s58 offen offset:2048 lds
  s_waitcnt vmcnt(13)
  s_barrier
  v_add_u32 v84, s60, v80
  v_add_u32 v85, s60, v81
  v_add_u32 v86, s60, v82
  v_add_u32 v87, s60, v83
  s_add_u32 s60, s60, 0x8000
  s_cmp_eq_u32 s60, 0x28000
  s_cselect_b32 s60, 0, s60
  v_mfma_f32_16x16x32_bf16 v[56:59], v[16:19], a[112:115], v[56:59]
  ds_read_b128 v[16:19], v84 offset:0
  v_mfma_f32_16x16x32_bf16 v[52:55], v[20:23], a[48:51], v[52:55]
  v_mfma_f32_16x16x32_bf16 v[60:63], v[20:23], a[112:115], v[60:63]
  ds_read_b128 v[20:23], v84 offset:16384
  s_waitcnt lgkmcnt(6)
  v_mfma_f32_16x16x32_bf16 v[48:51], v[24:27], a[52:55], v[48:51]
  v_mfma_f32_16x16x32_bf16 v[56:59], v[24:27], a[116:119], v[56:59]
  ds_read_b128 v[24:27], v85 offset:0
  v_mfma_f32_16x16x32_bf16 v[52:55], v[28:31], a[52:55], v[52:55]
  s_cmp_lg_u32 s3, 0
  s_cbranch_scc1 L_pv_loop_nf0
  s_cmp_lg_u32 s57, 2
  s_cbranch_scc1 L_pv_loop_nf0
  v_mov_b32 v8, 1
  s_mov_b64 exec, 1
  buffer_store_dword v8, v6, s[4:7], s62 offen sc1
  s_mov_b64 exec, -1
L_pv_loop_nf0:
  v_mfma_f32_16x16x32_bf16 v[60:63], v[28:31], a[116:119], v[60:63]
  ds_read_b128 v[28:31], v85 offset:16384
  s_waitcnt lgkmcnt(6)
  v_mfma_f32_16x16x32_bf16 v[48:51], v[32:35], a[56:59], v[48:51]
  buffer_load_dwordx4 v79, s[44:47], s58 offen offset:3072 lds
  s_add_u32 s58, s58, s68
  s_min_u32 s58, s58, 0x1f8000
  s_add_u32 s59, s59, 0x8000
  s_cmp_eq_u32 s59, 0x28000
  s_cselect_b32 s59, 0, s59
  v_mfma_f32_16x16x32_bf16 v[56:59], v[32:35], a[120:123], v[56:59]
  ds_read_b128 v[32:35], v86 offset:0
  v_mfma_f32_16x16x32_bf16 v[52:55], v[36:39], a[56:59], v[52:55]
  v_mfma_f32_16x16x32_bf16 v[60:63], v[36:39], a[120:123], v[60:63]
  ds_read_b128 v[36:39], v86 offset:16384
  s_waitcnt lgkmcnt(6)
  v_mfma_f32_16x16x32_bf16 v[48:51], v[40:43], a[60:63], v[48:51]
  v_mfma_f32_16x16x32_bf16 v[56:59], v[40:43], a[124:127], v[56:59]
  ds_read_b128 v[40:43], v87 offset:0
  v_mfma_f32_16x16x32_bf16 v[52:55], v[44:47], a[60:63], v[52:55]
  v_mfma_f32_16x16x32_bf16 v[60:63], v[44:47], a[124:127], v[60:63]
  ds_read_b128 v[44:47], v87 offset:16384
  s_waitcnt lgkmcnt(6)
  v_mfma_f32_16x16x32_bf16 v[88:91], v[16:19], a[0:3], 0
  s_lshl_b32 s55, s3, 13
  s_add_u32 m0, s59, s55
  s_nop 0
  buffer_load_dwordx4 v72, s[44:47], s58 offen offset:0 lds
  v_mfma_f32_16x16x32_bf16 v[96:99], v[16:19], a[64:67], 0
  ds_read_b128 v[16:19], v84 offset:256
  v_mfma_f32_16x16x32_bf16 v[92:95], v[20:23], a[0:3], 0
  v_mfma_f32_16x16x32_bf16 v[100:103], v[20:23], a[64:67], 0
  ds_read_b128 v[20:23], v84 offset:16640
  s_waitcnt lgkmcnt(6)
  v_mfma_f32_16x16x32_bf16 v[88:91], v[24:27], a[4:7], v[88:91]
  v_mfma_f32_16x16x32_bf16 v[96:99], v[24:27], a[68:71], v[96:99]
  ds_read_b128 v[24:27], v85 offset:256
  v_mfma_f32_16x16x32_bf16 v[92:95], v[28:31], a[4:7], v[92:95]
  v_mfma_f32_16x16x32_bf16 v[100:103], v[28:31], a[68:71], v[100:103]
  ds_read_b128 v[28:31], v85 offset:16640
  s_waitcnt lgkmcnt(6)
  v_mfma_f32_16x16x32_bf16 v[88:91], v[32:35], a[8:11], v[88:91]
  buffer_load_dwordx4 v73, s[44:47], s58 offen offset:1024 lds
  v_cvt_pk_bf16_f32 v64, v48, v49
  v_mfma_f32_16x16x32_bf16 v[96:99], v[32:35], a[72:75], v[96:99]
  ds_read_b128 v[32:35], v86 offset:256
  v_mfma_f32_16x16x32_bf16 v[92:95], v[36:39], a[8:11], v[92:95]
  v_cvt_pk_bf16_f32 v65, v50, v51
  v_mfma_f32_16x16x32_bf16 v[100:103], v[36:39], a[72:75], v[100:103]
  ds_read_b128 v[36:39], v86 offset:16640
  s_waitcnt lgkmcnt(6)
  v_mfma_f32_16x16x32_bf16 v[88:91], v[40:43], a[12:15], v[88:91]
  v_cvt_pk_bf16_f32 v66, v52, v53
  v_mfma_f32_16x16x32_bf16 v[96:99], v[40:43], a[76:79], v[96:99]
  ds_read_b128 v[40:43], v87 offset:256
  v_mfma_f32_16x16x32_bf16 v[92:95], v[44:47], a[12:15], v[92:95]
  v_cvt_pk_bf16_f32 v67, v54, v55
  v_mfma_f32_16x16x32_bf16 v[100:103], v[44:47], a[76:79], v[100:103]
  ds_read_b128 v[44:47], v87 offset:16640
  s_waitcnt lgkmcnt(6)
  v_mfma_f32_16x16x32_bf16 v[88:91], v[16:19], a[16:19], v[88:91]
  buffer_load_dwordx4 v74, s[44:47], s58 offen offset:2048 lds
  buffer_store_dwordx4 v[64:67], v1, s[4:7], s61 offen sc1
  v_mfma_f32_16x16x32_bf16 v[96:99], v[16:19], a[80:83], v[96:99]
  ds_read_b128 v[16:19], v84 offset:512
  v_mfma_f32_16x16x32_bf16 v[92:95], v[20:23], a[16:19], v[92:95]
  v_cvt_pk_bf16_f32 v68, v60, v61
  v_mfma_f32_16x16x32_bf16 v[100:103], v[20:23], a[80:83], v[100:103]
  ds_read_b128 v[20:23], v84 offset:16896
  s_waitcnt lgkmcnt(6)
  v_mfma_f32_16x16x32_bf16 v[88:91], v[24:27], a[20:23], v[88:91]
  v_cvt_pk_bf16_f32 v69, v62, v63
  v_mfma_f32_16x16x32_bf16 v[96:99], v[24:27], a[84:87], v[96:99]
  ds_read_b128 v[24:27], v85 offset:512
  v_mfma_f32_16x16x32_bf16 v[92:95], v[28:31], a[20:23], v[92:95]
  v_cvt_pk_bf16_f32 v70, v56, v57
  v_mfma_f32_16x16x32_bf16 v[100:103], v[28:31], a[84:87], v[100:103]
  ds_read_b128 v[28:31], v85 offset:16896
  s_waitcnt lgkmcnt(6)
  v_mfma_f32_16x16x32_bf16 v[88:91], v[32:35], a[24:27], v[88:91]
  buffer_load_dwordx4 v75, s[44:47], s58 offen offset:3072 lds
  s_add_u32 m0, m0, 4096
  v_cvt_pk_bf16_f32 v71, v58, v59
  v_mfma_f32_16x16x32_bf16 v[96:99], v[32:35], a[88:91], v[96:99]
  ds_read_b128 v[32:35], v86 offset:512
  v_mfma_f32_16x16x32_bf16 v[92:95], v[36:39], a[24:27], v[92:95]
  buffer_store_dwordx4 v[68:71], v1, s[4:7], s66 offen sc1
  buffer_store_dwordx4 v[12:15], v11, s[4:7], s61 offen sc1
  v_mfma_f32_16x16x32_bf16 v[100:103], v[36:39], a[88:91], v[100:103]
  ds_read_b128 v[36:39], v86 offset:16896
  s_waitcnt lgkmcnt(6)
  v_mfma_f32_16x16x32_bf16 v[88:91], v[40:43], a[28:31], v[88:91]
  s_add_u32 s61, s61, s63
  s_add_u32 s66, s66, s63
  s_mov_b32 s63, s68
  v_mfma_f32_16x16x32_bf16 v[96:99], v[40:43], a[92:95], v[96:99]
  ds_read_b128 v[40:43], v87 offset:512
  v_mfma_f32_16x16x32_bf16 v[92:95], v[44:47], a[28:31], v[92:95]
  v_mfma_f32_16x16x32_bf16 v[100:103], v[44:47], a[92:95], v[100:103]
  ds_read_b128 v[44:47], v87 offset:16896
  s_waitcnt lgkmcnt(6)
  v_mfma_f32_16x16x32_bf16 v[88:91], v[16:19], a[32:35], v[88:91]
  buffer_load_dwordx4 v76, s[44:47], s58 offen offset:0 lds
  v_mfma_f32_16x16x32_bf16 v[96:99], v[16:19], a[96:99], v[96:99]
  ds_read_b128 v[16:19], v84 offset:768
  v_mfma_f32_16x16x32_bf16 v[92:95], v[20:23], a[32:35], v[92:95]
  v_mfma_f32_16x16x32_bf16 v[100:103], v[20:23], a[96:99], v[100:103]
  ds_read_b128 v[20:23], v84 offset:17152
  s_waitcnt lgkmcnt(6)
  v_mfma_f32_16x16x32_bf16 v[88:91], v[24:27], a[36:39], v[88:91]
  v_mfma_f32_16x16x32_bf16 v[96:99], v[24:27], a[100:103], v[96:99]
  ds_read_b128 v[24:27], v85 offset:768
  v_mfma_f32_16x16x32_bf16 v[92:95], v[28:31], a[36:39], v[92:95]
  v_mfma_f32_16x16x32_bf16 v[100:103], v[28:31], a[100:103], v[100:103]
  ds_read_b128 v[28:31], v85 offset:17152
  s_waitcnt lgkmcnt(6)
  v_mfma_f32_16x16x32_bf16 v[88:91], v[32:35], a[40:43], v[88:91]
  buffer_load_dwordx4 v77, s[44:47], s58 offen offset:1024 lds
  v_mfma_f32_16x16x32_bf16 v[96:99], v[32:35], a[104:107], v[96:99]
  ds_read_b128 v[32:35], v86 offset:768
  v_mfma_f32_16x16x32_bf16 v[92:95], v[36:39], a[40:43], v[92:95]
  v_mfma_f32_16x16x32_bf16 v[100:103], v[36:39], a[104:107], v[100:103]
  ds_read_b128 v[36:39], v86 offset:17152
  s_waitcnt lgkmcnt(6)
  v_mfma_f32_16x16x32_bf16 v[88:91], v[40:43], a[44:47], v[88:91]
  v_mfma_f32_16x16x32_bf16 v[96:99], v[40:43], a[108:111], v[96:99]
  ds_read_b128 v[40:43], v87 offset:768
  v_mfma_f32_16x16x32_bf16 v[92:95], v[44:47], a[44:47], v[92:95]
  v_mfma_f32_16x16x32_bf16 v[100:103], v[44:47], a[108:111], v[100:103]
  ds_read_b128 v[44:47], v87 offset:17152
  s_waitcnt lgkmcnt(6)
  v_mfma_f32_16x16x32_bf16 v[88:91], v[16:19], a[48:51], v[88:91]
  buffer_load_dwordx4 v78, s[44:47], s58 offen offset:2048 lds
  s_waitcnt vmcnt(13)
  s_barrier
  v_add_u32 v84, s60, v80
  v_add_u32 v85, s60, v81
  v_add_u32 v86, s60, v82
  v_add_u32 v87, s60, v83
  s_add_u32 s60, s60, 0x8000
  s_cmp_eq_u32 s60, 0x28000
  s_cselect_b32 s60, 0, s60
  v_mfma_f32_16x16x32_bf16 v[96:99], v[16:19], a[112:115], v[96:99]
  ds_read_b128 v[16:19], v84 offset:0
  v_mfma_f32_16x16x32_bf16 v[92:95], v[20:23], a[48:51], v[92:95]
  v_mfma_f32_16x16x32_bf16 v[100:103], v[20:23], a[112:115], v[100:103]
  ds_read_b128 v[20:23], v84 offset:16384
  s_waitcnt lgkmcnt(6)
  v_mfma_f32_16x16x32_bf16 v[88:91], v[24:27], a[52:55], v[88:91]
  v_mfma_f32_16x16x32_bf16 v[96:99], v[24:27], a[116:119], v[96:99]
  ds_read_b128 v[24:27], v85 offset:0
  v_mfma_f32_16x16x32_bf16 v[92:95], v[28:31], a[52:55], v[92:95]
  s_cmp_lg_u32 s3, 0
  s_cbranch_scc1 L_pv_loop_nf1
  v_mov_b32 v8, s57
  s_mov_b64 exec, 1
  buffer_store_dword v8, v6, s[4:7], s62 offen sc1
  s_mov_b64 exec, -1
L_pv_loop_nf1:
  v_mfma_f32_16x16x32_bf16 v[100:103], v[28:31], a[116:119], v[100:103]
  ds_read_b128 v[28:31], v85 offset:16384
  s_waitcnt lgkmcnt(6)
  v_mfma_f32_16x16x32_bf16 v[88:91], v[32:35], a[56:59], v[88:91]
  buffer_load_dwordx4 v79, s[44:47], s58 offen offset:3072 lds
  s_add_u32 s58, s58, s68
  s_min_u32 s58, s58, 0x1f8000
  s_add_u32 s59, s59, 0x8000
  s_cmp_eq_u32 s59, 0x28000
  s_cselect_b32 s59, 0, s59
  v_mfma_f32_16x16x32_bf16 v[96:99], v[32:35], a[120:123], v[96:99]
  ds_read_b128 v[32:35], v86 offset:0
  v_mfma_f32_16x16x32_bf16 v[92:95], v[36:39], a[56:59], v[92:95]
  v_mfma_f32_16x16x32_bf16 v[100:103], v[36:39], a[120:123], v[100:103]
  ds_read_b128 v[36:39], v86 offset:16384
  s_waitcnt lgkmcnt(6)
  v_mfma_f32_16x16x32_bf16 v[88:91], v[40:43], a[60:63], v[88:91]
  v_mfma_f32_16x16x32_bf16 v[96:99], v[40:43], a[124:127], v[96:99]
  ds_read_b128 v[40:43], v87 offset:0
  v_mfma_f32_16x16x32_bf16 v[92:95], v[44:47], a[60:63], v[92:95]
  v_mfma_f32_16x16x32_bf16 v[100:103], v[44:47], a[124:127], v[100:103]
  ds_read_b128 v[44:47], v87 offset:16384
  s_add_u32 s57, s57, 2
  s_cmp_lt_u32 s57, s69
  s_cbranch_scc1 L_pv_loop
  s_nop 3
  s_nop 7
  v_cvt_pk_bf16_f32 v64, v88, v89
  v_cvt_pk_bf16_f32 v65, v90, v91
  v_cvt_pk_bf16_f32 v66, v92, v93
  v_cvt_pk_bf16_f32 v67, v94, v95
  buffer_store_dwordx4 v[64:67], v1, s[4:7], s61 offen sc1
  v_cvt_pk_bf16_f32 v68, v100, v101
  v_cvt_pk_bf16_f32 v69, v102, v103
  v_cvt_pk_bf16_f32 v70, v96, v97
  v_cvt_pk_bf16_f32 v71, v98, v99
  buffer_store_dwordx4 v[68:71], v1, s[4:7], s66 offen sc1
  buffer_store_dwordx4 v[12:15], v11, s[4:7], s61 offen sc1
  s_add_u32 s61, s61, s63
  s_add_u32 s66, s66, s63
  s_mov_b32 s63, s68
L_p_done:
  s_waitcnt vmcnt(0) lgkmcnt(0)
  s_barrier
  s_cmp_lg_u32 s3, 0
  s_cbranch_scc1 L_p_fl
  s_cmp_eq_u32 s52, 4
  s_cselect_b32 s55, 64, 32
  v_mov_b32 v8, s55
  s_mov_b64 exec, 1
  buffer_store_dword v8, v6, s[4:7], s62 offen sc1
  s_mov_b64 exec, -1
L_p_fl:
  s_cmp_ge_u32 s52, 5
  s_cbranch_scc1 L_a_out
  s_mov_b32 s12, s32
  s_and_b32 s13, s33, 0xffff
  s_mov_b32 s14, 0x400000
  s_mov_b32 s15, 0x20000
  s_mov_b32 s44, s36
  s_and_b32 s45, s37, 0xffff
  s_mov_b32 s46, 0x400000
  s_mov_b32 s47, 0x20000
  v_lshrrev_b32 v90, 2, v0
  v_lshlrev_b32 v90, 10, v90
  v_and_b32 v13, 3, v0
  v_lshl_add_u32 v90, v13, 4, v90
  s_mul_i32 s67, s43, 1
  s_and_b32 s67, s67, 31
  s_lshl_b32 s53, s3, 3
  s_xor_b32 s67, s67, s53
  s_and_b32 s62, s43, 15
  s_lshl_b32 s62, s62, 6
  s_lshl_b32 m0, s3, 15
  s_xor_b32 s66, s67, 0
  s_lshl_b32 s66, s66, 17
  s_add_u32 s66, s66, s62
  buffer_load_dwordx4 v90, s[12:15], s66 offen lds
  s_add_u32 s66, s66, 0x4000
  s_add_u32 m0, m0, 1024
  s_nop 0
  buffer_load_dwordx4 v90, s[12:15], s66 offen lds
  s_add_u32 s66, s66, 0x4000
  s_add_u32 m0, m0, 1024
  s_nop 0
  buffer_load_dwordx4 v90, s[12:15], s66 offen lds
  s_add_u32 s66, s66, 0x4000
  s_add_u32 m0, m0, 1024
  s_nop 0
  buffer_load_dwordx4 v90, s[12:15], s66 offen lds
  s_add_u32 s66, s66, 0x4000
  s_add_u32 m0, m0, 1024
  s_nop 0
  buffer_load_dwordx4 v90, s[12:15], s66 offen lds
  s_add_u32 s66, s66, 0x4000
  s_add_u32 m0, m0, 1024
  s_nop 0
  buffer_load_dwordx4 v90, s[12:15], s66 offen lds
  s_add_u32 s66, s66, 0x4000
  s_add_u32 m0, m0, 1024
  s_nop 0
  buffer_load_dwordx4 v90, s[12:15], s66 offen lds
  s_add_u32 s66, s66, 0x4000
  s_add_u32 m0, m0, 1024
  s_nop 0
  buffer_load_dwordx4 v90, s[12:15], s66 offen lds
  s_add_u32 s66, s66, 0x4000
  s_add_u32 m0, m0, 1024
  s_xor_b32 s66, s67, 1
  s_lshl_b32 s66, s66, 17
  s_add_u32 s66, s66, s62
  buffer_load_dwordx4 v90, s[12:15], s66 offen lds
  s_add_u32 s66, s66, 0x4000
  s_add_u32 m0, m0, 1024
  s_nop 0
  buffer_load_dwordx4 v90, s[12:15], s66 offen lds
  s_add_u32 s66, s66, 0x4000
  s_add_u32 m0, m0, 1024
  s_nop 0
  buffer_load_dwordx4 v90, s[12:15], s66 offen lds
  s_add_u32 s66, s66, 0x4000
  s_add_u32 m0, m0, 1024
  s_nop 0
  buffer_load_dwordx4 v90, s[12:15], s66 offen lds
  s_add_u32 s66, s66, 0x4000
  s_add_u32 m0, m0, 1024
  s_nop 0
  buffer_load_dwordx4 v90, s[12:15], s66 offen lds
  s_add_u32 s66, s66, 0x4000
  s_add_u32 m0, m0, 1024
  s_nop 0
  buffer_load_dwordx4 v90, s[12:15], s66 offen lds
  s_add_u32 s66, s66, 0x4000
  s_add_u32 m0, m0, 1024
  s_nop 0
  buffer_load_dwordx4 v90, s[12:15], s66 offen lds
  s_add_u32 s66, s66, 0x4000
  s_add_u32 m0, m0, 1024
  s_nop 0
  buffer_load_dwordx4 v90, s[12:15], s66 offen lds
  s_add_u32 s66, s66, 0x4000
  s_add_u32 m0, m0, 1024
  s_xor_b32 s66, s67, 2
  s_lshl_b32 s66, s66, 17
  s_add_u32 s66, s66, s62
  buffer_load_dwordx4 v90, s[12:15], s66 offen lds
  s_add_u32 s66, s66, 0x4000
  s_add_u32 m0, m0, 1024
  s_nop 0
  buffer_load_dwordx4 v90, s[12:15], s66 offen lds
  s_add_u32 s66, s66, 0x4000
  s_add_u32 m0, m0, 1024
  s_nop 0
  buffer_load_dwordx4 v90, s[12:15], s66 offen lds
  s_add_u32 s66, s66, 0x4000
  s_add_u32 m0, m0, 1024
  s_nop 0
  buffer_load_dwordx4 v90, s[12:15], s66 offen lds
  s_add_u32 s66, s66, 0x4000
  s_add_u32 m0, m0, 1024
  s_nop 0
  buffer_load_dwordx4 v90, s[12:15], s66 offen lds
  s_add_u32 s66, s66, 0x4000
  s_add_u32 m0, m0, 1024
  s_nop 0
  buffer_load_dwordx4 v90, s[12:15], s66 offen lds
  s_add_u32 s66, s66, 0x4000
  s_add_u32 m0, m0, 1024
  s_nop 0
  buffer_load_dwordx4 v90, s[12:15], s66 offen lds
  s_add_u32 s66, s66, 0x4000
  s_add_u32 m0, m0, 1024
  s_nop 0
  buffer_load_dwordx4 v90, s[12:15], s66 offen lds
  s_add_u32 s66, s66, 0x4000
  s_add_u32 m0, m0, 1024
  s_xor_b32 s66, s67, 3
  s_lshl_b32 s66, s66, 17
  s_add_u32 s66, s66, s62
  buffer_load_dwordx4 v90, s[12:15], s66 offen lds
  s_add_u32 s66, s66, 0x4000
  s_add_u32 m0, m0, 1024
  s_nop 0
  buffer_load_dwordx4 v90, s[12:15], s66 offen lds
  s_add_u32 s66, s66, 0x4000
  s_add_u32 m0, m0, 1024
  s_nop 0
  buffer_load_dwordx4 v90, s[12:15], s66 offen lds
  s_add_u32 s66, s66, 0x4000
  s_add_u32 m0, m0, 1024
  s_nop 0
  buffer_load_dwordx4 v90, s[12:15], s66 offen lds
  s_add_u32 s66, s66, 0x4000
  s_add_u32 m0, m0, 1024
  s_nop 0
  buffer_load_dwordx4 v90, s[12:15], s66 offen lds
  s_add_u32 s66, s66, 0x4000
  s_add_u32 m0, m0, 1024
  s_nop 0
  buffer_load_dwordx4 v90, s[12:15], s66 offen lds
  s_add_u32 s66, s66, 0x4000
  s_add_u32 m0, m0, 1024
  s_nop 0
  buffer_load_dwordx4 v90, s[12:15], s66 offen lds
  s_add_u32 s66, s66, 0x4000
  s_add_u32 m0, m0, 1024
  s_nop 0
  buffer_load_dwordx4 v90, s[12:15], s66 offen lds
  s_add_u32 s66, s66, 0x4000
  s_add_u32 m0, m0, 1024
  s_lshl_b32 s53, s3, 15
  v_lshrrev_b32 v2, 2, v0
  v_lshlrev_b32 v2, 6, v2
  v_lshl_add_u32 v2, v13, 3, v2
  v_add_u32 v2, s53, v2
  s_and_b32 s57, s3, 1
  s_lshr_b32 s58, s3, 1
  v_and_b32 v13, 15, v0
  v_lshrrev_b32 v14, 4, v0
  v_bfe_u32 v15, v0, 4, 1
  v_bfe_u32 v112, v0, 5, 1
  v_lshlrev_b32 v3, 4, v13
  v_lshl_add_u32 v3, v112, 8, v3
  v_lshl_add_u32 v3, v15, 3, v3
  s_lshl_b32 s53, s3, 9
  s_add_u32 s53, s53, 131072
  v_add_u32 v3, s53, v3
  v_lshlrev_b32 v113, 3, v0
  s_add_u32 s53, s53, 2048
  v_add_u32 v4, s53, v113
  s_lshl_b32 s53, s58, 10
  s_add_u32 s53, s53, 133120
  v_add_u32 v88, s53, v113
  v_lshrrev_b32 v113, 2, v0
  v_lshlrev_b32 v113, 4, v113
  v_and_b32 v114, 1, v0
  v_lshl_add_u32 v113, v114, 3, v113
  v_add_u32 v5, 131072, v113
  v_lshlrev_b32 v8, 11, v13
  v_lshl_add_u32 v8, v14, 3, v8
  s_lshl_b32 s53, s3, 10
  s_add_u32 s53, s53, 139264
  v_add_u32 v10, s53, v1
  s_lshl_b32 s53, s57, 12
  s_add_u32 s53, s53, 139264
  v_add_u32 v11, s53, v1
  v_mov_b32 v9, 0xd028965f
  s_lshl_b32 s53, s57, 4
  v_lshlrev_b32 v113, 2, v14
  v_sub_u32 v113, v13, v113
  v_add_u32 v113, s53, v113
  v_cmp_gt_i32 s[68:69], 0, v113
  v_cmp_gt_i32 s[70:71], 1, v113
  v_cmp_gt_i32 s[72:73], 2, v113
  v_cmp_gt_i32 s[74:75], 3, v113
  v_cmp_gt_i32 s[76:77], 16, v113
  v_cmp_gt_i32 s[78:79], 17, v113
  v_cmp_gt_i32 s[80:81], 18, v113
  v_cmp_gt_i32 s[82:83], 19, v113
  s_mov_b32 s64, 0x3e0293ee
  s_mov_b32 s65, 0xbe0293ee
  s_lshl_b32 s53, s52, 12
  s_add_u32 s63, s53, 0x5101000
  s_mov_b32 s55, s52
  s_mov_b32 s59, -1
  s_mov_b32 s60, 1
  v_and_b32 v7, 31, v0
  v_lshlrev_b32 v7, 7, v7
  s_waitcnt vmcnt(24)
  ds_read_b64_tr_b16 a[0:1], v2 offset:0
  ds_read_b64_tr_b16 a[128:129], v2 offset:32
  ds_read_b64_tr_b16 a[2:3], v2 offset:1024
  ds_read_b64_tr_b16 a[130:131], v2 offset:1056
  ds_read_b64_tr_b16 a[4:5], v2 offset:2048
  ds_read_b64_tr_b16 a[132:133], v2 offset:2080
  ds_read_b64_tr_b16 a[6:7], v2 offset:3072
  ds_read_b64_tr_b16 a[134:135], v2 offset:3104
  ds_read_b64_tr_b16 a[8:9], v2 offset:4096
  ds_read_b64_tr_b16 a[136:137], v2 offset:4128
  ds_read_b64_tr_b16 a[10:11], v2 offset:5120
  ds_read_b64_tr_b16 a[138:139], v2 offset:5152
  ds_read_b64_tr_b16 a[12:13], v2 offset:6144
  ds_read_b64_tr_b16 a[140:141], v2 offset:6176
  ds_read_b64_tr_b16 a[14:15], v2 offset:7168
  ds_read_b64_tr_b16 a[142:143], v2 offset:7200
  s_waitcnt vmcnt(16)
  ds_read_b64_tr_b16 a[16:17], v2 offset:8192
  ds_read_b64_tr_b16 a[144:145], v2 offset:8224
  ds_read_b64_tr_b16 a[18:19], v2 offset:9216
  ds_read_b64_tr_b16 a[146:147], v2 offset:9248
  ds_read_b64_tr_b16 a[20:21], v2 offset:10240
  ds_read_b64_tr_b16 a[148:149], v2 offset:10272
  ds_read_b64_tr_b16 a[22:23], v2 offset:11264
  ds_read_b64_tr_b16 a[150:151], v2 offset:11296
  ds_read_b64_tr_b16 a[24:25], v2 offset:12288
  ds_read_b64_tr_b16 a[152:153], v2 offset:12320
  ds_read_b64_tr_b16 a[26:27], v2 offset:13312
  ds_read_b64_tr_b16 a[154:155], v2 offset:13344
  ds_read_b64_tr_b16 a[28:29], v2 offset:14336
  ds_read_b64_tr_b16 a[156:157], v2 offset:14368
  ds_read_b64_tr_b16 a[30:31], v2 offset:15360
  ds_read_b64_tr_b16 a[158:159], v2 offset:15392
  s_waitcnt vmcnt(8)
  ds_read_b64_tr_b16 a[32:33], v2 offset:16384
  ds_read_b64_tr_b16 a[160:161], v2 offset:16416
  ds_read_b64_tr_b16 a[34:35], v2 offset:17408
  ds_read_b64_tr_b16 a[162:163], v2 offset:17440
  ds_read_b64_tr_b16 a[36:37], v2 offset:18432
  ds_read_b64_tr_b16 a[164:165], v2 offset:18464
  ds_read_b64_tr_b16 a[38:39], v2 offset:19456
  ds_read_b64_tr_b16 a[166:167], v2 offset:19488
  ds_read_b64_tr_b16 a[40:41], v2 offset:20480
  ds_read_b64_tr_b16 a[168:169], v2 offset:20512
  ds_read_b64_tr_b16 a[42:43], v2 offset:21504
  ds_read_b64_tr_b16 a[170:171], v2 offset:21536
  ds_read_b64_tr_b16 a[44:45], v2 offset:22528
  ds_read_b64_tr_b16 a[172:173], v2 offset:22560
  ds_read_b64_tr_b16 a[46:47], v2 offset:23552
  ds_read_b64_tr_b16 a[174:175], v2 offset:23584
  s_waitcnt vmcnt(0)
  ds_read_b64_tr_b16 a[48:49], v2 offset:24576
  ds_read_b64_tr_b16 a[176:177], v2 offset:24608
  ds_read_b64_tr_b16 a[50:51], v2 offset:25600
  ds_read_b64_tr_b16 a[178:179], v2 offset:25632
  ds_read_b64_tr_b16 a[52:53], v2 offset:26624
  ds_read_b64_tr_b16 a[180:181], v2 offset:26656
  ds_read_b64_tr_b16 a[54:55], v2 offset:27648
  ds_read_b64_tr_b16 a[182:183], v2 offset:27680
  ds_read_b64_tr_b16 a[56:57], v2 offset:28672
  ds_read_b64_tr_b16 a[184:185], v2 offset:28704
  ds_read_b64_tr_b16 a[58:59], v2 offset:29696
  ds_read_b64_tr_b16 a[186:187], v2 offset:29728
  ds_read_b64_tr_b16 a[60:61], v2 offset:30720
  ds_read_b64_tr_b16 a[188:189], v2 offset:30752
  ds_read_b64_tr_b16 a[62:63], v2 offset:31744
  ds_read_b64_tr_b16 a[190:191], v2 offset:31776
  s_waitcnt lgkmcnt(0)
  s_lshl_b32 m0, s3, 15
  s_xor_b32 s66, s67, 4
  s_lshl_b32 s66, s66, 17
  s_add_u32 s66, s66, s62
  buffer_load_dwordx4 v90, s[12:15], s66 offen lds
  s_add_u32 s66, s66, 0x4000
  s_add_u32 m0, m0, 1024
  s_nop 0
  buffer_load_dwordx4 v90, s[12:15], s66 offen lds
  s_add_u32 s66, s66, 0x4000
  s_add_u32 m0, m0, 1024
  s_nop 0
  buffer_load_dwordx4 v90, s[12:15], s66 offen lds
  s_add_u32 s66, s66, 0x4000
  s_add_u32 m0, m0, 1024
  s_nop 0
  buffer_load_dwordx4 v90, s[12:15], s66 offen lds
  s_add_u32 s66, s66, 0x4000
  s_add_u32 m0, m0, 1024
  s_nop 0
  buffer_load_dwordx4 v90, s[12:15], s66 offen lds
  s_add_u32 s66, s66, 0x4000
  s_add_u32 m0, m0, 1024
  s_nop 0
  buffer_load_dwordx4 v90, s[12:15], s66 offen lds
  s_add_u32 s66, s66, 0x4000
  s_add_u32 m0, m0, 1024
  s_nop 0
  buffer_load_dwordx4 v90, s[12:15], s66 offen lds
  s_add_u32 s66, s66, 0x4000
  s_add_u32 m0, m0, 1024
  s_nop 0
  buffer_load_dwordx4 v90, s[12:15], s66 offen lds
  s_add_u32 s66, s66, 0x4000
  s_add_u32 m0, m0, 1024
  s_xor_b32 s66, s67, 5
  s_lshl_b32 s66, s66, 17
  s_add_u32 s66, s66, s62
  buffer_load_dwordx4 v90, s[12:15], s66 offen lds
  s_add_u32 s66, s66, 0x4000
  s_add_u32 m0, m0, 1024
  s_nop 0
  buffer_load_dwordx4 v90, s[12:15], s66 offen lds
  s_add_u32 s66, s66, 0x4000
  s_add_u32 m0, m0, 1024
  s_nop 0
  buffer_load_dwordx4 v90, s[12:15], s66 offen lds
  s_add_u32 s66, s66, 0x4000
  s_add_u32 m0, m0, 1024
  s_nop 0
  buffer_load_dwordx4 v90, s[12:15], s66 offen lds
  s_add_u32 s66, s66, 0x4000
  s_add_u32 m0, m0, 1024
  s_nop 0
  buffer_load_dwordx4 v90, s[12:15], s66 offen lds
  s_add_u32 s66, s66, 0x4000
  s_add_u32 m0, m0, 1024
  s_nop 0
  buffer_load_dwordx4 v90, s[12:15], s66 offen lds
  s_add_u32 s66, s66, 0x4000
  s_add_u32 m0, m0, 1024
  s_nop 0
  buffer_load_dwordx4 v90, s[12:15], s66 offen lds
  s_add_u32 s66, s66, 0x4000
  s_add_u32 m0, m0, 1024
  s_nop 0
  buffer_load_dwordx4 v90, s[12:15], s66 offen lds
  s_add_u32 s66, s66, 0x4000
  s_add_u32 m0, m0, 1024
  s_xor_b32 s66, s67, 6
  s_lshl_b32 s66, s66, 17
  s_add_u32 s66, s66, s62
  buffer_load_dwordx4 v90, s[12:15], s66 offen lds
  s_add_u32 s66, s66, 0x4000
  s_add_u32 m0, m0, 1024
  s_nop 0
  buffer_load_dwordx4 v90, s[12:15], s66 offen lds
  s_add_u32 s66, s66, 0x4000
  s_add_u32 m0, m0, 1024
  s_nop 0
  buffer_load_dwordx4 v90, s[12:15], s66 offen lds
  s_add_u32 s66, s66, 0x4000
  s_add_u32 m0, m0, 1024
  s_nop 0
  buffer_load_dwordx4 v90, s[12:15], s66 offen lds
  s_add_u32 s66, s66, 0x4000
  s_add_u32 m0, m0, 1024
  s_nop 0
  buffer_load_dwordx4 v90, s[12:15], s66 offen lds
  s_add_u32 s66, s66, 0x4000
  s_add_u32 m0, m0, 1024
  s_nop 0
  buffer_load_dwordx4 v90, s[12:15], s66 offen lds
  s_add_u32 s66, s66, 0x4000
  s_add_u32 m0, m0, 1024
  s_nop 0
  buffer_load_dwordx4 v90, s[12:15], s66 offen lds
  s_add_u32 s66, s66, 0x4000
  s_add_u32 m0, m0, 1024
  s_nop 0
  buffer_load_dwordx4 v90, s[12:15], s66 offen lds
  s_add_u32 s66, s66, 0x4000
  s_add_u32 m0, m0, 1024
  s_xor_b32 s66, s67, 7
  s_lshl_b32 s66, s66, 17
  s_add_u32 s66, s66, s62
  buffer_load_dwordx4 v90, s[12:15], s66 offen lds
  s_add_u32 s66, s66, 0x4000
  s_add_u32 m0, m0, 1024
  s_nop 0
  buffer_load_dwordx4 v90, s[12:15], s66 offen lds
  s_add_u32 s66, s66, 0x4000
  s_add_u32 m0, m0, 1024
  s_nop 0
  buffer_load_dwordx4 v90, s[12:15], s66 offen lds
  s_add_u32 s66, s66, 0x4000
  s_add_u32 m0, m0, 1024
  s_nop 0
  buffer_load_dwordx4 v90, s[12:15], s66 offen lds
  s_add_u32 s66, s66, 0x4000
  s_add_u32 m0, m0, 1024
  s_nop 0
  buffer_load_dwordx4 v90, s[12:15], s66 offen lds
  s_add_u32 s66, s66, 0x4000
  s_add_u32 m0, m0, 1024
  s_nop 0
  buffer_load_dwordx4 v90, s[12:15], s66 offen lds
  s_add_u32 s66, s66, 0x4000
  s_add_u32 m0, m0, 1024
  s_nop 0
  buffer_load_dwordx4 v90, s[12:15], s66 offen lds
  s_add_u32 s66, s66, 0x4000
  s_add_u32 m0, m0, 1024
  s_nop 0
  buffer_load_dwordx4 v90, s[12:15], s66 offen lds
  s_add_u32 s66, s66, 0x4000
  s_add_u32 m0, m0, 1024
  s_waitcnt vmcnt(24)
  ds_read_b64_tr_b16 a[64:65], v2 offset:0
  ds_read_b64_tr_b16 a[192:193], v2 offset:32
  ds_read_b64_tr_b16 a[66:67], v2 offset:1024
  ds_read_b64_tr_b16 a[194:195], v2 offset:1056
  ds_read_b64_tr_b16 a[68:69], v2 offset:2048
  ds_read_b64_tr_b16 a[196:197], v2 offset:2080
  ds_read_b64_tr_b16 a[70:71], v2 offset:3072
  ds_read_b64_tr_b16 a[198:199], v2 offset:3104
  ds_read_b64_tr_b16 a[72:73], v2 offset:4096
  ds_read_b64_tr_b16 a[200:201], v2 offset:4128
  ds_read_b64_tr_b16 a[74:75], v2 offset:5120
  ds_read_b64_tr_b16 a[202:203], v2 offset:5152
  ds_read_b64_tr_b16 a[76:77], v2 offset:6144
  ds_read_b64_tr_b16 a[204:205], v2 offset:6176
  ds_read_b64_tr_b16 a[78:79], v2 offset:7168
  ds_read_b64_tr_b16 a[206:207], v2 offset:7200
  s_waitcnt vmcnt(16)
  ds_read_b64_tr_b16 a[80:81], v2 offset:8192
  ds_read_b64_tr_b16 a[208:209], v2 offset:8224
  ds_read_b64_tr_b16 a[82:83], v2 offset:9216
  ds_read_b64_tr_b16 a[210:211], v2 offset:9248
  ds_read_b64_tr_b16 a[84:85], v2 offset:10240
  ds_read_b64_tr_b16 a[212:213], v2 offset:10272
  ds_read_b64_tr_b16 a[86:87], v2 offset:11264
  ds_read_b64_tr_b16 a[214:215], v2 offset:11296
  ds_read_b64_tr_b16 a[88:89], v2 offset:12288
  ds_read_b64_tr_b16 a[216:217], v2 offset:12320
  ds_read_b64_tr_b16 a[90:91], v2 offset:13312
  ds_read_b64_tr_b16 a[218:219], v2 offset:13344
  ds_read_b64_tr_b16 a[92:93], v2 offset:14336
  ds_read_b64_tr_b16 a[220:221], v2 offset:14368
  ds_read_b64_tr_b16 a[94:95], v2 offset:15360
  ds_read_b64_tr_b16 a[222:223], v2 offset:15392
  s_waitcnt vmcnt(8)
  ds_read_b64_tr_b16 a[96:97], v2 offset:16384
  ds_read_b64_tr_b16 a[224:225], v2 offset:16416
  ds_read_b64_tr_b16 a[98:99], v2 offset:17408
  ds_read_b64_tr_b16 a[226:227], v2 offset:17440
  ds_read_b64_tr_b16 a[100:101], v2 offset:18432
  ds_read_b64_tr_b16 a[228:229], v2 offset:18464
  ds_read_b64_tr_b16 a[102:103], v2 offset:19456
  ds_read_b64_tr_b16 a[230:231], v2 offset:19488
  ds_read_b64_tr_b16 a[104:105], v2 offset:20480
  ds_read_b64_tr_b16 a[232:233], v2 offset:20512
  ds_read_b64_tr_b16 a[106:107], v2 offset:21504
  ds_read_b64_tr_b16 a[234:235], v2 offset:21536
  ds_read_b64_tr_b16 a[108:109], v2 offset:22528
  ds_read_b64_tr_b16 a[236:237], v2 offset:22560
  ds_read_b64_tr_b16 a[110:111], v2 offset:23552
  ds_read_b64_tr_b16 a[238:239], v2 offset:23584
  s_waitcnt vmcnt(0)
  ds_read_b64_tr_b16 a[112:113], v2 offset:24576
  ds_read_b64_tr_b16 a[240:241], v2 offset:24608
  ds_read_b64_tr_b16 a[114:115], v2 offset:25600
  ds_read_b64_tr_b16 a[242:243], v2 offset:25632
  ds_read_b64_tr_b16 a[116:117], v2 offset:26624
  ds_read_b64_tr_b16 a[244:245], v2 offset:26656
  ds_read_b64_tr_b16 a[118:119], v2 offset:27648
  ds_read_b64_tr_b16 a[246:247], v2 offset:27680
  ds_read_b64_tr_b16 a[120:121], v2 offset:28672
  ds_read_b64_tr_b16 a[248:249], v2 offset:28704
  ds_read_b64_tr_b16 a[122:123], v2 offset:29696
  ds_read_b64_tr_b16 a[250:251], v2 offset:29728
  ds_read_b64_tr_b16 a[124:125], v2 offset:30720
  ds_read_b64_tr_b16 a[252:253], v2 offset:30752
  ds_read_b64_tr_b16 a[126:127], v2 offset:31744
  ds_read_b64_tr_b16 a[254:255], v2 offset:31776
  s_waitcnt lgkmcnt(0)
  s_cmp_lg_u32 s3, 0
  s_cbranch_scc1 L_a_iw_ok
  s_mov_b32 s61, 0
L_a_iw:
  buffer_load_dword v12, v6, s[8:11], 0 offen sc1
  s_waitcnt vmcnt(0)
  v_cmp_gt_u32 vcc, 192, v12
  s_cbranch_vccz L_a_iw_ok
  s_sleep 8
  s_add_u32 s61, s61, 1
  s_cmp_lt_u32 s61, 0x200000
  s_cbranch_scc1 L_a_iw
L_a_iw_ok:
  s_barrier
  buffer_load_dword v12, v7, s[4:7], s63 offen offset:4 sc1
  s_waitcnt vmcnt(0)
  v_readfirstlane_b32 s53, v12
  s_nop 1
  v_cmp_ne_u32 vcc, s53, v12
  s_mov_b32 s59, vcc_lo
  v_min_u32 v113, 4, v0
  v_lshrrev_b32 v114, 2, v113
  v_add_u32 v113, v113, v114
  v_lshlrev_b32 v113, 7, v113
  s_lshl_b32 s56, s43, 21
  s_add_u32 s56, s56, 0xf000
  v_add_u32 v7, s63, v7
  s_add_u32 s53, s56, 512
  s_mov_b32 exec_lo, 0
  v_mov_b32 v7, s53
  s_mov_b32 exec_lo, -1
  s_cmp_lg_u32 s3, 0
  s_cbranch_scc1 L_a_gw_ok
  s_mov_b32 s61, 0
L_a_gw:
  buffer_load_dword v12, v113, s[4:7], s56 offen sc1
  s_waitcnt vmcnt(0)
  v_cmp_gt_u32 vcc, 32, v12
  s_cbranch_vccz L_a_gw_ok
  s_sleep 4
  s_add_u32 s61, s61, 1
  s_cmp_lt_u32 s61, 0x200000
  s_cbranch_scc1 L_a_gw
L_a_gw_ok:
  s_barrier
  s_cmp_eq_u32 s52, 4
  s_cselect_b32 s55, 20, s55
  s_lshl_b32 s56, s43, 6
  s_add_u32 s56, s56, s55
  s_lshl_b32 s56, s56, 15
  s_lshl_b32 s53, s57, 12
  s_add_u32 s53, s53, s56
  buffer_load_dwordx4 v[16:19], v1, s[4:7], s53 offen offset:0 sc1
  buffer_load_dwordx4 v[20:23], v1, s[4:7], s53 offen offset:1024 sc1
  buffer_load_dwordx4 v[24:27], v1, s[4:7], s53 offen offset:2048 sc1
  buffer_load_dwordx4 v[28:31], v1, s[4:7], s53 offen offset:3072 sc1
  s_add_u32 s53, s56, 0x2000
  buffer_load_dwordx4 v[32:35], v1, s[4:7], s53 offen offset:0 sc1
  buffer_load_dwordx4 v[36:39], v1, s[4:7], s53 offen offset:1024 sc1
  buffer_load_dwordx4 v[40:43], v1, s[4:7], s53 offen offset:2048 sc1
  buffer_load_dwordx4 v[44:47], v1, s[4:7], s53 offen offset:3072 sc1
  s_add_u32 s53, s56, 0x3000
  buffer_load_dwordx4 v[48:51], v1, s[4:7], s53 offen offset:0 sc1
  buffer_load_dwordx4 v[52:55], v1, s[4:7], s53 offen offset:1024 sc1
  buffer_load_dwordx4 v[56:59], v1, s[4:7], s53 offen offset:2048 sc1
  buffer_load_dwordx4 v[60:63], v1, s[4:7], s53 offen offset:3072 sc1
  s_lshl_b32 s53, s58, 12
  s_add_u32 s53, s53, s56
  s_add_u32 s53, s53, 0x4000
  buffer_load_dwordx4 v[64:67], v1, s[4:7], s53 offen offset:0 sc1
  buffer_load_dwordx4 v[68:71], v1, s[4:7], s53 offen offset:1024 sc1
  buffer_load_dwordx4 v[72:75], v1, s[4:7], s53 offen offset:2048 sc1
  buffer_load_dwordx4 v[76:79], v1, s[4:7], s53 offen offset:3072 sc1
L_a_loop:
  s_cmp_lt_u32 s55, 16
  s_cselect_b32 s62, 4, 5
  s_add_u32 s62, s62, s55
  s_waitcnt vmcnt(4)
  v_mfma_f32_16x16x32_bf16 v[112:115], v[32:35], v[16:19], 0
  v_mfma_f32_16x16x32_bf16 v[116:119], v[48:51], v[16:19], 0
  v_mfma_f32_16x16x32_bf16 v[112:115], v[36:39], v[20:23], v[112:115]
  v_mfma_f32_16x16x32_bf16 v[116:119], v[52:55], v[20:23], v[116:119]
  v_mfma_f32_16x16x32_bf16 v[112:115], v[40:43], v[24:27], v[112:115]
  v_mfma_f32_16x16x32_bf16 v[116:119], v[56:59], v[24:27], v[116:119]
  v_mfma_f32_16x16x32_bf16 v[112:115], v[44:47], v[28:31], v[112:115]
  v_mfma_f32_16x16x32_bf16 v[116:119], v[60:63], v[28:31], v[116:119]
  s_nop 6
  v_cndmask_b32 v112, v112, v9, s[68:69]
  v_cndmask_b32 v113, v113, v9, s[70:71]
  v_cndmask_b32 v114, v114, v9, s[72:73]
  v_cndmask_b32 v115, v115, v9, s[74:75]
  v_cndmask_b32 v116, v116, v9, s[76:77]
  v_cndmask_b32 v117, v117, v9, s[78:79]
  v_cndmask_b32 v118, v118, v9, s[80:81]
  v_cndmask_b32 v119, v119, v9, s[82:83]
  v_max3_f32 v160, v112, v113, v114
  v_max3_f32 v160, v160, v115, v116
  v_max3_f32 v160, v160, v117, v118
  v_max_f32 v160, v160, v119
  v_mov_b32 v131, 0
  v_mov_b32 v132, 0
  s_lshl_b32 s53, s3, 10
  s_add_u32 s66, s56, s53
  s_add_u32 s66, s66, 0x6000
  s_mov_b32 s61, 0
  s_cmp_ge_u32 s55, 63
  s_cbranch_scc1 L_a_cw
  s_cmp_lg_u32 s3, 3
  s_cbranch_scc1 L_a_pw_ok
L_a_pw:
  buffer_load_dword v12, v6, s[4:7], s66 offen offset:1008 sc1
  s_waitcnt vmcnt(0)
  v_cmp_eq_u32 vcc, -1, v12
  s_cbranch_vccz L_a_pw_ok
  s_sleep 2
  s_add_u32 s61, s61, 1
  s_cmp_lt_u32 s61, 0x200000
  s_cbranch_scc1 L_a_pw
L_a_pw_ok:
  s_barrier
L_a_cw:
  buffer_load_dwordx4 v[80:83], v1, s[4:7], s66 offen sc1
  s_waitcnt vmcnt(0)
  v_cmp_eq_u32 vcc, -1, v80
  s_cbranch_vccz L_a_cw_ok
  s_sleep 1
  s_add_u32 s61, s61, 1
  s_cmp_lt_u32 s61, 0x200000
  s_cbranch_scc1 L_a_cw
L_a_cw_ok:
  ds_write_b64 v3, v[80:81]
  ds_write_b64 v4, v[82:83]
  s_waitcnt lgkmcnt(0)
  s_barrier
  ds_read_b64 v[82:83], v88 offset:0
  ds_read_b64 v[86:87], v88 offset:512
  ds_read_b64_tr_b16 v[96:97], v5 offset:0
  ds_read_b64_tr_b16 v[98:99], v5 offset:256
  ds_read_b64_tr_b16 v[100:101], v5 offset:512
  ds_read_b64_tr_b16 v[102:103], v5 offset:768
  ds_read_b64_tr_b16 v[104:105], v5 offset:1024
  ds_read_b64_tr_b16 v[106:107], v5 offset:1280
  ds_read_b64_tr_b16 v[108:109], v5 offset:1536
  ds_read_b64_tr_b16 v[110:111], v5 offset:1792
  s_waitcnt lgkmcnt(6)
  v_mfma_f32_16x16x32_bf16 v[120:123], v[96:99], v[16:19], 0
  s_waitcnt lgkmcnt(4)
  v_mfma_f32_16x16x32_bf16 v[120:123], v[100:103], v[20:23], v[120:123]
  s_waitcnt lgkmcnt(2)
  v_mfma_f32_16x16x32_bf16 v[120:123], v[104:107], v[24:27], v[120:123]
  s_waitcnt lgkmcnt(0)
  v_mfma_f32_16x16x32_bf16 v[120:123], v[108:111], v[28:31], v[120:123]
  s_nop 7
  v_mov_b32_dpp v120, v122 quad_perm:[0,1,2,3] row_mask:0xc bank_mask:0xf
  v_mov_b32_dpp v121, v123 quad_perm:[0,1,2,3] row_mask:0xc bank_mask:0xf
  v_max3_f32 v160, v160, v120, v121
  v_mov_b32 v162, v160
  v_mov_b32 v163, v160
  s_nop 1
  v_permlane32_swap_b32 v162, v163
  v_max_f32 v164, v162, v163
  v_max_f32 v165, v162, v163
  s_nop 1
  v_permlane16_swap_b32 v164, v165
  v_max_f32 v162, v164, v165
  v_mul_f32 v160, s65, v162
  v_fma_f32 v112, v112, s64, v160
  v_fma_f32 v113, v113, s64, v160
  v_fma_f32 v114, v114, s64, v160
  v_fma_f32 v115, v115, s64, v160
  v_fma_f32 v116, v116, s64, v160
  v_fma_f32 v117, v117, s64, v160
  v_fma_f32 v118, v118, s64, v160
  v_fma_f32 v119, v119, s64, v160
  v_fma_f32 v120, v120, s64, v160
  v_fma_f32 v121, v121, s64, v160
  v_exp_f32 v112, v112
  v_exp_f32 v113, v113
  v_exp_f32 v114, v114
  v_exp_f32 v115, v115
  v_exp_f32 v116, v116
  v_exp_f32 v117, v117
  v_exp_f32 v118, v118
  v_exp_f32 v119, v119
  v_exp_f32 v120, v120
  v_exp_f32 v121, v121
  v_cvt_pk_bf16_f32 v124, v112, v113
  v_cvt_pk_bf16_f32 v125, v114, v115
  v_cvt_pk_bf16_f32 v126, v116, v117
  v_cvt_pk_bf16_f32 v127, v118, v119
  v_cvt_pk_bf16_f32 v128, v112, v113
  v_cvt_pk_bf16_f32 v129, v114, v115
  v_cvt_pk_bf16_f32 v130, v120, v121
  v_cvt_pk_bf16_f32 v133, v121, v120
  v_mfma_f32_16x16x32_bf16 v[136:139], v[64:67], v[124:127], 0
  v_mfma_f32_16x16x32_bf16 v[140:143], v[68:71], v[126:129], 0
  v_mfma_f32_16x16x32_bf16 v[144:147], v[72:75], v[124:127], 0
  v_mfma_f32_16x16x32_bf16 v[148:151], v[76:79], v[126:129], 0
  v_mfma_f32_16x16x16_bf16 v[136:139], v[82:83], v[130:131], v[136:139]
  v_mfma_f32_16x16x16_bf16 v[140:143], v[82:83], v[132:133], v[140:143]
  v_mfma_f32_16x16x16_bf16 v[144:147], v[86:87], v[130:131], v[144:147]
  v_mfma_f32_16x16x16_bf16 v[148:151], v[86:87], v[132:133], v[148:151]
  v_add_f32 v160, v112, v113
  v_add_f32 v160, v160, v114
  v_add_f32 v160, v160, v115
  v_add_f32 v160, v160, v116
  v_add_f32 v160, v160, v117
  v_add_f32 v160, v160, v118
  v_add_f32 v160, v160, v119
  v_add_f32 v160, v160, v120
  v_add_f32 v160, v160, v121
  v_mov_b32 v162, v160
  v_mov_b32 v163, v160
  s_nop 1
  v_permlane32_swap_b32 v162, v163
  v_add_f32 v164, v162, v163
  v_add_f32 v165, v162, v163
  s_nop 1
  v_permlane16_swap_b32 v164, v165
  v_add_f32 v162, v164, v165
  v_rcp_f32 v162, v162
  s_nop 0
  v_mul_f32 v136, v136, v162
  v_mul_f32 v137, v137, v162
  v_mul_f32 v138, v138, v162
  v_mul_f32 v139, v139, v162
  v_mul_f32 v140, v140, v162
  v_mul_f32 v141, v141, v162
  v_mul_f32 v142, v142, v162
  v_mul_f32 v143, v143, v162
  v_mul_f32 v144, v144, v162
  v_mul_f32 v145, v145, v162
  v_mul_f32 v146, v146, v162
  v_mul_f32 v147, v147, v162
  v_mul_f32 v148, v148, v162
  v_mul_f32 v149, v149, v162
  v_mul_f32 v150, v150, v162
  v_mul_f32 v151, v151, v162
  v_cvt_pk_bf16_f32 v152, v136, v137
  v_cvt_pk_bf16_f32 v153, v138, v139
  v_cvt_pk_bf16_f32 v154, v140, v141
  v_cvt_pk_bf16_f32 v155, v142, v143
  v_cvt_pk_bf16_f32 v156, v144, v145
  v_cvt_pk_bf16_f32 v157, v146, v147
  v_cvt_pk_bf16_f32 v158, v148, v149
  v_cvt_pk_bf16_f32 v159, v150, v151
  s_lshl_b32 s53, s57, 12
  s_lshl_b32 s54, s58, 11
  s_add_u32 s53, s53, s54
  s_add_u32 s53, s53, 0x4000000
  s_lshl_b32 s54, s55, 5
  s_add_u32 s54, s54, s43
  s_lshl_b32 s54, s54, 13
  s_add_u32 s53, s53, s54
  s_cmp_lg_u32 s59, 0
  s_cbranch_scc1 L_a_s1
  buffer_store_dwordx4 v[152:155], v1, s[4:7], s53 offen offset:0
  buffer_store_dwordx4 v[156:159], v1, s[4:7], s53 offen offset:1024
  s_branch L_a_s2
L_a_s1:
  buffer_store_dwordx4 v[152:155], v1, s[4:7], s53 offen offset:0 sc1
  buffer_store_dwordx4 v[156:159], v1, s[4:7], s53 offen offset:1024 sc1
L_a_s2:
  s_waitcnt vmcnt(0)
  s_barrier
  s_cmp_lg_u32 s3, 0
  s_cbranch_scc1 L_a_nf
  v_mov_b32 v12, s60
  s_lshl_b32 s53, s43, 7
  s_add_u32 s53, s53, s63
  s_mov_b64 exec, 1
  s_cmp_lg_u32 s59, 0
  s_cbranch_scc1 L_a_f1
  buffer_store_dword v12, v6, s[4:7], s53 offen
  s_branch L_a_f2
L_a_f1:
  buffer_store_dword v12, v6, s[4:7], s53 offen sc1
L_a_f2:
  s_mov_b64 exec, -1
L_a_nf:
  s_add_u32 s53, s62, -11
  s_max_i32 s53, s53, 0
  v_mov_b32 v13, s53
  s_mov_b32 exec_hi, 0
  v_mov_b32 v13, s60
  s_mov_b32 exec_hi, -1
  s_cmp_lg_u32 s3, 0
  s_cbranch_scc1 L_a_ow_ok
  s_mov_b32 s61, 0
L_a_ow:
  buffer_load_dword v12, v7, s[4:7], 0 offen sc1
  s_waitcnt vmcnt(0)
  v_cmp_gt_u32 vcc, v13, v12
  s_cbranch_vccz L_a_ow_ok
  s_sleep 0
  s_add_u32 s61, s61, 1
  s_cmp_lt_u32 s61, 0x200000
  s_cbranch_scc1 L_a_ow
L_a_ow_ok:
  s_barrier
  s_lshl_b32 s66, s55, 18
  s_add_u32 s66, s66, 0x4000000
  s_lshr_b32 s53, s43, 4
  s_lshl_b32 s53, s53, 12
  s_add_u32 s66, s66, s53
  s_xor_b32 s53, s67, 0
  s_lshl_b32 s53, s53, 13
  s_add_u32 s53, s53, s66
  buffer_load_dwordx4 v[128:131], v1, s[4:7], s53 offen offset:0 sc1
  buffer_load_dwordx4 v[132:135], v1, s[4:7], s53 offen offset:1024 sc1
  buffer_load_dwordx4 v[136:139], v1, s[4:7], s53 offen offset:2048 sc1
  buffer_load_dwordx4 v[140:143], v1, s[4:7], s53 offen offset:3072 sc1
  s_xor_b32 s53, s67, 1
  s_lshl_b32 s53, s53, 13
  s_add_u32 s53, s53, s66
  buffer_load_dwordx4 v[144:147], v1, s[4:7], s53 offen offset:0 sc1
  buffer_load_dwordx4 v[148:151], v1, s[4:7], s53 offen offset:1024 sc1
  buffer_load_dwordx4 v[152:155], v1, s[4:7], s53 offen offset:2048 sc1
  buffer_load_dwordx4 v[156:159], v1, s[4:7], s53 offen offset:3072 sc1
  s_xor_b32 s53, s67, 2
  s_lshl_b32 s53, s53, 13
  s_add_u32 s53, s53, s66
  buffer_load_dwordx4 v[160:163], v1, s[4:7], s53 offen offset:0 sc1
  buffer_load_dwordx4 v[164:167], v1, s[4:7], s53 offen offset:1024 sc1
  buffer_load_dwordx4 v[168:171], v1, s[4:7], s53 offen offset:2048 sc1
  buffer_load_dwordx4 v[172:175], v1, s[4:7], s53 offen offset:3072 sc1
  s_xor_b32 s53, s67, 3
  s_lshl_b32 s53, s53, 13
  s_add_u32 s53, s53, s66
  buffer_load_dwordx4 v[176:179], v1, s[4:7], s53 offen offset:0 sc1
  buffer_load_dwordx4 v[180:183], v1, s[4:7], s53 offen offset:1024 sc1
  buffer_load_dwordx4 v[184:187], v1, s[4:7], s53 offen offset:2048 sc1
  buffer_load_dwordx4 v[188:191], v1, s[4:7], s53 offen offset:3072 sc1
  s_xor_b32 s53, s67, 4
  s_lshl_b32 s53, s53, 13
  s_add_u32 s53, s53, s66
  buffer_load_dwordx4 v[192:195], v1, s[4:7], s53 offen offset:0 sc1
  buffer_load_dwordx4 v[196:199], v1, s[4:7], s53 offen offset:1024 sc1
  buffer_load_dwordx4 v[200:203], v1, s[4:7], s53 offen offset:2048 sc1
  buffer_load_dwordx4 v[204:207], v1, s[4:7], s53 offen offset:3072 sc1
  s_xor_b32 s53, s67, 5
  s_lshl_b32 s53, s53, 13
  s_add_u32 s53, s53, s66
  buffer_load_dwordx4 v[208:211], v1, s[4:7], s53 offen offset:0 sc1
  buffer_load_dwordx4 v[212:215], v1, s[4:7], s53 offen offset:1024 sc1
  buffer_load_dwordx4 v[216:219], v1, s[4:7], s53 offen offset:2048 sc1
  buffer_load_dwordx4 v[220:223], v1, s[4:7], s53 offen offset:3072 sc1
  s_xor_b32 s53, s67, 6
  s_lshl_b32 s53, s53, 13
  s_add_u32 s53, s53, s66
  buffer_load_dwordx4 v[224:227], v1, s[4:7], s53 offen offset:0 sc1
  buffer_load_dwordx4 v[228:231], v1, s[4:7], s53 offen offset:1024 sc1
  buffer_load_dwordx4 v[232:235], v1, s[4:7], s53 offen offset:2048 sc1
  buffer_load_dwordx4 v[236:239], v1, s[4:7], s53 offen offset:3072 sc1
  s_xor_b32 s53, s67, 7
  s_lshl_b32 s53, s53, 13
  s_add_u32 s53, s53, s66
  buffer_load_dwordx4 v[240:243], v1, s[4:7], s53 offen offset:0 sc1
  buffer_load_dwordx4 v[244:247], v1, s[4:7], s53 offen offset:1024 sc1
  buffer_load_dwordx4 v[248:251], v1, s[4:7], s53 offen offset:2048 sc1
  buffer_load_dwordx4 v[252:255], v1, s[4:7], s53 offen offset:3072 sc1
  s_waitcnt vmcnt(30)
  v_mfma_f32_16x16x32_bf16 v[112:115], a[0:3], v[128:131], 0
  v_mfma_f32_16x16x32_bf16 v[120:123], a[128:131], v[128:131], 0
  v_mfma_f32_16x16x32_bf16 v[116:119], a[4:7], v[132:135], 0
  v_mfma_f32_16x16x32_bf16 v[124:127], a[132:135], v[132:135], 0
  s_waitcnt vmcnt(28)
  v_mfma_f32_16x16x32_bf16 v[112:115], a[8:11], v[136:139], v[112:115]
  v_mfma_f32_16x16x32_bf16 v[120:123], a[136:139], v[136:139], v[120:123]
  v_mfma_f32_16x16x32_bf16 v[116:119], a[12:15], v[140:143], v[116:119]
  v_mfma_f32_16x16x32_bf16 v[124:127], a[140:143], v[140:143], v[124:127]
  s_waitcnt vmcnt(26)
  v_mfma_f32_16x16x32_bf16 v[112:115], a[16:19], v[144:147], v[112:115]
  v_mfma_f32_16x16x32_bf16 v[120:123], a[144:147], v[144:147], v[120:123]
  v_mfma_f32_16x16x32_bf16 v[116:119], a[20:23], v[148:151], v[116:119]
  v_mfma_f32_16x16x32_bf16 v[124:127], a[148:151], v[148:151], v[124:127]
  s_waitcnt vmcnt(24)
  v_mfma_f32_16x16x32_bf16 v[112:115], a[24:27], v[152:155], v[112:115]
  v_mfma_f32_16x16x32_bf16 v[120:123], a[152:155], v[152:155], v[120:123]
  v_mfma_f32_16x16x32_bf16 v[116:119], a[28:31], v[156:159], v[116:119]
  v_mfma_f32_16x16x32_bf16 v[124:127], a[156:159], v[156:159], v[124:127]
  s_waitcnt vmcnt(22)
  v_mfma_f32_16x16x32_bf16 v[112:115], a[32:35], v[160:163], v[112:115]
  v_mfma_f32_16x16x32_bf16 v[120:123], a[160:163], v[160:163], v[120:123]
  v_mfma_f32_16x16x32_bf16 v[116:119], a[36:39], v[164:167], v[116:119]
  v_mfma_f32_16x16x32_bf16 v[124:127], a[164:167], v[164:167], v[124:127]
  s_waitcnt vmcnt(20)
  v_mfma_f32_16x16x32_bf16 v[112:115], a[40:43], v[168:171], v[112:115]
  v_mfma_f32_16x16x32_bf16 v[120:123], a[168:171], v[168:171], v[120:123]
  v_mfma_f32_16x16x32_bf16 v[116:119], a[44:47], v[172:175], v[116:119]
  v_mfma_f32_16x16x32_bf16 v[124:127], a[172:175], v[172:175], v[124:127]
  s_waitcnt vmcnt(18)
  v_mfma_f32_16x16x32_bf16 v[112:115], a[48:51], v[176:179], v[112:115]
  v_mfma_f32_16x16x32_bf16 v[120:123], a[176:179], v[176:179], v[120:123]
  v_mfma_f32_16x16x32_bf16 v[116:119], a[52:55], v[180:183], v[116:119]
  v_mfma_f32_16x16x32_bf16 v[124:127], a[180:183], v[180:183], v[124:127]
  s_waitcnt vmcnt(16)
  v_mfma_f32_16x16x32_bf16 v[112:115], a[56:59], v[184:187], v[112:115]
  v_mfma_f32_16x16x32_bf16 v[120:123], a[184:187], v[184:187], v[120:123]
  v_mfma_f32_16x16x32_bf16 v[116:119], a[60:63], v[188:191], v[116:119]
  v_mfma_f32_16x16x32_bf16 v[124:127], a[188:191], v[188:191], v[124:127]
  s_waitcnt vmcnt(14)
  v_mfma_f32_16x16x32_bf16 v[112:115], a[64:67], v[192:195], v[112:115]
  v_mfma_f32_16x16x32_bf16 v[120:123], a[192:195], v[192:195], v[120:123]
  v_mfma_f32_16x16x32_bf16 v[116:119], a[68:71], v[196:199], v[116:119]
  v_mfma_f32_16x16x32_bf16 v[124:127], a[196:199], v[196:199], v[124:127]
  s_waitcnt vmcnt(12)
  v_mfma_f32_16x16x32_bf16 v[112:115], a[72:75], v[200:203], v[112:115]
  v_mfma_f32_16x16x32_bf16 v[120:123], a[200:203], v[200:203], v[120:123]
  v_mfma_f32_16x16x32_bf16 v[116:119], a[76:79], v[204:207], v[116:119]
  v_mfma_f32_16x16x32_bf16 v[124:127], a[204:207], v[204:207], v[124:127]
  s_waitcnt vmcnt(10)
  v_mfma_f32_16x16x32_bf16 v[112:115], a[80:83], v[208:211], v[112:115]
  v_mfma_f32_16x16x32_bf16 v[120:123], a[208:211], v[208:211], v[120:123]
  v_mfma_f32_16x16x32_bf16 v[116:119], a[84:87], v[212:215], v[116:119]
  v_mfma_f32_16x16x32_bf16 v[124:127], a[212:215], v[212:215], v[124:127]
  s_waitcnt vmcnt(8)
  v_mfma_f32_16x16x32_bf16 v[112:115], a[88:91], v[216:219], v[112:115]
  v_mfma_f32_16x16x32_bf16 v[120:123], a[216:219], v[216:219], v[120:123]
  v_mfma_f32_16x16x32_bf16 v[116:119], a[92:95], v[220:223], v[116:119]
  v_mfma_f32_16x16x32_bf16 v[124:127], a[220:223], v[220:223], v[124:127]
  s_waitcnt vmcnt(6)
  v_mfma_f32_16x16x32_bf16 v[112:115], a[96:99], v[224:227], v[112:115]
  v_mfma_f32_16x16x32_bf16 v[120:123], a[224:227], v[224:227], v[120:123]
  v_mfma_f32_16x16x32_bf16 v[116:119], a[100:103], v[228:231], v[116:119]
  v_mfma_f32_16x16x32_bf16 v[124:127], a[228:231], v[228:231], v[124:127]
  s_waitcnt vmcnt(4)
  v_mfma_f32_16x16x32_bf16 v[112:115], a[104:107], v[232:235], v[112:115]
  v_mfma_f32_16x16x32_bf16 v[120:123], a[232:235], v[232:235], v[120:123]
  v_mfma_f32_16x16x32_bf16 v[116:119], a[108:111], v[236:239], v[116:119]
  v_mfma_f32_16x16x32_bf16 v[124:127], a[236:239], v[236:239], v[124:127]
  s_waitcnt vmcnt(2)
  v_mfma_f32_16x16x32_bf16 v[112:115], a[112:115], v[240:243], v[112:115]
  v_mfma_f32_16x16x32_bf16 v[120:123], a[240:243], v[240:243], v[120:123]
  v_mfma_f32_16x16x32_bf16 v[116:119], a[116:119], v[244:247], v[116:119]
  v_mfma_f32_16x16x32_bf16 v[124:127], a[244:247], v[244:247], v[124:127]
  s_waitcnt vmcnt(0)
  v_mfma_f32_16x16x32_bf16 v[112:115], a[120:123], v[248:251], v[112:115]
  v_mfma_f32_16x16x32_bf16 v[120:123], a[248:251], v[248:251], v[120:123]
  v_mfma_f32_16x16x32_bf16 v[116:119], a[124:127], v[252:255], v[116:119]
  v_mfma_f32_16x16x32_bf16 v[124:127], a[252:255], v[252:255], v[124:127]
  s_nop 0
  s_cmp_ge_u32 s62, 64
  s_cbranch_scc1 L_a_npf
  s_lshl_b32 s56, s43, 6
  s_add_u32 s56, s56, s62
  s_lshl_b32 s56, s56, 15
  s_lshl_b32 s53, s57, 12
  s_add_u32 s53, s53, s56
  buffer_load_dwordx4 v[16:19], v1, s[4:7], s53 offen offset:0 sc1
  buffer_load_dwordx4 v[20:23], v1, s[4:7], s53 offen offset:1024 sc1
  buffer_load_dwordx4 v[24:27], v1, s[4:7], s53 offen offset:2048 sc1
  buffer_load_dwordx4 v[28:31], v1, s[4:7], s53 offen offset:3072 sc1
  s_add_u32 s53, s56, 0x2000
  buffer_load_dwordx4 v[32:35], v1, s[4:7], s53 offen offset:0 sc1
  buffer_load_dwordx4 v[36:39], v1, s[4:7], s53 offen offset:1024 sc1
  buffer_load_dwordx4 v[40:43], v1, s[4:7], s53 offen offset:2048 sc1
  buffer_load_dwordx4 v[44:47], v1, s[4:7], s53 offen offset:3072 sc1
  s_add_u32 s53, s56, 0x3000
  buffer_load_dwordx4 v[48:51], v1, s[4:7], s53 offen offset:0 sc1
  buffer_load_dwordx4 v[52:55], v1, s[4:7], s53 offen offset:1024 sc1
  buffer_load_dwordx4 v[56:59], v1, s[4:7], s53 offen offset:2048 sc1
  buffer_load_dwordx4 v[60:63], v1, s[4:7], s53 offen offset:3072 sc1
  s_lshl_b32 s53, s58, 12
  s_add_u32 s53, s53, s56
  s_add_u32 s53, s53, 0x4000
  buffer_load_dwordx4 v[64:67], v1, s[4:7], s53 offen offset:0 sc1
  buffer_load_dwordx4 v[68:71], v1, s[4:7], s53 offen offset:1024 sc1
  buffer_load_dwordx4 v[72:75], v1, s[4:7], s53 offen offset:2048 sc1
  buffer_load_dwordx4 v[76:79], v1, s[4:7], s53 offen offset:3072 sc1
L_a_npf:
  s_nop 4
  v_add_f32 v112, v112, v116
  v_add_f32 v113, v113, v117
  v_add_f32 v114, v114, v118
  v_add_f32 v115, v115, v119
  ds_write_b128 v10, v[112:115] offset:0
  v_add_f32 v120, v120, v124
  v_add_f32 v121, v121, v125
  v_add_f32 v122, v122, v126
  v_add_f32 v123, v123, v127
  ds_write_b128 v10, v[120:123] offset:4096
  s_waitcnt lgkmcnt(0)
  s_barrier
  s_cmp_ge_u32 s3, 2
  s_cbranch_scc1 L_a_ns
  ds_read_b128 v[128:131], v11 offset:0
  ds_read_b128 v[132:135], v11 offset:1024
  ds_read_b128 v[136:139], v11 offset:2048
  ds_read_b128 v[140:143], v11 offset:3072
  s_lshl_b32 s53, s55, 16
  s_lshr_b32 s54, s43, 4
  s_lshl_b32 s54, s54, 15
  s_add_u32 s53, s53, s54
  s_and_b32 s54, s43, 15
  s_lshl_b32 s54, s54, 6
  s_add_u32 s53, s53, s54
  s_lshl_b32 s54, s57, 5
  s_add_u32 s53, s53, s54
  s_waitcnt lgkmcnt(0)
  v_add_f32 v128, v128, v132
  v_add_f32 v136, v136, v140
  v_add_f32 v129, v129, v133
  v_add_f32 v137, v137, v141
  v_add_f32 v130, v130, v134
  v_add_f32 v138, v138, v142
  v_add_f32 v131, v131, v135
  v_add_f32 v139, v139, v143
  v_add_f32 v128, v128, v136
  v_add_f32 v129, v129, v137
  v_add_f32 v130, v130, v138
  v_add_f32 v131, v131, v139
  v_cvt_pk_bf16_f32 v128, v128, v129
  v_cvt_pk_bf16_f32 v129, v130, v131
  buffer_store_dwordx2 v[128:129], v8, s[44:47], s53 offen offset:1024
L_a_ns:
  s_add_u32 s60, s60, 1
  s_nop 0
  s_mov_b32 s55, s62
  s_cmp_lt_u32 s55, 64
  s_cbranch_scc1 L_a_loop
L_a_out:
  s_endpgm
L_apart:
  s_waitcnt lgkmcnt(0)
  s_mov_b32 s4, s40
  s_and_b32 s5, s41, 0xffff
  s_mov_b32 s6, 0x10000000
  s_mov_b32 s7, 0x20000
  s_mov_b32 s8, s38
  s_and_b32 s9, s39, 0xffff
  s_mov_b32 s10, 0x100
  s_mov_b32 s11, 0x20000
  s_mov_b32 s12, s16
  s_and_b32 s13, s17, 0xffff
  s_mov_b32 s14, 0x200000
  s_mov_b32 s15, 0x20000
  s_mov_b32 s78, s18
  s_mov_b32 s79, s19
  s_mov_b32 s80, s20
  s_mov_b32 s81, s21
  s_mov_b32 s16, s78
  s_and_b32 s17, s79, 0xffff
  s_mov_b32 s18, 0x180000
  s_mov_b32 s19, 0x20000
  s_mov_b32 s20, s80
  s_and_b32 s21, s81, 0xffff
  s_mov_b32 s22, 0x80000
  s_mov_b32 s23, 0x20000
  v_lshlrev_b32 v1, 4, v0
  s_mov_b32 s28, s32
  s_and_b32 s29, s33, 0xffff
  s_mov_b32 s30, 0x400000
  s_mov_b32 s31, 0x20000
  v_lshlrev_b32 v2, 7, v0
  s_lshl_b32 s52, s43, 17
  s_lshl_b32 s53, s3, 15
  s_add_u32 s52, s52, s53
  buffer_load_dword v248, v2, s[28:31], s52 offen
  s_add_u32 s52, s52, 8192
  buffer_load_dword v249, v2, s[28:31], s52 offen
  s_add_u32 s52, s52, 8192
  buffer_load_dword v250, v2, s[28:31], s52 offen
  s_add_u32 s52, s52, 8192
  buffer_load_dword v251, v2, s[28:31], s52 offen
  s_add_u32 s52, s52, 8192
  s_mov_b32 s24, s36
  s_and_b32 s25, s37, 0xffff
  s_mov_b32 s26, 0x400000
  s_mov_b32 s27, 0x20000
  s_lshl_b32 s61, s43, 16
  s_add_u32 s52, s3, 0
  v_xor_b32 v16, s52, v0
  v_lshlrev_b32 v16, 4, v16
  s_add_u32 s52, s3, 4
  v_xor_b32 v17, s52, v0
  v_lshlrev_b32 v17, 4, v17
  s_add_u32 s52, s3, 8
  v_xor_b32 v18, s52, v0
  v_lshlrev_b32 v18, 4, v18
  s_add_u32 s52, s3, 12
  v_xor_b32 v19, s52, v0
  v_lshlrev_b32 v19, 4, v19
  s_sub_u32 s53, s61, 16384
  s_max_i32 s53, s53, 0
  s_lshl_b32 s52, s3, 10
  s_add_u32 s53, s53, s52
  s_add_u32 m0, s52, 0
  s_nop 0
  buffer_load_dwordx4 v16, s[12:15], s53 offen lds
  s_add_u32 s53, s53, 4096
  s_add_u32 m0, m0, 4096
  s_nop 0
  buffer_load_dwordx4 v17, s[12:15], s53 offen lds
  s_add_u32 s53, s53, 4096
  s_add_u32 m0, m0, 4096
  s_nop 0
  buffer_load_dwordx4 v18, s[12:15], s53 offen lds
  s_add_u32 s53, s53, 4096
  s_add_u32 m0, m0, 4096
  s_nop 0
  buffer_load_dwordx4 v19, s[12:15], s53 offen lds
  s_add_u32 s53, s61, 0
  s_lshl_b32 s52, s3, 10
  s_add_u32 s53, s53, s52
  s_add_u32 m0, s52, 16384
  s_nop 0
  buffer_load_dwordx4 v16, s[12:15], s53 offen lds
  s_add_u32 s53, s53, 4096
  s_add_u32 m0, m0, 4096
  s_nop 0
  buffer_load_dwordx4 v17, s[12:15], s53 offen lds
  s_add_u32 s53, s53, 4096
  s_add_u32 m0, m0, 4096
  s_nop 0
  buffer_load_dwordx4 v18, s[12:15], s53 offen lds
  s_add_u32 s53, s53, 4096
  s_add_u32 m0, m0, 4096
  s_nop 0
  buffer_load_dwordx4 v19, s[12:15], s53 offen lds
  s_add_u32 s53, s61, 16384
  s_lshl_b32 s52, s3, 10
  s_add_u32 s53, s53, s52
  s_add_u32 m0, s52, 32768
  s_nop 0
  buffer_load_dwordx4 v16, s[12:15], s53 offen lds
  s_add_u32 s53, s53, 4096
  s_add_u32 m0, m0, 4096
  s_nop 0
  buffer_load_dwordx4 v17, s[12:15], s53 offen lds
  s_add_u32 s53, s53, 4096
  s_add_u32 m0, m0, 4096
  s_nop 0
  buffer_load_dwordx4 v18, s[12:15], s53 offen lds
  s_add_u32 s53, s53, 4096
  s_add_u32 m0, m0, 4096
  s_nop 0
  buffer_load_dwordx4 v19, s[12:15], s53 offen lds
  s_add_u32 s53, s61, 32768
  s_lshl_b32 s52, s3, 10
  s_add_u32 s53, s53, s52
  s_add_u32 m0, s52, 49152
  s_nop 0
  buffer_load_dwordx4 v16, s[12:15], s53 offen lds
  s_add_u32 s53, s53, 4096
  s_add_u32 m0, m0, 4096
  s_nop 0
  buffer_load_dwordx4 v17, s[12:15], s53 offen lds
  s_add_u32 s53, s53, 4096
  s_add_u32 m0, m0, 4096
  s_nop 0
  buffer_load_dwordx4 v18, s[12:15], s53 offen lds
  s_add_u32 s53, s53, 4096
  s_add_u32 m0, m0, 4096
  s_nop 0
  buffer_load_dwordx4 v19, s[12:15], s53 offen lds
  s_add_u32 s53, s61, 49152
  s_lshl_b32 s52, s3, 10
  s_add_u32 s53, s53, s52
  s_add_u32 m0, s52, 65536
  s_nop 0
  buffer_load_dwordx4 v16, s[12:15], s53 offen lds
  s_add_u32 s53, s53, 4096
  s_add_u32 m0, m0, 4096
  s_nop 0
  buffer_load_dwordx4 v17, s[12:15], s53 offen lds
  s_add_u32 s53, s53, 4096
  s_add_u32 m0, m0, 4096
  s_nop 0
  buffer_load_dwordx4 v18, s[12:15], s53 offen lds
  s_add_u32 s53, s53, 4096
  s_add_u32 m0, m0, 4096
  s_nop 0
  buffer_load_dwordx4 v19, s[12:15], s53 offen lds
  v_lshrrev_b32 v8, 4, v0
  v_bfe_u32 v9, v0, 2, 2
  v_and_b32 v10, 3, v0
  v_and_b32 v11, 15, v0
  v_lshl_add_u32 v2, v8, 3, v9
  v_mul_u32_u24 v2, 3072, v2
  v_lshl_add_u32 v2, v10, 4, v2
  v_lshl_add_u32 v3, v8, 2, v9
  v_lshlrev_b32 v3, 10, v3
  v_lshl_add_u32 v3, v10, 4, v3
  v_lshrrev_b32 v4, 2, v0
  v_lshlrev_b32 v4, 6, v4
  v_lshl_add_u32 v4, v10, 3, v4
  s_mul_i32 s58, s3, 20480
  s_add_u32 s58, s58, 81920
  v_add_u32 v4, s58, v4
  v_or_b32 v12, 0, v8
  v_xor_b32 v12, v12, v11
  v_lshlrev_b32 v12, 4, v12
  v_lshl_add_u32 v12, v11, 10, v12
  v_or_b32 v13, 4, v8
  v_xor_b32 v13, v13, v11
  v_lshlrev_b32 v13, 4, v13
  v_lshl_add_u32 v13, v11, 10, v13
  v_or_b32 v14, 8, v8
  v_xor_b32 v14, v14, v11
  v_lshlrev_b32 v14, 4, v14
  v_lshl_add_u32 v14, v11, 10, v14
  v_or_b32 v15, 12, v8
  v_xor_b32 v15, v15, v11
  v_lshlrev_b32 v15, 4, v15
  v_lshl_add_u32 v15, v11, 10, v15
  v_mov_b32 v6, 0xff800000
  v_lshlrev_b32 v7, 11, v11
  v_lshl_add_u32 v7, v8, 3, v7
  v_lshlrev_b32 v9, 2, v8
  v_sub_u32 v9, v11, v9
  v_add_u32 v10, 16, v9
  v_and_b32 v10, -15, v10
  v_cmp_eq_u32 s[62:63], 0, v10
  v_add_u32 v10, 15, v9
  v_and_b32 v10, -15, v10
  v_cmp_eq_u32 s[64:65], 0, v10
  v_add_u32 v10, 14, v9
  v_and_b32 v10, -15, v10
  v_cmp_eq_u32 s[66:67], 0, v10
  v_add_u32 v10, 13, v9
  v_and_b32 v10, -15, v10
  v_cmp_eq_u32 s[68:69], 0, v10
  v_add_u32 v10, 0, v9
  v_and_b32 v10, -15, v10
  v_cmp_eq_u32 s[70:71], 0, v10
  v_add_u32 v10, -1, v9
  v_and_b32 v10, -15, v10
  v_cmp_eq_u32 s[72:73], 0, v10
  v_add_u32 v10, -2, v9
  v_and_b32 v10, -15, v10
  v_cmp_eq_u32 s[74:75], 0, v10
  v_add_u32 v10, -3, v9
  v_and_b32 v10, -15, v10
  v_cmp_eq_u32 s[76:77], 0, v10
  s_cmp_eq_u32 s43, 0
  s_cselect_b64 s[44:45], 0, s[62:63]
  s_cselect_b64 s[46:47], 0, s[64:65]
  s_cselect_b64 s[48:49], 0, s[66:67]
  s_cselect_b64 s[50:51], 0, s[68:69]
  s_mov_b32 s59, 0x3eb8aa3b
  s_mov_b32 s60, 0xbeb8aa3b
  s_lshl_b32 s54, s3, 8
  s_mov_b32 s55, 0
  s_mov_b32 s56, 0
  s_add_u32 m0, s58, s55
  s_add_u32 s52, s54, 0
  buffer_load_dwordx4 v2, s[16:19], s52 offen lds
  s_add_u32 s52, s52, 12288
  s_add_u32 m0, m0, 1024
  s_nop 0
  buffer_load_dwordx4 v2, s[16:19], s52 offen lds
  s_add_u32 s52, s52, 86016
  s_add_u32 m0, m0, 1024
  s_nop 0
  buffer_load_dwordx4 v2, s[16:19], s52 offen lds
  s_add_u32 s52, s52, 12288
  s_add_u32 m0, m0, 1024
  s_nop 0
  buffer_load_dwordx4 v2, s[16:19], s52 offen lds
  s_add_u32 s55, s55, 4096
  s_cmp_eq_u32 s55, 20480
  s_cselect_b32 s55, 0, s55
  s_add_u32 m0, s58, s55
  s_add_u32 s52, s54, 1024
  buffer_load_dwordx4 v2, s[16:19], s52 offen lds
  s_add_u32 s52, s52, 12288
  s_add_u32 m0, m0, 1024
  s_nop 0
  buffer_load_dwordx4 v2, s[16:19], s52 offen lds
  s_add_u32 s52, s52, 86016
  s_add_u32 m0, m0, 1024
  s_nop 0
  buffer_load_dwordx4 v2, s[16:19], s52 offen lds
  s_add_u32 s52, s52, 12288
  s_add_u32 m0, m0, 1024
  s_nop 0
  buffer_load_dwordx4 v2, s[16:19], s52 offen lds
  s_add_u32 s55, s55, 4096
  s_cmp_eq_u32 s55, 20480
  s_cselect_b32 s55, 0, s55
  s_add_u32 m0, s58, s55
  s_add_u32 s52, s54, 2048
  buffer_load_dwordx4 v2, s[16:19], s52 offen lds
  s_add_u32 s52, s52, 12288
  s_add_u32 m0, m0, 1024
  s_nop 0
  buffer_load_dwordx4 v2, s[16:19], s52 offen lds
  s_add_u32 s52, s52, 86016
  s_add_u32 m0, m0, 1024
  s_nop 0
  buffer_load_dwordx4 v2, s[16:19], s52 offen lds
  s_add_u32 s52, s52, 12288
  s_add_u32 m0, m0, 1024
  s_nop 0
  buffer_load_dwordx4 v2, s[16:19], s52 offen lds
  s_add_u32 s55, s55, 4096
  s_cmp_eq_u32 s55, 20480
  s_cselect_b32 s55, 0, s55
  s_waitcnt vmcnt(12)
  s_barrier
  v_mov_b64 v[72:73], 0
  v_mov_b64 v[74:75], 0
  v_mov_b64 v[76:77], 0
  v_mov_b64 v[78:79], 0
  v_mov_b64 v[80:81], 0
  v_mov_b64 v[82:83], 0
  v_mov_b64 v[84:85], 0
  v_mov_b64 v[86:87], 0
  v_mov_b64 v[88:89], 0
  v_mov_b64 v[90:91], 0
  v_mov_b64 v[92:93], 0
  v_mov_b64 v[94:95], 0
  v_mov_b64 v[96:97], 0
  v_mov_b64 v[98:99], 0
  v_mov_b64 v[100:101], 0
  v_mov_b64 v[102:103], 0
  v_mov_b64 v[104:105], 0
  v_mov_b64 v[106:107], 0
  v_mov_b64 v[108:109], 0
  v_mov_b64 v[110:111], 0
  v_mov_b64 v[112:113], 0
  v_mov_b64 v[114:115], 0
  v_mov_b64 v[116:117], 0
  v_mov_b64 v[118:119], 0
  v_mov_b64 v[120:121], 0
  v_mov_b64 v[122:123], 0
  v_mov_b64 v[124:125], 0
  v_mov_b64 v[126:127], 0
  v_mov_b64 v[128:129], 0
  v_mov_b64 v[130:131], 0
  v_mov_b64 v[132:133], 0
  v_mov_b64 v[134:135], 0
  v_mov_b64 v[136:137], 0
  v_mov_b64 v[138:139], 0
  v_mov_b64 v[140:141], 0
  v_mov_b64 v[142:143], 0
  v_mov_b64 v[144:145], 0
  v_mov_b64 v[146:147], 0
  v_mov_b64 v[148:149], 0
  v_mov_b64 v[150:151], 0
  v_mov_b64 v[152:153], 0
  v_mov_b64 v[154:155], 0
  v_mov_b64 v[156:157], 0
  v_mov_b64 v[158:159], 0
  v_mov_b64 v[160:161], 0
  v_mov_b64 v[162:163], 0
  v_mov_b64 v[164:165], 0
  v_mov_b64 v[166:167], 0
  v_mov_b64 v[168:169], 0
  v_mov_b64 v[170:171], 0
  v_mov_b64 v[172:173], 0
  v_mov_b64 v[174:175], 0
  v_mov_b64 v[176:177], 0
  v_mov_b64 v[178:179], 0
  v_mov_b64 v[180:181], 0
  v_mov_b64 v[182:183], 0
  s_mov_b32 s57, 0
L_x_kb0:
  s_add_u32 s54, s54, 196608
  v_add_u32 v8, s57, v12
  ds_read_b128 v[16:19], v8 offset:0
  ds_read_b128 v[20:23], v8 offset:16384
  ds_read_b128 v[24:27], v8 offset:32768
  ds_read_b128 v[28:31], v8 offset:49152
  v_add_u32 v8, 0x10000, v8
  ds_read_b128 v[32:35], v8
  v_add_u32 v8, s57, v13
  ds_read_b128 v[36:39], v8 offset:0
  ds_read_b128 v[40:43], v8 offset:16384
  ds_read_b128 v[44:47], v8 offset:32768
  ds_read_b128 v[48:51], v8 offset:49152
  v_add_u32 v8, 0x10000, v8
  ds_read_b128 v[52:55], v8
  s_waitcnt vmcnt(8)
  v_add_u32 v5, s56, v4
  s_add_u32 s56, s56, 4096
  s_cmp_eq_u32 s56, 20480
  s_cselect_b32 s56, 0, s56
  ds_read_b64_tr_b16 v[56:57], v5 offset:0
  ds_read_b64_tr_b16 v[60:61], v5 offset:32
  ds_read_b64_tr_b16 v[58:59], v5 offset:1024
  ds_read_b64_tr_b16 v[62:63], v5 offset:1056
  ds_read_b64_tr_b16 v[64:65], v5 offset:2048
  ds_read_b64_tr_b16 v[68:69], v5 offset:2080
  ds_read_b64_tr_b16 v[66:67], v5 offset:3072
  ds_read_b64_tr_b16 v[70:71], v5 offset:3104
  s_add_u32 m0, s58, s55
  s_add_u32 s52, s54, 0
  buffer_load_dwordx4 v2, s[16:19], s52 offen lds
  s_add_u32 s52, s52, 12288
  s_add_u32 m0, m0, 1024
  s_nop 0
  buffer_load_dwordx4 v2, s[16:19], s52 offen lds
  s_add_u32 s52, s52, 86016
  s_add_u32 m0, m0, 1024
  s_nop 0
  buffer_load_dwordx4 v2, s[16:19], s52 offen lds
  s_add_u32 s52, s52, 12288
  s_add_u32 m0, m0, 1024
  s_nop 0
  buffer_load_dwordx4 v2, s[16:19], s52 offen lds
  s_add_u32 s55, s55, 4096
  s_cmp_eq_u32 s55, 20480
  s_cselect_b32 s55, 0, s55
  s_waitcnt lgkmcnt(0)
  v_mfma_f32_16x16x32_bf16 v[72:75], v[56:59], v[20:23], v[72:75]
  v_mfma_f32_16x16x32_bf16 v[76:79], v[56:59], v[24:27], v[76:79]
  v_mfma_f32_16x16x32_bf16 v[80:83], v[56:59], v[28:31], v[80:83]
  v_mfma_f32_16x16x32_bf16 v[84:87], v[56:59], v[32:35], v[84:87]
  v_mfma_f32_16x16x32_bf16 v[88:91], v[60:63], v[20:23], v[88:91]
  v_mfma_f32_16x16x32_bf16 v[92:95], v[60:63], v[24:27], v[92:95]
  v_mfma_f32_16x16x32_bf16 v[96:99], v[60:63], v[28:31], v[96:99]
  v_mfma_f32_16x16x32_bf16 v[100:103], v[60:63], v[32:35], v[100:103]
  v_mfma_f32_16x16x32_bf16 v[72:75], v[64:67], v[40:43], v[72:75]
  v_mfma_f32_16x16x32_bf16 v[76:79], v[64:67], v[44:47], v[76:79]
  v_mfma_f32_16x16x32_bf16 v[80:83], v[64:67], v[48:51], v[80:83]
  v_mfma_f32_16x16x32_bf16 v[84:87], v[64:67], v[52:55], v[84:87]
  v_mfma_f32_16x16x32_bf16 v[88:91], v[68:71], v[40:43], v[88:91]
  v_mfma_f32_16x16x32_bf16 v[92:95], v[68:71], v[44:47], v[92:95]
  v_mfma_f32_16x16x32_bf16 v[96:99], v[68:71], v[48:51], v[96:99]
  v_mfma_f32_16x16x32_bf16 v[100:103], v[68:71], v[52:55], v[100:103]
  s_waitcnt vmcnt(8)
  v_add_u32 v5, s56, v4
  s_add_u32 s56, s56, 4096
  s_cmp_eq_u32 s56, 20480
  s_cselect_b32 s56, 0, s56
  ds_read_b64_tr_b16 v[56:57], v5 offset:0
  ds_read_b64_tr_b16 v[60:61], v5 offset:32
  ds_read_b64_tr_b16 v[58:59], v5 offset:1024
  ds_read_b64_tr_b16 v[62:63], v5 offset:1056
  ds_read_b64_tr_b16 v[64:65], v5 offset:2048
  ds_read_b64_tr_b16 v[68:69], v5 offset:2080
  ds_read_b64_tr_b16 v[66:67], v5 offset:3072
  ds_read_b64_tr_b16 v[70:71], v5 offset:3104
  s_add_u32 m0, s58, s55
  s_add_u32 s52, s54, 1024
  buffer_load_dwordx4 v2, s[16:19], s52 offen lds
  s_add_u32 s52, s52, 12288
  s_add_u32 m0, m0, 1024
  s_nop 0
  buffer_load_dwordx4 v2, s[16:19], s52 offen lds
  s_add_u32 s52, s52, 86016
  s_add_u32 m0, m0, 1024
  s_nop 0
  buffer_load_dwordx4 v2, s[16:19], s52 offen lds
  s_add_u32 s52, s52, 12288
  s_add_u32 m0, m0, 1024
  s_nop 0
  buffer_load_dwordx4 v2, s[16:19], s52 offen lds
  s_add_u32 s55, s55, 4096
  s_cmp_eq_u32 s55, 20480
  s_cselect_b32 s55, 0, s55
  s_waitcnt lgkmcnt(0)
  v_mfma_f32_16x16x32_bf16 v[104:107], v[56:59], v[16:19], v[104:107]
  v_mfma_f32_16x16x32_bf16 v[108:111], v[56:59], v[20:23], v[108:111]
  v_mfma_f32_16x16x32_bf16 v[112:115], v[56:59], v[24:27], v[112:115]
  v_mfma_f32_16x16x32_bf16 v[116:119], v[56:59], v[28:31], v[116:119]
  v_mfma_f32_16x16x32_bf16 v[120:123], v[56:59], v[32:35], v[120:123]
  v_mfma_f32_16x16x32_bf16 v[124:127], v[60:63], v[16:19], v[124:127]
  v_mfma_f32_16x16x32_bf16 v[128:131], v[60:63], v[20:23], v[128:131]
  v_mfma_f32_16x16x32_bf16 v[132:135], v[60:63], v[24:27], v[132:135]
  v_mfma_f32_16x16x32_bf16 v[136:139], v[60:63], v[28:31], v[136:139]
  v_mfma_f32_16x16x32_bf16 v[140:143], v[60:63], v[32:35], v[140:143]
  v_mfma_f32_16x16x32_bf16 v[104:107], v[64:67], v[36:39], v[104:107]
  v_mfma_f32_16x16x32_bf16 v[108:111], v[64:67], v[40:43], v[108:111]
  v_mfma_f32_16x16x32_bf16 v[112:115], v[64:67], v[44:47], v[112:115]
  v_mfma_f32_16x16x32_bf16 v[116:119], v[64:67], v[48:51], v[116:119]
  v_mfma_f32_16x16x32_bf16 v[120:123], v[64:67], v[52:55], v[120:123]
  v_mfma_f32_16x16x32_bf16 v[124:127], v[68:71], v[36:39], v[124:127]
  v_mfma_f32_16x16x32_bf16 v[128:131], v[68:71], v[40:43], v[128:131]
  v_mfma_f32_16x16x32_bf16 v[132:135], v[68:71], v[44:47], v[132:135]
  v_mfma_f32_16x16x32_bf16 v[136:139], v[68:71], v[48:51], v[136:139]
  v_mfma_f32_16x16x32_bf16 v[140:143], v[68:71], v[52:55], v[140:143]
  s_waitcnt vmcnt(8)
  v_add_u32 v5, s56, v4
  s_add_u32 s56, s56, 4096
  s_cmp_eq_u32 s56, 20480
  s_cselect_b32 s56, 0, s56
  ds_read_b64_tr_b16 v[56:57], v5 offset:0
  ds_read_b64_tr_b16 v[60:61], v5 offset:32
  ds_read_b64_tr_b16 v[58:59], v5 offset:1024
  ds_read_b64_tr_b16 v[62:63], v5 offset:1056
  ds_read_b64_tr_b16 v[64:65], v5 offset:2048
  ds_read_b64_tr_b16 v[68:69], v5 offset:2080
  ds_read_b64_tr_b16 v[66:67], v5 offset:3072
  ds_read_b64_tr_b16 v[70:71], v5 offset:3104
  s_add_u32 m0, s58, s55
  s_add_u32 s52, s54, 2048
  buffer_load_dwordx4 v2, s[16:19], s52 offen lds
  s_add_u32 s52, s52, 12288
  s_add_u32 m0, m0, 1024
  s_nop 0
  buffer_load_dwordx4 v2, s[16:19], s52 offen lds
  s_add_u32 s52, s52, 86016
  s_add_u32 m0, m0, 1024
  s_nop 0
  buffer_load_dwordx4 v2, s[16:19], s52 offen lds
  s_add_u32 s52, s52, 12288
  s_add_u32 m0, m0, 1024
  s_nop 0
  buffer_load_dwordx4 v2, s[16:19], s52 offen lds
  s_add_u32 s55, s55, 4096
  s_cmp_eq_u32 s55, 20480
  s_cselect_b32 s55, 0, s55
  s_waitcnt lgkmcnt(0)
  v_mfma_f32_16x16x32_bf16 v[144:147], v[16:19], v[56:59], v[144:147]
  v_mfma_f32_16x16x32_bf16 v[148:151], v[20:23], v[56:59], v[148:151]
  v_mfma_f32_16x16x32_bf16 v[152:155], v[24:27], v[56:59], v[152:155]
  v_mfma_f32_16x16x32_bf16 v[156:159], v[28:31], v[56:59], v[156:159]
  v_mfma_f32_16x16x32_bf16 v[160:163], v[32:35], v[56:59], v[160:163]
  v_mfma_f32_16x16x32_bf16 v[164:167], v[16:19], v[60:63], v[164:167]
  v_mfma_f32_16x16x32_bf16 v[168:171], v[20:23], v[60:63], v[168:171]
  v_mfma_f32_16x16x32_bf16 v[172:175], v[24:27], v[60:63], v[172:175]
  v_mfma_f32_16x16x32_bf16 v[176:179], v[28:31], v[60:63], v[176:179]
  v_mfma_f32_16x16x32_bf16 v[180:183], v[32:35], v[60:63], v[180:183]
  v_mfma_f32_16x16x32_bf16 v[144:147], v[36:39], v[64:67], v[144:147]
  v_mfma_f32_16x16x32_bf16 v[148:151], v[40:43], v[64:67], v[148:151]
  v_mfma_f32_16x16x32_bf16 v[152:155], v[44:47], v[64:67], v[152:155]
  v_mfma_f32_16x16x32_bf16 v[156:159], v[48:51], v[64:67], v[156:159]
  v_mfma_f32_16x16x32_bf16 v[160:163], v[52:55], v[64:67], v[160:163]
  v_mfma_f32_16x16x32_bf16 v[164:167], v[36:39], v[68:71], v[164:167]
  v_mfma_f32_16x16x32_bf16 v[168:171], v[40:43], v[68:71], v[168:171]
  v_mfma_f32_16x16x32_bf16 v[172:175], v[44:47], v[68:71], v[172:175]
  v_mfma_f32_16x16x32_bf16 v[176:179], v[48:51], v[68:71], v[176:179]
  v_mfma_f32_16x16x32_bf16 v[180:183], v[52:55], v[68:71], v[180:183]
  s_add_u32 s54, s54, 196608
  s_lshl_b32 s52, s3, 8
  s_add_u32 s52, s52, 64
  s_cmp_eq_u32 s57, 768
  s_cselect_b32 s54, s52, s54
  v_add_u32 v8, s57, v14
  ds_read_b128 v[16:19], v8 offset:0
  ds_read_b128 v[20:23], v8 offset:16384
  ds_read_b128 v[24:27], v8 offset:32768
  ds_read_b128 v[28:31], v8 offset:49152
  v_add_u32 v8, 0x10000, v8
  ds_read_b128 v[32:35], v8
  v_add_u32 v8, s57, v15
  ds_read_b128 v[36:39], v8 offset:0
  ds_read_b128 v[40:43], v8 offset:16384
  ds_read_b128 v[44:47], v8 offset:32768
  ds_read_b128 v[48:51], v8 offset:49152
  v_add_u32 v8, 0x10000, v8
  ds_read_b128 v[52:55], v8
  s_waitcnt vmcnt(8)
  v_add_u32 v5, s56, v4
  s_add_u32 s56, s56, 4096
  s_cmp_eq_u32 s56, 20480
  s_cselect_b32 s56, 0, s56
  ds_read_b64_tr_b16 v[56:57], v5 offset:0
  ds_read_b64_tr_b16 v[60:61], v5 offset:32
  ds_read_b64_tr_b16 v[58:59], v5 offset:1024
  ds_read_b64_tr_b16 v[62:63], v5 offset:1056
  ds_read_b64_tr_b16 v[64:65], v5 offset:2048
  ds_read_b64_tr_b16 v[68:69], v5 offset:2080
  ds_read_b64_tr_b16 v[66:67], v5 offset:3072
  ds_read_b64_tr_b16 v[70:71], v5 offset:3104
  s_add_u32 m0, s58, s55
  s_add_u32 s52, s54, 0
  buffer_load_dwordx4 v2, s[16:19], s52 offen lds
  s_add_u32 s52, s52, 12288
  s_add_u32 m0, m0, 1024
  s_nop 0
  buffer_load_dwordx4 v2, s[16:19], s52 offen lds
  s_add_u32 s52, s52, 86016
  s_add_u32 m0, m0, 1024
  s_nop 0
  buffer_load_dwordx4 v2, s[16:19], s52 offen lds
  s_add_u32 s52, s52, 12288
  s_add_u32 m0, m0, 1024
  s_nop 0
  buffer_load_dwordx4 v2, s[16:19], s52 offen lds
  s_add_u32 s55, s55, 4096
  s_cmp_eq_u32 s55, 20480
  s_cselect_b32 s55, 0, s55
  s_waitcnt lgkmcnt(0)
  v_mfma_f32_16x16x32_bf16 v[72:75], v[56:59], v[20:23], v[72:75]
  v_mfma_f32_16x16x32_bf16 v[76:79], v[56:59], v[24:27], v[76:79]
  v_mfma_f32_16x16x32_bf16 v[80:83], v[56:59], v[28:31], v[80:83]
  v_mfma_f32_16x16x32_bf16 v[84:87], v[56:59], v[32:35], v[84:87]
  v_mfma_f32_16x16x32_bf16 v[88:91], v[60:63], v[20:23], v[88:91]
  v_mfma_f32_16x16x32_bf16 v[92:95], v[60:63], v[24:27], v[92:95]
  v_mfma_f32_16x16x32_bf16 v[96:99], v[60:63], v[28:31], v[96:99]
  v_mfma_f32_16x16x32_bf16 v[100:103], v[60:63], v[32:35], v[100:103]
  v_mfma_f32_16x16x32_bf16 v[72:75], v[64:67], v[40:43], v[72:75]
  v_mfma_f32_16x16x32_bf16 v[76:79], v[64:67], v[44:47], v[76:79]
  v_mfma_f32_16x16x32_bf16 v[80:83], v[64:67], v[48:51], v[80:83]
  v_mfma_f32_16x16x32_bf16 v[84:87], v[64:67], v[52:55], v[84:87]
  v_mfma_f32_16x16x32_bf16 v[88:91], v[68:71], v[40:43], v[88:91]
  v_mfma_f32_16x16x32_bf16 v[92:95], v[68:71], v[44:47], v[92:95]
  v_mfma_f32_16x16x32_bf16 v[96:99], v[68:71], v[48:51], v[96:99]
  v_mfma_f32_16x16x32_bf16 v[100:103], v[68:71], v[52:55], v[100:103]
  s_waitcnt vmcnt(8)
  v_add_u32 v5, s56, v4
  s_add_u32 s56, s56, 4096
  s_cmp_eq_u32 s56, 20480
  s_cselect_b32 s56, 0, s56
  ds_read_b64_tr_b16 v[56:57], v5 offset:0
  ds_read_b64_tr_b16 v[60:61], v5 offset:32
  ds_read_b64_tr_b16 v[58:59], v5 offset:1024
  ds_read_b64_tr_b16 v[62:63], v5 offset:1056
  ds_read_b64_tr_b16 v[64:65], v5 offset:2048
  ds_read_b64_tr_b16 v[68:69], v5 offset:2080
  ds_read_b64_tr_b16 v[66:67], v5 offset:3072
  ds_read_b64_tr_b16 v[70:71], v5 offset:3104
  s_add_u32 m0, s58, s55
  s_add_u32 s52, s54, 1024
  buffer_load_dwordx4 v2, s[16:19], s52 offen lds
  s_add_u32 s52, s52, 12288
  s_add_u32 m0, m0, 1024
  s_nop 0
  buffer_load_dwordx4 v2, s[16:19], s52 offen lds
  s_add_u32 s52, s52, 86016
  s_add_u32 m0, m0, 1024
  s_nop 0
  buffer_load_dwordx4 v2, s[16:19], s52 offen lds
  s_add_u32 s52, s52, 12288
  s_add_u32 m0, m0, 1024
  s_nop 0
  buffer_load_dwordx4 v2, s[16:19], s52 offen lds
  s_add_u32 s55, s55, 4096
  s_cmp_eq_u32 s55, 20480
  s_cselect_b32 s55, 0, s55
  s_waitcnt lgkmcnt(0)
  v_mfma_f32_16x16x32_bf16 v[104:107], v[56:59], v[16:19], v[104:107]
  v_mfma_f32_16x16x32_bf16 v[108:111], v[56:59], v[20:23], v[108:111]
  v_mfma_f32_16x16x32_bf16 v[112:115], v[56:59], v[24:27], v[112:115]
  v_mfma_f32_16x16x32_bf16 v[116:119], v[56:59], v[28:31], v[116:119]
  v_mfma_f32_16x16x32_bf16 v[120:123], v[56:59], v[32:35], v[120:123]
  v_mfma_f32_16x16x32_bf16 v[124:127], v[60:63], v[16:19], v[124:127]
  v_mfma_f32_16x16x32_bf16 v[128:131], v[60:63], v[20:23], v[128:131]
  v_mfma_f32_16x16x32_bf16 v[132:135], v[60:63], v[24:27], v[132:135]
  v_mfma_f32_16x16x32_bf16 v[136:139], v[60:63], v[28:31], v[136:139]
  v_mfma_f32_16x16x32_bf16 v[140:143], v[60:63], v[32:35], v[140:143]
  v_mfma_f32_16x16x32_bf16 v[104:107], v[64:67], v[36:39], v[104:107]
  v_mfma_f32_16x16x32_bf16 v[108:111], v[64:67], v[40:43], v[108:111]
  v_mfma_f32_16x16x32_bf16 v[112:115], v[64:67], v[44:47], v[112:115]
  v_mfma_f32_16x16x32_bf16 v[116:119], v[64:67], v[48:51], v[116:119]
  v_mfma_f32_16x16x32_bf16 v[120:123], v[64:67], v[52:55], v[120:123]
  v_mfma_f32_16x16x32_bf16 v[124:127], v[68:71], v[36:39], v[124:127]
  v_mfma_f32_16x16x32_bf16 v[128:131], v[68:71], v[40:43], v[128:131]
  v_mfma_f32_16x16x32_bf16 v[132:135], v[68:71], v[44:47], v[132:135]
  v_mfma_f32_16x16x32_bf16 v[136:139], v[68:71], v[48:51], v[136:139]
  v_mfma_f32_16x16x32_bf16 v[140:143], v[68:71], v[52:55], v[140:143]
  s_waitcnt vmcnt(8)
  v_add_u32 v5, s56, v4
  s_add_u32 s56, s56, 4096
  s_cmp_eq_u32 s56, 20480
  s_cselect_b32 s56, 0, s56
  ds_read_b64_tr_b16 v[56:57], v5 offset:0
  ds_read_b64_tr_b16 v[60:61], v5 offset:32
  ds_read_b64_tr_b16 v[58:59], v5 offset:1024
  ds_read_b64_tr_b16 v[62:63], v5 offset:1056
  ds_read_b64_tr_b16 v[64:65], v5 offset:2048
  ds_read_b64_tr_b16 v[68:69], v5 offset:2080
  ds_read_b64_tr_b16 v[66:67], v5 offset:3072
  ds_read_b64_tr_b16 v[70:71], v5 offset:3104
  s_add_u32 m0, s58, s55
  s_add_u32 s52, s54, 2048
  buffer_load_dwordx4 v2, s[16:19], s52 offen lds
  s_add_u32 s52, s52, 12288
  s_add_u32 m0, m0, 1024
  s_nop 0
  buffer_load_dwordx4 v2, s[16:19], s52 offen lds
  s_add_u32 s52, s52, 86016
  s_add_u32 m0, m0, 1024
  s_nop 0
  buffer_load_dwordx4 v2, s[16:19], s52 offen lds
  s_add_u32 s52, s52, 12288
  s_add_u32 m0, m0, 1024
  s_nop 0
  buffer_load_dwordx4 v2, s[16:19], s52 offen lds
  s_add_u32 s55, s55, 4096
  s_cmp_eq_u32 s55, 20480
  s_cselect_b32 s55, 0, s55
  s_waitcnt lgkmcnt(0)
  v_mfma_f32_16x16x32_bf16 v[144:147], v[16:19], v[56:59], v[144:147]
  v_mfma_f32_16x16x32_bf16 v[148:151], v[20:23], v[56:59], v[148:151]
  v_mfma_f32_16x16x32_bf16 v[152:155], v[24:27], v[56:59], v[152:155]
  v_mfma_f32_16x16x32_bf16 v[156:159], v[28:31], v[56:59], v[156:159]
  v_mfma_f32_16x16x32_bf16 v[160:163], v[32:35], v[56:59], v[160:163]
  v_mfma_f32_16x16x32_bf16 v[164:167], v[16:19], v[60:63], v[164:167]
  v_mfma_f32_16x16x32_bf16 v[168:171], v[20:23], v[60:63], v[168:171]
  v_mfma_f32_16x16x32_bf16 v[172:175], v[24:27], v[60:63], v[172:175]
  v_mfma_f32_16x16x32_bf16 v[176:179], v[28:31], v[60:63], v[176:179]
  v_mfma_f32_16x16x32_bf16 v[180:183], v[32:35], v[60:63], v[180:183]
  v_mfma_f32_16x16x32_bf16 v[144:147], v[36:39], v[64:67], v[144:147]
  v_mfma_f32_16x16x32_bf16 v[148:151], v[40:43], v[64:67], v[148:151]
  v_mfma_f32_16x16x32_bf16 v[152:155], v[44:47], v[64:67], v[152:155]
  v_mfma_f32_16x16x32_bf16 v[156:159], v[48:51], v[64:67], v[156:159]
  v_mfma_f32_16x16x32_bf16 v[160:163], v[52:55], v[64:67], v[160:163]
  v_mfma_f32_16x16x32_bf16 v[164:167], v[36:39], v[68:71], v[164:167]
  v_mfma_f32_16x16x32_bf16 v[168:171], v[40:43], v[68:71], v[168:171]
  v_mfma_f32_16x16x32_bf16 v[172:175], v[44:47], v[68:71], v[172:175]
  v_mfma_f32_16x16x32_bf16 v[176:179], v[48:51], v[68:71], v[176:179]
  v_mfma_f32_16x16x32_bf16 v[180:183], v[52:55], v[68:71], v[180:183]
  s_add_u32 s57, s57, 256
  s_cmp_lt_u32 s57, 1024
  s_cbranch_scc1 L_x_kb0
  s_nop 4
  s_nop 7
  v_cvt_pk_bf16_f32 v72, v72, v73
  v_cvt_pk_bf16_f32 v73, v74, v75
  v_cvt_pk_bf16_f32 v74, v76, v77
  v_cvt_pk_bf16_f32 v75, v78, v79
  v_cvt_pk_bf16_f32 v76, v80, v81
  v_cvt_pk_bf16_f32 v77, v82, v83
  v_cvt_pk_bf16_f32 v78, v84, v85
  v_cvt_pk_bf16_f32 v79, v86, v87
  v_cvt_pk_bf16_f32 v80, v88, v89
  v_cvt_pk_bf16_f32 v81, v90, v91
  v_cvt_pk_bf16_f32 v82, v92, v93
  v_cvt_pk_bf16_f32 v83, v94, v95
  v_cvt_pk_bf16_f32 v84, v96, v97
  v_cvt_pk_bf16_f32 v85, v98, v99
  v_cvt_pk_bf16_f32 v86, v100, v101
  v_cvt_pk_bf16_f32 v87, v102, v103
  v_cvt_pk_bf16_f32 v104, v104, v105
  v_cvt_pk_bf16_f32 v105, v106, v107
  v_cvt_pk_bf16_f32 v106, v108, v109
  v_cvt_pk_bf16_f32 v107, v110, v111
  v_cvt_pk_bf16_f32 v108, v112, v113
  v_cvt_pk_bf16_f32 v109, v114, v115
  v_cvt_pk_bf16_f32 v110, v116, v117
  v_cvt_pk_bf16_f32 v111, v118, v119
  v_cvt_pk_bf16_f32 v112, v120, v121
  v_cvt_pk_bf16_f32 v113, v122, v123
  v_cvt_pk_bf16_f32 v114, v124, v125
  v_cvt_pk_bf16_f32 v115, v126, v127
  v_cvt_pk_bf16_f32 v116, v128, v129
  v_cvt_pk_bf16_f32 v117, v130, v131
  v_cvt_pk_bf16_f32 v118, v132, v133
  v_cvt_pk_bf16_f32 v119, v134, v135
  v_cvt_pk_bf16_f32 v120, v136, v137
  v_cvt_pk_bf16_f32 v121, v138, v139
  v_cvt_pk_bf16_f32 v122, v140, v141
  v_cvt_pk_bf16_f32 v123, v142, v143
  v_cvt_pk_bf16_f32 v144, v144, v145
  v_cvt_pk_bf16_f32 v145, v146, v147
  v_cvt_pk_bf16_f32 v146, v148, v149
  v_cvt_pk_bf16_f32 v147, v150, v151
  v_cvt_pk_bf16_f32 v148, v152, v153
  v_cvt_pk_bf16_f32 v149, v154, v155
  v_cvt_pk_bf16_f32 v150, v156, v157
  v_cvt_pk_bf16_f32 v151, v158, v159
  v_cvt_pk_bf16_f32 v152, v160, v161
  v_cvt_pk_bf16_f32 v153, v162, v163
  v_cvt_pk_bf16_f32 v154, v164, v165
  v_cvt_pk_bf16_f32 v155, v166, v167
  v_cvt_pk_bf16_f32 v156, v168, v169
  v_cvt_pk_bf16_f32 v157, v170, v171
  v_cvt_pk_bf16_f32 v158, v172, v173
  v_cvt_pk_bf16_f32 v159, v174, v175
  v_cvt_pk_bf16_f32 v160, v176, v177
  v_cvt_pk_bf16_f32 v161, v178, v179
  v_cvt_pk_bf16_f32 v162, v180, v181
  v_cvt_pk_bf16_f32 v163, v182, v183
  v_mfma_f32_16x16x16_bf16 v[16:19], v[104:105], v[72:73], 0
  v_mfma_f32_16x16x16_bf16 v[20:23], v[106:107], v[72:73], 0
  s_nop 6
  v_cndmask_b32 v16, v6, v16, s[44:45]
  v_cndmask_b32 v17, v6, v17, s[46:47]
  v_cndmask_b32 v18, v6, v18, s[48:49]
  v_cndmask_b32 v19, v6, v19, s[50:51]
  v_cndmask_b32 v20, v6, v20, s[70:71]
  v_cndmask_b32 v21, v6, v21, s[72:73]
  v_cndmask_b32 v22, v6, v22, s[74:75]
  v_cndmask_b32 v23, v6, v23, s[76:77]
  v_max3_f32 v32, v16, v17, v18
  v_max3_f32 v32, v32, v19, v20
  v_max3_f32 v32, v32, v21, v22
  v_max_f32 v32, v32, v23
  v_mov_b32 v34, v32
  v_mov_b32 v35, v32
  s_nop 1
  v_permlane32_swap_b32 v34, v35
  v_max_f32 v36, v34, v35
  v_max_f32 v37, v34, v35
  s_nop 1
  v_permlane16_swap_b32 v36, v37
  v_max_f32 v34, v36, v37
  v_mul_f32 v32, s60, v34
  v_fma_f32 v16, v16, s59, v32
  v_fma_f32 v17, v17, s59, v32
  v_fma_f32 v18, v18, s59, v32
  v_fma_f32 v19, v19, s59, v32
  v_fma_f32 v20, v20, s59, v32
  v_fma_f32 v21, v21, s59, v32
  v_fma_f32 v22, v22, s59, v32
  v_fma_f32 v23, v23, s59, v32
  v_exp_f32 v16, v16
  v_exp_f32 v17, v17
  v_exp_f32 v18, v18
  v_exp_f32 v19, v19
  v_exp_f32 v20, v20
  v_exp_f32 v21, v21
  v_exp_f32 v22, v22
  v_exp_f32 v23, v23
  v_cvt_pk_bf16_f32 v24, v16, v17
  v_cvt_pk_bf16_f32 v25, v18, v19
  v_cvt_pk_bf16_f32 v26, v20, v21
  v_cvt_pk_bf16_f32 v27, v22, v23
  v_add_f32 v32, v16, v17
  v_add_f32 v32, v32, v18
  v_mfma_f32_16x16x32_bf16 v[28:31], v[144:147], v[24:27], 0
  v_add_f32 v32, v32, v19
  v_add_f32 v32, v32, v20
  v_add_f32 v32, v32, v21
  v_add_f32 v32, v32, v22
  v_add_f32 v32, v32, v23
  v_mov_b32 v34, v32
  v_mov_b32 v35, v32
  s_nop 1
  v_permlane32_swap_b32 v34, v35
  v_add_f32 v36, v34, v35
  v_add_f32 v37, v34, v35
  s_nop 1
  v_permlane16_swap_b32 v36, v37
  v_add_f32 v34, v36, v37
  v_rcp_f32 v34, v34
  s_nop 0
  v_mul_f32 v28, v28, v34
  v_mul_f32 v29, v29, v34
  v_mul_f32 v30, v30, v34
  v_mul_f32 v31, v31, v34
  v_cvt_pk_bf16_f32 v184, v28, v29
  v_cvt_pk_bf16_f32 v185, v30, v31
  v_mfma_f32_16x16x16_bf16 v[16:19], v[106:107], v[74:75], 0
  v_mfma_f32_16x16x16_bf16 v[20:23], v[108:109], v[74:75], 0
  s_nop 6
  v_cndmask_b32 v16, v6, v16, s[62:63]
  v_cndmask_b32 v17, v6, v17, s[64:65]
  v_cndmask_b32 v18, v6, v18, s[66:67]
  v_cndmask_b32 v19, v6, v19, s[68:69]
  v_cndmask_b32 v20, v6, v20, s[70:71]
  v_cndmask_b32 v21, v6, v21, s[72:73]
  v_cndmask_b32 v22, v6, v22, s[74:75]
  v_cndmask_b32 v23, v6, v23, s[76:77]
  v_max3_f32 v32, v16, v17, v18
  v_max3_f32 v32, v32, v19, v20
  v_max3_f32 v32, v32, v21, v22
  v_max_f32 v32, v32, v23
  v_mov_b32 v34, v32
  v_mov_b32 v35, v32
  s_nop 1
  v_permlane32_swap_b32 v34, v35
  v_max_f32 v36, v34, v35
  v_max_f32 v37, v34, v35
  s_nop 1
  v_permlane16_swap_b32 v36, v37
  v_max_f32 v34, v36, v37
  v_mul_f32 v32, s60, v34
  v_fma_f32 v16, v16, s59, v32
  v_fma_f32 v17, v17, s59, v32
  v_fma_f32 v18, v18, s59, v32
  v_fma_f32 v19, v19, s59, v32
  v_fma_f32 v20, v20, s59, v32
  v_fma_f32 v21, v21, s59, v32
  v_fma_f32 v22, v22, s59, v32
  v_fma_f32 v23, v23, s59, v32
  v_exp_f32 v16, v16
  v_exp_f32 v17, v17
  v_exp_f32 v18, v18
  v_exp_f32 v19, v19
  v_exp_f32 v20, v20
  v_exp_f32 v21, v21
  v_exp_f32 v22, v22
  v_exp_f32 v23, v23
  v_cvt_pk_bf16_f32 v24, v16, v17
  v_cvt_pk_bf16_f32 v25, v18, v19
  v_cvt_pk_bf16_f32 v26, v20, v21
  v_cvt_pk_bf16_f32 v27, v22, v23
  v_add_f32 v32, v16, v17
  v_add_f32 v32, v32, v18
  v_mfma_f32_16x16x32_bf16 v[28:31], v[146:149], v[24:27], 0
  v_add_f32 v32, v32, v19
  v_add_f32 v32, v32, v20
  v_add_f32 v32, v32, v21
  v_add_f32 v32, v32, v22
  v_add_f32 v32, v32, v23
  v_mov_b32 v34, v32
  v_mov_b32 v35, v32
  s_nop 1
  v_permlane32_swap_b32 v34, v35
  v_add_f32 v36, v34, v35
  v_add_f32 v37, v34, v35
  s_nop 1
  v_permlane16_swap_b32 v36, v37
  v_add_f32 v34, v36, v37
  v_rcp_f32 v34, v34
  s_nop 0
  v_mul_f32 v28, v28, v34
  v_mul_f32 v29, v29, v34
  v_mul_f32 v30, v30, v34
  v_mul_f32 v31, v31, v34
  v_cvt_pk_bf16_f32 v188, v28, v29
  v_cvt_pk_bf16_f32 v189, v30, v31
  v_mfma_f32_16x16x16_bf16 v[16:19], v[108:109], v[76:77], 0
  v_mfma_f32_16x16x16_bf16 v[20:23], v[110:111], v[76:77], 0
  s_nop 6
  v_cndmask_b32 v16, v6, v16, s[62:63]
  v_cndmask_b32 v17, v6, v17, s[64:65]
  v_cndmask_b32 v18, v6, v18, s[66:67]
  v_cndmask_b32 v19, v6, v19, s[68:69]
  v_cndmask_b32 v20, v6, v20, s[70:71]
  v_cndmask_b32 v21, v6, v21, s[72:73]
  v_cndmask_b32 v22, v6, v22, s[74:75]
  v_cndmask_b32 v23, v6, v23, s[76:77]
  v_max3_f32 v32, v16, v17, v18
  v_max3_f32 v32, v32, v19, v20
  v_max3_f32 v32, v32, v21, v22
  v_max_f32 v32, v32, v23
  v_mov_b32 v34, v32
  v_mov_b32 v35, v32
  s_nop 1
  v_permlane32_swap_b32 v34, v35
  v_max_f32 v36, v34, v35
  v_max_f32 v37, v34, v35
  s_nop 1
  v_permlane16_swap_b32 v36, v37
  v_max_f32 v34, v36, v37
  v_mul_f32 v32, s60, v34
  v_fma_f32 v16, v16, s59, v32
  v_fma_f32 v17, v17, s59, v32
  v_fma_f32 v18, v18, s59, v32
  v_fma_f32 v19, v19, s59, v32
  v_fma_f32 v20, v20, s59, v32
  v_fma_f32 v21, v21, s59, v32
  v_fma_f32 v22, v22, s59, v32
  v_fma_f32 v23, v23, s59, v32
  v_exp_f32 v16, v16
  v_exp_f32 v17, v17
  v_exp_f32 v18, v18
  v_exp_f32 v19, v19
  v_exp_f32 v20, v20
  v_exp_f32 v21, v21
  v_exp_f32 v22, v22
  v_exp_f32 v23, v23
  v_cvt_pk_bf16_f32 v24, v16, v17
  v_cvt_pk_bf16_f32 v25, v18, v19
  v_cvt_pk_bf16_f32 v26, v20, v21
  v_cvt_pk_bf16_f32 v27, v22, v23
  v_add_f32 v32, v16, v17
  v_add_f32 v32, v32, v18
  v_mfma_f32_16x16x32_bf16 v[28:31], v[148:151], v[24:27], 0
  v_add_f32 v32, v32, v19
  v_add_f32 v32, v32, v20
  v_add_f32 v32, v32, v21
  v_add_f32 v32, v32, v22
  v_add_f32 v32, v32, v23
  v_mov_b32 v34, v32
  v_mov_b32 v35, v32
  s_nop 1
  v_permlane32_swap_b32 v34, v35
  v_add_f32 v36, v34, v35
  v_add_f32 v37, v34, v35
  s_nop 1
  v_permlane16_swap_b32 v36, v37
  v_add_f32 v34, v36, v37
  v_rcp_f32 v34, v34
  s_nop 0
  v_mul_f32 v28, v28, v34
  v_mul_f32 v29, v29, v34
  v_mul_f32 v30, v30, v34
  v_mul_f32 v31, v31, v34
  v_cvt_pk_bf16_f32 v192, v28, v29
  v_cvt_pk_bf16_f32 v193, v30, v31
  v_mfma_f32_16x16x16_bf16 v[16:19], v[110:111], v[78:79], 0
  v_mfma_f32_16x16x16_bf16 v[20:23], v[112:113], v[78:79], 0
  s_nop 6
  v_cndmask_b32 v16, v6, v16, s[62:63]
  v_cndmask_b32 v17, v6, v17, s[64:65]
  v_cndmask_b32 v18, v6, v18, s[66:67]
  v_cndmask_b32 v19, v6, v19, s[68:69]
  v_cndmask_b32 v20, v6, v20, s[70:71]
  v_cndmask_b32 v21, v6, v21, s[72:73]
  v_cndmask_b32 v22, v6, v22, s[74:75]
  v_cndmask_b32 v23, v6, v23, s[76:77]
  v_max3_f32 v32, v16, v17, v18
  v_max3_f32 v32, v32, v19, v20
  v_max3_f32 v32, v32, v21, v22
  v_max_f32 v32, v32, v23
  v_mov_b32 v34, v32
  v_mov_b32 v35, v32
  s_nop 1
  v_permlane32_swap_b32 v34, v35
  v_max_f32 v36, v34, v35
  v_max_f32 v37, v34, v35
  s_nop 1
  v_permlane16_swap_b32 v36, v37
  v_max_f32 v34, v36, v37
  v_mul_f32 v32, s60, v34
  v_fma_f32 v16, v16, s59, v32
  v_fma_f32 v17, v17, s59, v32
  v_fma_f32 v18, v18, s59, v32
  v_fma_f32 v19, v19, s59, v32
  v_fma_f32 v20, v20, s59, v32
  v_fma_f32 v21, v21, s59, v32
  v_fma_f32 v22, v22, s59, v32
  v_fma_f32 v23, v23, s59, v32
  v_exp_f32 v16, v16
  v_exp_f32 v17, v17
  v_exp_f32 v18, v18
  v_exp_f32 v19, v19
  v_exp_f32 v20, v20
  v_exp_f32 v21, v21
  v_exp_f32 v22, v22
  v_exp_f32 v23, v23
  v_cvt_pk_bf16_f32 v24, v16, v17
  v_cvt_pk_bf16_f32 v25, v18, v19
  v_cvt_pk_bf16_f32 v26, v20, v21
  v_cvt_pk_bf16_f32 v27, v22, v23
  v_add_f32 v32, v16, v17
  v_add_f32 v32, v32, v18
  v_mfma_f32_16x16x32_bf16 v[28:31], v[150:153], v[24:27], 0
  v_add_f32 v32, v32, v19
  v_add_f32 v32, v32, v20
  v_add_f32 v32, v32, v21
  v_add_f32 v32, v32, v22
  v_add_f32 v32, v32, v23
  v_mov_b32 v34, v32
  v_mov_b32 v35, v32
  s_nop 1
  v_permlane32_swap_b32 v34, v35
  v_add_f32 v36, v34, v35
  v_add_f32 v37, v34, v35
  s_nop 1
  v_permlane16_swap_b32 v36, v37
  v_add_f32 v34, v36, v37
  v_rcp_f32 v34, v34
  s_nop 0
  v_mul_f32 v28, v28, v34
  v_mul_f32 v29, v29, v34
  v_mul_f32 v30, v30, v34
  v_mul_f32 v31, v31, v34
  v_cvt_pk_bf16_f32 v196, v28, v29
  v_cvt_pk_bf16_f32 v197, v30, v31
  v_mfma_f32_16x16x16_bf16 v[16:19], v[114:115], v[80:81], 0
  v_mfma_f32_16x16x16_bf16 v[20:23], v[116:117], v[80:81], 0
  s_nop 6
  v_cndmask_b32 v16, v6, v16, s[44:45]
  v_cndmask_b32 v17, v6, v17, s[46:47]
  v_cndmask_b32 v18, v6, v18, s[48:49]
  v_cndmask_b32 v19, v6, v19, s[50:51]
  v_cndmask_b32 v20, v6, v20, s[70:71]
  v_cndmask_b32 v21, v6, v21, s[72:73]
  v_cndmask_b32 v22, v6, v22, s[74:75]
  v_cndmask_b32 v23, v6, v23, s[76:77]
  v_max3_f32 v32, v16, v17, v18
  v_max3_f32 v32, v32, v19, v20
  v_max3_f32 v32, v32, v21, v22
  v_max_f32 v32, v32, v23
  v_mov_b32 v34, v32
  v_mov_b32 v35, v32
  s_nop 1
  v_permlane32_swap_b32 v34, v35
  v_max_f32 v36, v34, v35
  v_max_f32 v37, v34, v35
  s_nop 1
  v_permlane16_swap_b32 v36, v37
  v_max_f32 v34, v36, v37
  v_mul_f32 v32, s60, v34
  v_fma_f32 v16, v16, s59, v32
  v_fma_f32 v17, v17, s59, v32
  v_fma_f32 v18, v18, s59, v32
  v_fma_f32 v19, v19, s59, v32
  v_fma_f32 v20, v20, s59, v32
  v_fma_f32 v21, v21, s59, v32
  v_fma_f32 v22, v22, s59, v32
  v_fma_f32 v23, v23, s59, v32
  v_exp_f32 v16, v16
  v_exp_f32 v17, v17
  v_exp_f32 v18, v18
  v_exp_f32 v19, v19
  v_exp_f32 v20, v20
  v_exp_f32 v21, v21
  v_exp_f32 v22, v22
  v_exp_f32 v23, v23
  v_cvt_pk_bf16_f32 v24, v16, v17
  v_cvt_pk_bf16_f32 v25, v18, v19
  v_cvt_pk_bf16_f32 v26, v20, v21
  v_cvt_pk_bf16_f32 v27, v22, v23
  v_add_f32 v32, v16, v17
  v_add_f32 v32, v32, v18
  v_mfma_f32_16x16x32_bf16 v[28:31], v[154:157], v[24:27], 0
  v_add_f32 v32, v32, v19
  v_add_f32 v32, v32, v20
  v_add_f32 v32, v32, v21
  v_add_f32 v32, v32, v22
  v_add_f32 v32, v32, v23
  v_mov_b32 v34, v32
  v_mov_b32 v35, v32
  s_nop 1
  v_permlane32_swap_b32 v34, v35
  v_add_f32 v36, v34, v35
  v_add_f32 v37, v34, v35
  s_nop 1
  v_permlane16_swap_b32 v36, v37
  v_add_f32 v34, v36, v37
  v_rcp_f32 v34, v34
  s_nop 0
  v_mul_f32 v28, v28, v34
  v_mul_f32 v29, v29, v34
  v_mul_f32 v30, v30, v34
  v_mul_f32 v31, v31, v34
  v_cvt_pk_bf16_f32 v186, v28, v29
  v_cvt_pk_bf16_f32 v187, v30, v31
  v_mfma_f32_16x16x16_bf16 v[16:19], v[116:117], v[82:83], 0
  v_mfma_f32_16x16x16_bf16 v[20:23], v[118:119], v[82:83], 0
  s_nop 6
  v_cndmask_b32 v16, v6, v16, s[62:63]
  v_cndmask_b32 v17, v6, v17, s[64:65]
  v_cndmask_b32 v18, v6, v18, s[66:67]
  v_cndmask_b32 v19, v6, v19, s[68:69]
  v_cndmask_b32 v20, v6, v20, s[70:71]
  v_cndmask_b32 v21, v6, v21, s[72:73]
  v_cndmask_b32 v22, v6, v22, s[74:75]
  v_cndmask_b32 v23, v6, v23, s[76:77]
  v_max3_f32 v32, v16, v17, v18
  v_max3_f32 v32, v32, v19, v20
  v_max3_f32 v32, v32, v21, v22
  v_max_f32 v32, v32, v23
  v_mov_b32 v34, v32
  v_mov_b32 v35, v32
  s_nop 1
  v_permlane32_swap_b32 v34, v35
  v_max_f32 v36, v34, v35
  v_max_f32 v37, v34, v35
  s_nop 1
  v_permlane16_swap_b32 v36, v37
  v_max_f32 v34, v36, v37
  v_mul_f32 v32, s60, v34
  v_fma_f32 v16, v16, s59, v32
  v_fma_f32 v17, v17, s59, v32
  v_fma_f32 v18, v18, s59, v32
  v_fma_f32 v19, v19, s59, v32
  v_fma_f32 v20, v20, s59, v32
  v_fma_f32 v21, v21, s59, v32
  v_fma_f32 v22, v22, s59, v32
  v_fma_f32 v23, v23, s59, v32
  v_exp_f32 v16, v16
  v_exp_f32 v17, v17
  v_exp_f32 v18, v18
  v_exp_f32 v19, v19
  v_exp_f32 v20, v20
  v_exp_f32 v21, v21
  v_exp_f32 v22, v22
  v_exp_f32 v23, v23
  v_cvt_pk_bf16_f32 v24, v16, v17
  v_cvt_pk_bf16_f32 v25, v18, v19
  v_cvt_pk_bf16_f32 v26, v20, v21
  v_cvt_pk_bf16_f32 v27, v22, v23
  v_add_f32 v32, v16, v17
  v_add_f32 v32, v32, v18
  v_mfma_f32_16x16x32_bf16 v[28:31], v[156:159], v[24:27], 0
  v_add_f32 v32, v32, v19
  v_add_f32 v32, v32, v20
  v_add_f32 v32, v32, v21
  v_add_f32 v32, v32, v22
  v_add_f32 v32, v32, v23
  v_mov_b32 v34, v32
  v_mov_b32 v35, v32
  s_nop 1
  v_permlane32_swap_b32 v34, v35
  v_add_f32 v36, v34, v35
  v_add_f32 v37, v34, v35
  s_nop 1
  v_permlane16_swap_b32 v36, v37
  v_add_f32 v34, v36, v37
  v_rcp_f32 v34, v34
  s_nop 0
  v_mul_f32 v28, v28, v34
  v_mul_f32 v29, v29, v34
  v_mul_f32 v30, v30, v34
  v_mul_f32 v31, v31, v34
  v_cvt_pk_bf16_f32 v190, v28, v29
  v_cvt_pk_bf16_f32 v191, v30, v31
  v_mfma_f32_16x16x16_bf16 v[16:19], v[118:119], v[84:85], 0
  v_mfma_f32_16x16x16_bf16 v[20:23], v[120:121], v[84:85], 0
  s_nop 6
  v_cndmask_b32 v16, v6, v16, s[62:63]
  v_cndmask_b32 v17, v6, v17, s[64:65]
  v_cndmask_b32 v18, v6, v18, s[66:67]
  v_cndmask_b32 v19, v6, v19, s[68:69]
  v_cndmask_b32 v20, v6, v20, s[70:71]
  v_cndmask_b32 v21, v6, v21, s[72:73]
  v_cndmask_b32 v22, v6, v22, s[74:75]
  v_cndmask_b32 v23, v6, v23, s[76:77]
  v_max3_f32 v32, v16, v17, v18
  v_max3_f32 v32, v32, v19, v20
  v_max3_f32 v32, v32, v21, v22
  v_max_f32 v32, v32, v23
  v_mov_b32 v34, v32
  v_mov_b32 v35, v32
  s_nop 1
  v_permlane32_swap_b32 v34, v35
  v_max_f32 v36, v34, v35
  v_max_f32 v37, v34, v35
  s_nop 1
  v_permlane16_swap_b32 v36, v37
  v_max_f32 v34, v36, v37
  v_mul_f32 v32, s60, v34
  v_fma_f32 v16, v16, s59, v32
  v_fma_f32 v17, v17, s59, v32
  v_fma_f32 v18, v18, s59, v32
  v_fma_f32 v19, v19, s59, v32
  v_fma_f32 v20, v20, s59, v32
  v_fma_f32 v21, v21, s59, v32
  v_fma_f32 v22, v22, s59, v32
  v_fma_f32 v23, v23, s59, v32
  v_exp_f32 v16, v16
  v_exp_f32 v17, v17
  v_exp_f32 v18, v18
  v_exp_f32 v19, v19
  v_exp_f32 v20, v20
  v_exp_f32 v21, v21
  v_exp_f32 v22, v22
  v_exp_f32 v23, v23
  v_cvt_pk_bf16_f32 v24, v16, v17
  v_cvt_pk_bf16_f32 v25, v18, v19
  v_cvt_pk_bf16_f32 v26, v20, v21
  v_cvt_pk_bf16_f32 v27, v22, v23
  v_add_f32 v32, v16, v17
  v_add_f32 v32, v32, v18
  v_mfma_f32_16x16x32_bf16 v[28:31], v[158:161], v[24:27], 0
  v_add_f32 v32, v32, v19
  v_add_f32 v32, v32, v20
  v_add_f32 v32, v32, v21
  v_add_f32 v32, v32, v22
  v_add_f32 v32, v32, v23
  v_mov_b32 v34, v32
  v_mov_b32 v35, v32
  s_nop 1
  v_permlane32_swap_b32 v34, v35
  v_add_f32 v36, v34, v35
  v_add_f32 v37, v34, v35
  s_nop 1
  v_permlane16_swap_b32 v36, v37
  v_add_f32 v34, v36, v37
  v_rcp_f32 v34, v34
  s_nop 0
  v_mul_f32 v28, v28, v34
  v_mul_f32 v29, v29, v34
  v_mul_f32 v30, v30, v34
  v_mul_f32 v31, v31, v34
  v_cvt_pk_bf16_f32 v194, v28, v29
  v_cvt_pk_bf16_f32 v195, v30, v31
  v_mfma_f32_16x16x16_bf16 v[16:19], v[120:121], v[86:87], 0
  v_mfma_f32_16x16x16_bf16 v[20:23], v[122:123], v[86:87], 0
  s_nop 6
  v_cndmask_b32 v16, v6, v16, s[62:63]
  v_cndmask_b32 v17, v6, v17, s[64:65]
  v_cndmask_b32 v18, v6, v18, s[66:67]
  v_cndmask_b32 v19, v6, v19, s[68:69]
  v_cndmask_b32 v20, v6, v20, s[70:71]
  v_cndmask_b32 v21, v6, v21, s[72:73]
  v_cndmask_b32 v22, v6, v22, s[74:75]
  v_cndmask_b32 v23, v6, v23, s[76:77]
  v_max3_f32 v32, v16, v17, v18
  v_max3_f32 v32, v32, v19, v20
  v_max3_f32 v32, v32, v21, v22
  v_max_f32 v32, v32, v23
  v_mov_b32 v34, v32
  v_mov_b32 v35, v32
  s_nop 1
  v_permlane32_swap_b32 v34, v35
  v_max_f32 v36, v34, v35
  v_max_f32 v37, v34, v35
  s_nop 1
  v_permlane16_swap_b32 v36, v37
  v_max_f32 v34, v36, v37
  v_mul_f32 v32, s60, v34
  v_fma_f32 v16, v16, s59, v32
  v_fma_f32 v17, v17, s59, v32
  v_fma_f32 v18, v18, s59, v32
  v_fma_f32 v19, v19, s59, v32
  v_fma_f32 v20, v20, s59, v32
  v_fma_f32 v21, v21, s59, v32
  v_fma_f32 v22, v22, s59, v32
  v_fma_f32 v23, v23, s59, v32
  v_exp_f32 v16, v16
  v_exp_f32 v17, v17
  v_exp_f32 v18, v18
  v_exp_f32 v19, v19
  v_exp_f32 v20, v20
  v_exp_f32 v21, v21
  v_exp_f32 v22, v22
  v_exp_f32 v23, v23
  v_cvt_pk_bf16_f32 v24, v16, v17
  v_cvt_pk_bf16_f32 v25, v18, v19
  v_cvt_pk_bf16_f32 v26, v20, v21
  v_cvt_pk_bf16_f32 v27, v22, v23
  v_add_f32 v32, v16, v17
  v_add_f32 v32, v32, v18
  v_mfma_f32_16x16x32_bf16 v[28:31], v[160:163], v[24:27], 0
  v_add_f32 v32, v32, v19
  v_add_f32 v32, v32, v20
  v_add_f32 v32, v32, v21
  v_add_f32 v32, v32, v22
  v_add_f32 v32, v32, v23
  v_mov_b32 v34, v32
  v_mov_b32 v35, v32
  s_nop 1
  v_permlane32_swap_b32 v34, v35
  v_add_f32 v36, v34, v35
  v_add_f32 v37, v34, v35
  s_nop 1
  v_permlane16_swap_b32 v36, v37
  v_add_f32 v34, v36, v37
  v_rcp_f32 v34, v34
  s_nop 0
  v_mul_f32 v28, v28, v34
  v_mul_f32 v29, v29, v34
  v_mul_f32 v30, v30, v34
  v_mul_f32 v31, v31, v34
  v_cvt_pk_bf16_f32 v198, v28, v29
  v_cvt_pk_bf16_f32 v199, v30, v31
  v_mov_b64 v[72:73], 0
  v_mov_b64 v[74:75], 0
  v_mov_b64 v[76:77], 0
  v_mov_b64 v[78:79], 0
  v_mov_b64 v[80:81], 0
  v_mov_b64 v[82:83], 0
  v_mov_b64 v[84:85], 0
  v_mov_b64 v[86:87], 0
  v_mov_b64 v[88:89], 0
  v_mov_b64 v[90:91], 0
  v_mov_b64 v[92:93], 0
  v_mov_b64 v[94:95], 0
  v_mov_b64 v[96:97], 0
  v_mov_b64 v[98:99], 0
  v_mov_b64 v[100:101], 0
  v_mov_b64 v[102:103], 0
  v_mov_b64 v[104:105], 0
  v_mov_b64 v[106:107], 0
  v_mov_b64 v[108:109], 0
  v_mov_b64 v[110:111], 0
  v_mov_b64 v[112:113], 0
  v_mov_b64 v[114:115], 0
  v_mov_b64 v[116:117], 0
  v_mov_b64 v[118:119], 0
  v_mov_b64 v[120:121], 0
  v_mov_b64 v[122:123], 0
  v_mov_b64 v[124:125], 0
  v_mov_b64 v[126:127], 0
  v_mov_b64 v[128:129], 0
  v_mov_b64 v[130:131], 0
  v_mov_b64 v[132:133], 0
  v_mov_b64 v[134:135], 0
  v_mov_b64 v[136:137], 0
  v_mov_b64 v[138:139], 0
  v_mov_b64 v[140:141], 0
  v_mov_b64 v[142:143], 0
  v_mov_b64 v[144:145], 0
  v_mov_b64 v[146:147], 0
  v_mov_b64 v[148:149], 0
  v_mov_b64 v[150:151], 0
  v_mov_b64 v[152:153], 0
  v_mov_b64 v[154:155], 0
  v_mov_b64 v[156:157], 0
  v_mov_b64 v[158:159], 0
  v_mov_b64 v[160:161], 0
  v_mov_b64 v[162:163], 0
  v_mov_b64 v[164:165], 0
  v_mov_b64 v[166:167], 0
  v_mov_b64 v[168:169], 0
  v_mov_b64 v[170:171], 0
  v_mov_b64 v[172:173], 0
  v_mov_b64 v[174:175], 0
  v_mov_b64 v[176:177], 0
  v_mov_b64 v[178:179], 0
  v_mov_b64 v[180:181], 0
  v_mov_b64 v[182:183], 0
  s_mov_b32 s57, 0
L_x_kb1:
  s_add_u32 s54, s54, 196608
  v_add_u32 v8, s57, v12
  ds_read_b128 v[16:19], v8 offset:0
  ds_read_b128 v[20:23], v8 offset:16384
  ds_read_b128 v[24:27], v8 offset:32768
  ds_read_b128 v[28:31], v8 offset:49152
  v_add_u32 v8, 0x10000, v8
  ds_read_b128 v[32:35], v8
  v_add_u32 v8, s57, v13
  ds_read_b128 v[36:39], v8 offset:0
  ds_read_b128 v[40:43], v8 offset:16384
  ds_read_b128 v[44:47], v8 offset:32768
  ds_read_b128 v[48:51], v8 offset:49152
  v_add_u32 v8, 0x10000, v8
  ds_read_b128 v[52:55], v8
  s_waitcnt vmcnt(8)
  v_add_u32 v5, s56, v4
  s_add_u32 s56, s56, 4096
  s_cmp_eq_u32 s56, 20480
  s_cselect_b32 s56, 0, s56
  ds_read_b64_tr_b16 v[56:57], v5 offset:0
  ds_read_b64_tr_b16 v[60:61], v5 offset:32
  ds_read_b64_tr_b16 v[58:59], v5 offset:1024
  ds_read_b64_tr_b16 v[62:63], v5 offset:1056
  ds_read_b64_tr_b16 v[64:65], v5 offset:2048
  ds_read_b64_tr_b16 v[68:69], v5 offset:2080
  ds_read_b64_tr_b16 v[66:67], v5 offset:3072
  ds_read_b64_tr_b16 v[70:71], v5 offset:3104
  s_add_u32 m0, s58, s55
  s_add_u32 s52, s54, 0
  buffer_load_dwordx4 v2, s[16:19], s52 offen lds
  s_add_u32 s52, s52, 12288
  s_add_u32 m0, m0, 1024
  s_nop 0
  buffer_load_dwordx4 v2, s[16:19], s52 offen lds
  s_add_u32 s52, s52, 86016
  s_add_u32 m0, m0, 1024
  s_nop 0
  buffer_load_dwordx4 v2, s[16:19], s52 offen lds
  s_add_u32 s52, s52, 12288
  s_add_u32 m0, m0, 1024
  s_nop 0
  buffer_load_dwordx4 v2, s[16:19], s52 offen lds
  s_add_u32 s55, s55, 4096
  s_cmp_eq_u32 s55, 20480
  s_cselect_b32 s55, 0, s55
  s_waitcnt lgkmcnt(0)
  v_mfma_f32_16x16x32_bf16 v[72:75], v[56:59], v[20:23], v[72:75]
  v_mfma_f32_16x16x32_bf16 v[76:79], v[56:59], v[24:27], v[76:79]
  v_mfma_f32_16x16x32_bf16 v[80:83], v[56:59], v[28:31], v[80:83]
  v_mfma_f32_16x16x32_bf16 v[84:87], v[56:59], v[32:35], v[84:87]
  v_mfma_f32_16x16x32_bf16 v[88:91], v[60:63], v[20:23], v[88:91]
  v_mfma_f32_16x16x32_bf16 v[92:95], v[60:63], v[24:27], v[92:95]
  v_mfma_f32_16x16x32_bf16 v[96:99], v[60:63], v[28:31], v[96:99]
  v_mfma_f32_16x16x32_bf16 v[100:103], v[60:63], v[32:35], v[100:103]
  v_mfma_f32_16x16x32_bf16 v[72:75], v[64:67], v[40:43], v[72:75]
  v_mfma_f32_16x16x32_bf16 v[76:79], v[64:67], v[44:47], v[76:79]
  v_mfma_f32_16x16x32_bf16 v[80:83], v[64:67], v[48:51], v[80:83]
  v_mfma_f32_16x16x32_bf16 v[84:87], v[64:67], v[52:55], v[84:87]
  v_mfma_f32_16x16x32_bf16 v[88:91], v[68:71], v[40:43], v[88:91]
  v_mfma_f32_16x16x32_bf16 v[92:95], v[68:71], v[44:47], v[92:95]
  v_mfma_f32_16x16x32_bf16 v[96:99], v[68:71], v[48:51], v[96:99]
  v_mfma_f32_16x16x32_bf16 v[100:103], v[68:71], v[52:55], v[100:103]
  s_waitcnt vmcnt(8)
  v_add_u32 v5, s56, v4
  s_add_u32 s56, s56, 4096
  s_cmp_eq_u32 s56, 20480
  s_cselect_b32 s56, 0, s56
  ds_read_b64_tr_b16 v[56:57], v5 offset:0
  ds_read_b64_tr_b16 v[60:61], v5 offset:32
  ds_read_b64_tr_b16 v[58:59], v5 offset:1024
  ds_read_b64_tr_b16 v[62:63], v5 offset:1056
  ds_read_b64_tr_b16 v[64:65], v5 offset:2048
  ds_read_b64_tr_b16 v[68:69], v5 offset:2080
  ds_read_b64_tr_b16 v[66:67], v5 offset:3072
  ds_read_b64_tr_b16 v[70:71], v5 offset:3104
  s_add_u32 m0, s58, s55
  s_add_u32 s52, s54, 1024
  buffer_load_dwordx4 v2, s[16:19], s52 offen lds
  s_add_u32 s52, s52, 12288
  s_add_u32 m0, m0, 1024
  s_nop 0
  buffer_load_dwordx4 v2, s[16:19], s52 offen lds
  s_add_u32 s52, s52, 86016
  s_add_u32 m0, m0, 1024
  s_nop 0
  buffer_load_dwordx4 v2, s[16:19], s52 offen lds
  s_add_u32 s52, s52, 12288
  s_add_u32 m0, m0, 1024
  s_nop 0
  buffer_load_dwordx4 v2, s[16:19], s52 offen lds
  s_add_u32 s55, s55, 4096
  s_cmp_eq_u32 s55, 20480
  s_cselect_b32 s55, 0, s55
  s_waitcnt lgkmcnt(0)
  v_mfma_f32_16x16x32_bf16 v[104:107], v[56:59], v[16:19], v[104:107]
  v_mfma_f32_16x16x32_bf16 v[108:111], v[56:59], v[20:23], v[108:111]
  v_mfma_f32_16x16x32_bf16 v[112:115], v[56:59], v[24:27], v[112:115]
  v_mfma_f32_16x16x32_bf16 v[116:119], v[56:59], v[28:31], v[116:119]
  v_mfma_f32_16x16x32_bf16 v[120:123], v[56:59], v[32:35], v[120:123]
  v_mfma_f32_16x16x32_bf16 v[124:127], v[60:63], v[16:19], v[124:127]
  v_mfma_f32_16x16x32_bf16 v[128:131], v[60:63], v[20:23], v[128:131]
  v_mfma_f32_16x16x32_bf16 v[132:135], v[60:63], v[24:27], v[132:135]
  v_mfma_f32_16x16x32_bf16 v[136:139], v[60:63], v[28:31], v[136:139]
  v_mfma_f32_16x16x32_bf16 v[140:143], v[60:63], v[32:35], v[140:143]
  v_mfma_f32_16x16x32_bf16 v[104:107], v[64:67], v[36:39], v[104:107]
  v_mfma_f32_16x16x32_bf16 v[108:111], v[64:67], v[40:43], v[108:111]
  v_mfma_f32_16x16x32_bf16 v[112:115], v[64:67], v[44:47], v[112:115]
  v_mfma_f32_16x16x32_bf16 v[116:119], v[64:67], v[48:51], v[116:119]
  v_mfma_f32_16x16x32_bf16 v[120:123], v[64:67], v[52:55], v[120:123]
  v_mfma_f32_16x16x32_bf16 v[124:127], v[68:71], v[36:39], v[124:127]
  v_mfma_f32_16x16x32_bf16 v[128:131], v[68:71], v[40:43], v[128:131]
  v_mfma_f32_16x16x32_bf16 v[132:135], v[68:71], v[44:47], v[132:135]
  v_mfma_f32_16x16x32_bf16 v[136:139], v[68:71], v[48:51], v[136:139]
  v_mfma_f32_16x16x32_bf16 v[140:143], v[68:71], v[52:55], v[140:143]
  s_waitcnt vmcnt(8)
  v_add_u32 v5, s56, v4
  s_add_u32 s56, s56, 4096
  s_cmp_eq_u32 s56, 20480
  s_cselect_b32 s56, 0, s56
  ds_read_b64_tr_b16 v[56:57], v5 offset:0
  ds_read_b64_tr_b16 v[60:61], v5 offset:32
  ds_read_b64_tr_b16 v[58:59], v5 offset:1024
  ds_read_b64_tr_b16 v[62:63], v5 offset:1056
  ds_read_b64_tr_b16 v[64:65], v5 offset:2048
  ds_read_b64_tr_b16 v[68:69], v5 offset:2080
  ds_read_b64_tr_b16 v[66:67], v5 offset:3072
  ds_read_b64_tr_b16 v[70:71], v5 offset:3104
  s_add_u32 m0, s58, s55
  s_add_u32 s52, s54, 2048
  buffer_load_dwordx4 v2, s[16:19], s52 offen lds
  s_add_u32 s52, s52, 12288
  s_add_u32 m0, m0, 1024
  s_nop 0
  buffer_load_dwordx4 v2, s[16:19], s52 offen lds
  s_add_u32 s52, s52, 86016
  s_add_u32 m0, m0, 1024
  s_nop 0
  buffer_load_dwordx4 v2, s[16:19], s52 offen lds
  s_add_u32 s52, s52, 12288
  s_add_u32 m0, m0, 1024
  s_nop 0
  buffer_load_dwordx4 v2, s[16:19], s52 offen lds
  s_add_u32 s55, s55, 4096
  s_cmp_eq_u32 s55, 20480
  s_cselect_b32 s55, 0, s55
  s_waitcnt lgkmcnt(0)
  v_mfma_f32_16x16x32_bf16 v[144:147], v[16:19], v[56:59], v[144:147]
  v_mfma_f32_16x16x32_bf16 v[148:151], v[20:23], v[56:59], v[148:151]
  v_mfma_f32_16x16x32_bf16 v[152:155], v[24:27], v[56:59], v[152:155]
  v_mfma_f32_16x16x32_bf16 v[156:159], v[28:31], v[56:59], v[156:159]
  v_mfma_f32_16x16x32_bf16 v[160:163], v[32:35], v[56:59], v[160:163]
  v_mfma_f32_16x16x32_bf16 v[164:167], v[16:19], v[60:63], v[164:167]
  v_mfma_f32_16x16x32_bf16 v[168:171], v[20:23], v[60:63], v[168:171]
  v_mfma_f32_16x16x32_bf16 v[172:175], v[24:27], v[60:63], v[172:175]
  v_mfma_f32_16x16x32_bf16 v[176:179], v[28:31], v[60:63], v[176:179]
  v_mfma_f32_16x16x32_bf16 v[180:183], v[32:35], v[60:63], v[180:183]
  v_mfma_f32_16x16x32_bf16 v[144:147], v[36:39], v[64:67], v[144:147]
  v_mfma_f32_16x16x32_bf16 v[148:151], v[40:43], v[64:67], v[148:151]
  v_mfma_f32_16x16x32_bf16 v[152:155], v[44:47], v[64:67], v[152:155]
  v_mfma_f32_16x16x32_bf16 v[156:159], v[48:51], v[64:67], v[156:159]
  v_mfma_f32_16x16x32_bf16 v[160:163], v[52:55], v[64:67], v[160:163]
  v_mfma_f32_16x16x32_bf16 v[164:167], v[36:39], v[68:71], v[164:167]
  v_mfma_f32_16x16x32_bf16 v[168:171], v[40:43], v[68:71], v[168:171]
  v_mfma_f32_16x16x32_bf16 v[172:175], v[44:47], v[68:71], v[172:175]
  v_mfma_f32_16x16x32_bf16 v[176:179], v[48:51], v[68:71], v[176:179]
  v_mfma_f32_16x16x32_bf16 v[180:183], v[52:55], v[68:71], v[180:183]
  s_add_u32 s54, s54, 196608
  s_lshl_b32 s52, s3, 8
  s_add_u32 s52, s52, 128
  s_cmp_eq_u32 s57, 768
  s_cselect_b32 s54, s52, s54
  v_add_u32 v8, s57, v14
  ds_read_b128 v[16:19], v8 offset:0
  ds_read_b128 v[20:23], v8 offset:16384
  ds_read_b128 v[24:27], v8 offset:32768
  ds_read_b128 v[28:31], v8 offset:49152
  v_add_u32 v8, 0x10000, v8
  ds_read_b128 v[32:35], v8
  v_add_u32 v8, s57, v15
  ds_read_b128 v[36:39], v8 offset:0
  ds_read_b128 v[40:43], v8 offset:16384
  ds_read_b128 v[44:47], v8 offset:32768
  ds_read_b128 v[48:51], v8 offset:49152
  v_add_u32 v8, 0x10000, v8
  ds_read_b128 v[52:55], v8
  s_waitcnt vmcnt(8)
  v_add_u32 v5, s56, v4
  s_add_u32 s56, s56, 4096
  s_cmp_eq_u32 s56, 20480
  s_cselect_b32 s56, 0, s56
  ds_read_b64_tr_b16 v[56:57], v5 offset:0
  ds_read_b64_tr_b16 v[60:61], v5 offset:32
  ds_read_b64_tr_b16 v[58:59], v5 offset:1024
  ds_read_b64_tr_b16 v[62:63], v5 offset:1056
  ds_read_b64_tr_b16 v[64:65], v5 offset:2048
  ds_read_b64_tr_b16 v[68:69], v5 offset:2080
  ds_read_b64_tr_b16 v[66:67], v5 offset:3072
  ds_read_b64_tr_b16 v[70:71], v5 offset:3104
  s_add_u32 m0, s58, s55
  s_add_u32 s52, s54, 0
  buffer_load_dwordx4 v2, s[16:19], s52 offen lds
  s_add_u32 s52, s52, 12288
  s_add_u32 m0, m0, 1024
  s_nop 0
  buffer_load_dwordx4 v2, s[16:19], s52 offen lds
  s_add_u32 s52, s52, 86016
  s_add_u32 m0, m0, 1024
  s_nop 0
  buffer_load_dwordx4 v2, s[16:19], s52 offen lds
  s_add_u32 s52, s52, 12288
  s_add_u32 m0, m0, 1024
  s_nop 0
  buffer_load_dwordx4 v2, s[16:19], s52 offen lds
  s_add_u32 s55, s55, 4096
  s_cmp_eq_u32 s55, 20480
  s_cselect_b32 s55, 0, s55
  s_waitcnt lgkmcnt(0)
  v_mfma_f32_16x16x32_bf16 v[72:75], v[56:59], v[20:23], v[72:75]
  v_mfma_f32_16x16x32_bf16 v[76:79], v[56:59], v[24:27], v[76:79]
  v_mfma_f32_16x16x32_bf16 v[80:83], v[56:59], v[28:31], v[80:83]
  v_mfma_f32_16x16x32_bf16 v[84:87], v[56:59], v[32:35], v[84:87]
  v_mfma_f32_16x16x32_bf16 v[88:91], v[60:63], v[20:23], v[88:91]
  v_mfma_f32_16x16x32_bf16 v[92:95], v[60:63], v[24:27], v[92:95]
  v_mfma_f32_16x16x32_bf16 v[96:99], v[60:63], v[28:31], v[96:99]
  v_mfma_f32_16x16x32_bf16 v[100:103], v[60:63], v[32:35], v[100:103]
  v_mfma_f32_16x16x32_bf16 v[72:75], v[64:67], v[40:43], v[72:75]
  v_mfma_f32_16x16x32_bf16 v[76:79], v[64:67], v[44:47], v[76:79]
  v_mfma_f32_16x16x32_bf16 v[80:83], v[64:67], v[48:51], v[80:83]
  v_mfma_f32_16x16x32_bf16 v[84:87], v[64:67], v[52:55], v[84:87]
  v_mfma_f32_16x16x32_bf16 v[88:91], v[68:71], v[40:43], v[88:91]
  v_mfma_f32_16x16x32_bf16 v[92:95], v[68:71], v[44:47], v[92:95]
  v_mfma_f32_16x16x32_bf16 v[96:99], v[68:71], v[48:51], v[96:99]
  v_mfma_f32_16x16x32_bf16 v[100:103], v[68:71], v[52:55], v[100:103]
  s_waitcnt vmcnt(8)
  v_add_u32 v5, s56, v4
  s_add_u32 s56, s56, 4096
  s_cmp_eq_u32 s56, 20480
  s_cselect_b32 s56, 0, s56
  ds_read_b64_tr_b16 v[56:57], v5 offset:0
  ds_read_b64_tr_b16 v[60:61], v5 offset:32
  ds_read_b64_tr_b16 v[58:59], v5 offset:1024
  ds_read_b64_tr_b16 v[62:63], v5 offset:1056
  ds_read_b64_tr_b16 v[64:65], v5 offset:2048
  ds_read_b64_tr_b16 v[68:69], v5 offset:2080
  ds_read_b64_tr_b16 v[66:67], v5 offset:3072
  ds_read_b64_tr_b16 v[70:71], v5 offset:3104
  s_add_u32 m0, s58, s55
  s_add_u32 s52, s54, 1024
  buffer_load_dwordx4 v2, s[16:19], s52 offen lds
  s_add_u32 s52, s52, 12288
  s_add_u32 m0, m0, 1024
  s_nop 0
  buffer_load_dwordx4 v2, s[16:19], s52 offen lds
  s_add_u32 s52, s52, 86016
  s_add_u32 m0, m0, 1024
  s_nop 0
  buffer_load_dwordx4 v2, s[16:19], s52 offen lds
  s_add_u32 s52, s52, 12288
  s_add_u32 m0, m0, 1024
  s_nop 0
  buffer_load_dwordx4 v2, s[16:19], s52 offen lds
  s_add_u32 s55, s55, 4096
  s_cmp_eq_u32 s55, 20480
  s_cselect_b32 s55, 0, s55
  s_waitcnt lgkmcnt(0)
  v_mfma_f32_16x16x32_bf16 v[104:107], v[56:59], v[16:19], v[104:107]
  v_mfma_f32_16x16x32_bf16 v[108:111], v[56:59], v[20:23], v[108:111]
  v_mfma_f32_16x16x32_bf16 v[112:115], v[56:59], v[24:27], v[112:115]
  v_mfma_f32_16x16x32_bf16 v[116:119], v[56:59], v[28:31], v[116:119]
  v_mfma_f32_16x16x32_bf16 v[120:123], v[56:59], v[32:35], v[120:123]
  v_mfma_f32_16x16x32_bf16 v[124:127], v[60:63], v[16:19], v[124:127]
  v_mfma_f32_16x16x32_bf16 v[128:131], v[60:63], v[20:23], v[128:131]
  v_mfma_f32_16x16x32_bf16 v[132:135], v[60:63], v[24:27], v[132:135]
  v_mfma_f32_16x16x32_bf16 v[136:139], v[60:63], v[28:31], v[136:139]
  v_mfma_f32_16x16x32_bf16 v[140:143], v[60:63], v[32:35], v[140:143]
  v_mfma_f32_16x16x32_bf16 v[104:107], v[64:67], v[36:39], v[104:107]
  v_mfma_f32_16x16x32_bf16 v[108:111], v[64:67], v[40:43], v[108:111]
  v_mfma_f32_16x16x32_bf16 v[112:115], v[64:67], v[44:47], v[112:115]
  v_mfma_f32_16x16x32_bf16 v[116:119], v[64:67], v[48:51], v[116:119]
  v_mfma_f32_16x16x32_bf16 v[120:123], v[64:67], v[52:55], v[120:123]
  v_mfma_f32_16x16x32_bf16 v[124:127], v[68:71], v[36:39], v[124:127]
  v_mfma_f32_16x16x32_bf16 v[128:131], v[68:71], v[40:43], v[128:131]
  v_mfma_f32_16x16x32_bf16 v[132:135], v[68:71], v[44:47], v[132:135]
  v_mfma_f32_16x16x32_bf16 v[136:139], v[68:71], v[48:51], v[136:139]
  v_mfma_f32_16x16x32_bf16 v[140:143], v[68:71], v[52:55], v[140:143]
  s_waitcnt vmcnt(8)
  v_add_u32 v5, s56, v4
  s_add_u32 s56, s56, 4096
  s_cmp_eq_u32 s56, 20480
  s_cselect_b32 s56, 0, s56
  ds_read_b64_tr_b16 v[56:57], v5 offset:0
  ds_read_b64_tr_b16 v[60:61], v5 offset:32
  ds_read_b64_tr_b16 v[58:59], v5 offset:1024
  ds_read_b64_tr_b16 v[62:63], v5 offset:1056
  ds_read_b64_tr_b16 v[64:65], v5 offset:2048
  ds_read_b64_tr_b16 v[68:69], v5 offset:2080
  ds_read_b64_tr_b16 v[66:67], v5 offset:3072
  ds_read_b64_tr_b16 v[70:71], v5 offset:3104
  s_add_u32 m0, s58, s55
  s_add_u32 s52, s54, 2048
  buffer_load_dwordx4 v2, s[16:19], s52 offen lds
  s_add_u32 s52, s52, 12288
  s_add_u32 m0, m0, 1024
  s_nop 0
  buffer_load_dwordx4 v2, s[16:19], s52 offen lds
  s_add_u32 s52, s52, 86016
  s_add_u32 m0, m0, 1024
  s_nop 0
  buffer_load_dwordx4 v2, s[16:19], s52 offen lds
  s_add_u32 s52, s52, 12288
  s_add_u32 m0, m0, 1024
  s_nop 0
  buffer_load_dwordx4 v2, s[16:19], s52 offen lds
  s_add_u32 s55, s55, 4096
  s_cmp_eq_u32 s55, 20480
  s_cselect_b32 s55, 0, s55
  s_waitcnt lgkmcnt(0)
  v_mfma_f32_16x16x32_bf16 v[144:147], v[16:19], v[56:59], v[144:147]
  v_mfma_f32_16x16x32_bf16 v[148:151], v[20:23], v[56:59], v[148:151]
  v_mfma_f32_16x16x32_bf16 v[152:155], v[24:27], v[56:59], v[152:155]
  v_mfma_f32_16x16x32_bf16 v[156:159], v[28:31], v[56:59], v[156:159]
  v_mfma_f32_16x16x32_bf16 v[160:163], v[32:35], v[56:59], v[160:163]
  v_mfma_f32_16x16x32_bf16 v[164:167], v[16:19], v[60:63], v[164:167]
  v_mfma_f32_16x16x32_bf16 v[168:171], v[20:23], v[60:63], v[168:171]
  v_mfma_f32_16x16x32_bf16 v[172:175], v[24:27], v[60:63], v[172:175]
  v_mfma_f32_16x16x32_bf16 v[176:179], v[28:31], v[60:63], v[176:179]
  v_mfma_f32_16x16x32_bf16 v[180:183], v[32:35], v[60:63], v[180:183]
  v_mfma_f32_16x16x32_bf16 v[144:147], v[36:39], v[64:67], v[144:147]
  v_mfma_f32_16x16x32_bf16 v[148:151], v[40:43], v[64:67], v[148:151]
  v_mfma_f32_16x16x32_bf16 v[152:155], v[44:47], v[64:67], v[152:155]
  v_mfma_f32_16x16x32_bf16 v[156:159], v[48:51], v[64:67], v[156:159]
  v_mfma_f32_16x16x32_bf16 v[160:163], v[52:55], v[64:67], v[160:163]
  v_mfma_f32_16x16x32_bf16 v[164:167], v[36:39], v[68:71], v[164:167]
  v_mfma_f32_16x16x32_bf16 v[168:171], v[40:43], v[68:71], v[168:171]
  v_mfma_f32_16x16x32_bf16 v[172:175], v[44:47], v[68:71], v[172:175]
  v_mfma_f32_16x16x32_bf16 v[176:179], v[48:51], v[68:71], v[176:179]
  v_mfma_f32_16x16x32_bf16 v[180:183], v[52:55], v[68:71], v[180:183]
  s_add_u32 s57, s57, 256
  s_cmp_lt_u32 s57, 1024
  s_cbranch_scc1 L_x_kb1
  s_nop 4
  s_nop 7
  v_cvt_pk_bf16_f32 v72, v72, v73
  v_cvt_pk_bf16_f32 v73, v74, v75
  v_cvt_pk_bf16_f32 v74, v76, v77
  v_cvt_pk_bf16_f32 v75, v78, v79
  v_cvt_pk_bf16_f32 v76, v80, v81
  v_cvt_pk_bf16_f32 v77, v82, v83
  v_cvt_pk_bf16_f32 v78, v84, v85
  v_cvt_pk_bf16_f32 v79, v86, v87
  v_cvt_pk_bf16_f32 v80, v88, v89
  v_cvt_pk_bf16_f32 v81, v90, v91
  v_cvt_pk_bf16_f32 v82, v92, v93
  v_cvt_pk_bf16_f32 v83, v94, v95
  v_cvt_pk_bf16_f32 v84, v96, v97
  v_cvt_pk_bf16_f32 v85, v98, v99
  v_cvt_pk_bf16_f32 v86, v100, v101
  v_cvt_pk_bf16_f32 v87, v102, v103
  v_cvt_pk_bf16_f32 v104, v104, v105
  v_cvt_pk_bf16_f32 v105, v106, v107
  v_cvt_pk_bf16_f32 v106, v108, v109
  v_cvt_pk_bf16_f32 v107, v110, v111
  v_cvt_pk_bf16_f32 v108, v112, v113
  v_cvt_pk_bf16_f32 v109, v114, v115
  v_cvt_pk_bf16_f32 v110, v116, v117
  v_cvt_pk_bf16_f32 v111, v118, v119
  v_cvt_pk_bf16_f32 v112, v120, v121
  v_cvt_pk_bf16_f32 v113, v122, v123
  v_cvt_pk_bf16_f32 v114, v124, v125
  v_cvt_pk_bf16_f32 v115, v126, v127
  v_cvt_pk_bf16_f32 v116, v128, v129
  v_cvt_pk_bf16_f32 v117, v130, v131
  v_cvt_pk_bf16_f32 v118, v132, v133
  v_cvt_pk_bf16_f32 v119, v134, v135
  v_cvt_pk_bf16_f32 v120, v136, v137
  v_cvt_pk_bf16_f32 v121, v138, v139
  v_cvt_pk_bf16_f32 v122, v140, v141
  v_cvt_pk_bf16_f32 v123, v142, v143
  v_cvt_pk_bf16_f32 v144, v144, v145
  v_cvt_pk_bf16_f32 v145, v146, v147
  v_cvt_pk_bf16_f32 v146, v148, v149
  v_cvt_pk_bf16_f32 v147, v150, v151
  v_cvt_pk_bf16_f32 v148, v152, v153
  v_cvt_pk_bf16_f32 v149, v154, v155
  v_cvt_pk_bf16_f32 v150, v156, v157
  v_cvt_pk_bf16_f32 v151, v158, v159
  v_cvt_pk_bf16_f32 v152, v160, v161
  v_cvt_pk_bf16_f32 v153, v162, v163
  v_cvt_pk_bf16_f32 v154, v164, v165
  v_cvt_pk_bf16_f32 v155, v166, v167
  v_cvt_pk_bf16_f32 v156, v168, v169
  v_cvt_pk_bf16_f32 v157, v170, v171
  v_cvt_pk_bf16_f32 v158, v172, v173
  v_cvt_pk_bf16_f32 v159, v174, v175
  v_cvt_pk_bf16_f32 v160, v176, v177
  v_cvt_pk_bf16_f32 v161, v178, v179
  v_cvt_pk_bf16_f32 v162, v180, v181
  v_cvt_pk_bf16_f32 v163, v182, v183
  v_mfma_f32_16x16x16_bf16 v[16:19], v[104:105], v[72:73], 0
  v_mfma_f32_16x16x16_bf16 v[20:23], v[106:107], v[72:73], 0
  s_nop 6
  v_cndmask_b32 v16, v6, v16, s[44:45]
  v_cndmask_b32 v17, v6, v17, s[46:47]
  v_cndmask_b32 v18, v6, v18, s[48:49]
  v_cndmask_b32 v19, v6, v19, s[50:51]
  v_cndmask_b32 v20, v6, v20, s[70:71]
  v_cndmask_b32 v21, v6, v21, s[72:73]
  v_cndmask_b32 v22, v6, v22, s[74:75]
  v_cndmask_b32 v23, v6, v23, s[76:77]
  v_max3_f32 v32, v16, v17, v18
  v_max3_f32 v32, v32, v19, v20
  v_max3_f32 v32, v32, v21, v22
  v_max_f32 v32, v32, v23
  v_mov_b32 v34, v32
  v_mov_b32 v35, v32
  s_nop 1
  v_permlane32_swap_b32 v34, v35
  v_max_f32 v36, v34, v35
  v_max_f32 v37, v34, v35
  s_nop 1
  v_permlane16_swap_b32 v36, v37
  v_max_f32 v34, v36, v37
  v_mul_f32 v32, s60, v34
  v_fma_f32 v16, v16, s59, v32
  v_fma_f32 v17, v17, s59, v32
  v_fma_f32 v18, v18, s59, v32
  v_fma_f32 v19, v19, s59, v32
  v_fma_f32 v20, v20, s59, v32
  v_fma_f32 v21, v21, s59, v32
  v_fma_f32 v22, v22, s59, v32
  v_fma_f32 v23, v23, s59, v32
  v_exp_f32 v16, v16
  v_exp_f32 v17, v17
  v_exp_f32 v18, v18
  v_exp_f32 v19, v19
  v_exp_f32 v20, v20
  v_exp_f32 v21, v21
  v_exp_f32 v22, v22
  v_exp_f32 v23, v23
  v_cvt_pk_bf16_f32 v24, v16, v17
  v_cvt_pk_bf16_f32 v25, v18, v19
  v_cvt_pk_bf16_f32 v26, v20, v21
  v_cvt_pk_bf16_f32 v27, v22, v23
  v_add_f32 v32, v16, v17
  v_add_f32 v32, v32, v18
  v_mfma_f32_16x16x32_bf16 v[28:31], v[144:147], v[24:27], 0
  v_add_f32 v32, v32, v19
  v_add_f32 v32, v32, v20
  v_add_f32 v32, v32, v21
  v_add_f32 v32, v32, v22
  v_add_f32 v32, v32, v23
  v_mov_b32 v34, v32
  v_mov_b32 v35, v32
  s_nop 1
  v_permlane32_swap_b32 v34, v35
  v_add_f32 v36, v34, v35
  v_add_f32 v37, v34, v35
  s_nop 1
  v_permlane16_swap_b32 v36, v37
  v_add_f32 v34, v36, v37
  v_rcp_f32 v34, v34
  s_nop 0
  v_mul_f32 v28, v28, v34
  v_mul_f32 v29, v29, v34
  v_mul_f32 v30, v30, v34
  v_mul_f32 v31, v31, v34
  v_cvt_pk_bf16_f32 v200, v28, v29
  v_cvt_pk_bf16_f32 v201, v30, v31
  v_mfma_f32_16x16x16_bf16 v[16:19], v[106:107], v[74:75], 0
  v_mfma_f32_16x16x16_bf16 v[20:23], v[108:109], v[74:75], 0
  s_nop 6
  v_cndmask_b32 v16, v6, v16, s[62:63]
  v_cndmask_b32 v17, v6, v17, s[64:65]
  v_cndmask_b32 v18, v6, v18, s[66:67]
  v_cndmask_b32 v19, v6, v19, s[68:69]
  v_cndmask_b32 v20, v6, v20, s[70:71]
  v_cndmask_b32 v21, v6, v21, s[72:73]
  v_cndmask_b32 v22, v6, v22, s[74:75]
  v_cndmask_b32 v23, v6, v23, s[76:77]
  v_max3_f32 v32, v16, v17, v18
  v_max3_f32 v32, v32, v19, v20
  v_max3_f32 v32, v32, v21, v22
  v_max_f32 v32, v32, v23
  v_mov_b32 v34, v32
  v_mov_b32 v35, v32
  s_nop 1
  v_permlane32_swap_b32 v34, v35
  v_max_f32 v36, v34, v35
  v_max_f32 v37, v34, v35
  s_nop 1
  v_permlane16_swap_b32 v36, v37
  v_max_f32 v34, v36, v37
  v_mul_f32 v32, s60, v34
  v_fma_f32 v16, v16, s59, v32
  v_fma_f32 v17, v17, s59, v32
  v_fma_f32 v18, v18, s59, v32
  v_fma_f32 v19, v19, s59, v32
  v_fma_f32 v20, v20, s59, v32
  v_fma_f32 v21, v21, s59, v32
  v_fma_f32 v22, v22, s59, v32
  v_fma_f32 v23, v23, s59, v32
  v_exp_f32 v16, v16
  v_exp_f32 v17, v17
  v_exp_f32 v18, v18
  v_exp_f32 v19, v19
  v_exp_f32 v20, v20
  v_exp_f32 v21, v21
  v_exp_f32 v22, v22
  v_exp_f32 v23, v23
  v_cvt_pk_bf16_f32 v24, v16, v17
  v_cvt_pk_bf16_f32 v25, v18, v19
  v_cvt_pk_bf16_f32 v26, v20, v21
  v_cvt_pk_bf16_f32 v27, v22, v23
  v_add_f32 v32, v16, v17
  v_add_f32 v32, v32, v18
  v_mfma_f32_16x16x32_bf16 v[28:31], v[146:149], v[24:27], 0
  v_add_f32 v32, v32, v19
  v_add_f32 v32, v32, v20
  v_add_f32 v32, v32, v21
  v_add_f32 v32, v32, v22
  v_add_f32 v32, v32, v23
  v_mov_b32 v34, v32
  v_mov_b32 v35, v32
  s_nop 1
  v_permlane32_swap_b32 v34, v35
  v_add_f32 v36, v34, v35
  v_add_f32 v37, v34, v35
  s_nop 1
  v_permlane16_swap_b32 v36, v37
  v_add_f32 v34, v36, v37
  v_rcp_f32 v34, v34
  s_nop 0
  v_mul_f32 v28, v28, v34
  v_mul_f32 v29, v29, v34
  v_mul_f32 v30, v30, v34
  v_mul_f32 v31, v31, v34
  v_cvt_pk_bf16_f32 v204, v28, v29
  v_cvt_pk_bf16_f32 v205, v30, v31
  v_mfma_f32_16x16x16_bf16 v[16:19], v[108:109], v[76:77], 0
  v_mfma_f32_16x16x16_bf16 v[20:23], v[110:111], v[76:77], 0
  s_nop 6
  v_cndmask_b32 v16, v6, v16, s[62:63]
  v_cndmask_b32 v17, v6, v17, s[64:65]
  v_cndmask_b32 v18, v6, v18, s[66:67]
  v_cndmask_b32 v19, v6, v19, s[68:69]
  v_cndmask_b32 v20, v6, v20, s[70:71]
  v_cndmask_b32 v21, v6, v21, s[72:73]
  v_cndmask_b32 v22, v6, v22, s[74:75]
  v_cndmask_b32 v23, v6, v23, s[76:77]
  v_max3_f32 v32, v16, v17, v18
  v_max3_f32 v32, v32, v19, v20
  v_max3_f32 v32, v32, v21, v22
  v_max_f32 v32, v32, v23
  v_mov_b32 v34, v32
  v_mov_b32 v35, v32
  s_nop 1
  v_permlane32_swap_b32 v34, v35
  v_max_f32 v36, v34, v35
  v_max_f32 v37, v34, v35
  s_nop 1
  v_permlane16_swap_b32 v36, v37
  v_max_f32 v34, v36, v37
  v_mul_f32 v32, s60, v34
  v_fma_f32 v16, v16, s59, v32
  v_fma_f32 v17, v17, s59, v32
  v_fma_f32 v18, v18, s59, v32
  v_fma_f32 v19, v19, s59, v32
  v_fma_f32 v20, v20, s59, v32
  v_fma_f32 v21, v21, s59, v32
  v_fma_f32 v22, v22, s59, v32
  v_fma_f32 v23, v23, s59, v32
  v_exp_f32 v16, v16
  v_exp_f32 v17, v17
  v_exp_f32 v18, v18
  v_exp_f32 v19, v19
  v_exp_f32 v20, v20
  v_exp_f32 v21, v21
  v_exp_f32 v22, v22
  v_exp_f32 v23, v23
  v_cvt_pk_bf16_f32 v24, v16, v17
  v_cvt_pk_bf16_f32 v25, v18, v19
  v_cvt_pk_bf16_f32 v26, v20, v21
  v_cvt_pk_bf16_f32 v27, v22, v23
  v_add_f32 v32, v16, v17
  v_add_f32 v32, v32, v18
  v_mfma_f32_16x16x32_bf16 v[28:31], v[148:151], v[24:27], 0
  v_add_f32 v32, v32, v19
  v_add_f32 v32, v32, v20
  v_add_f32 v32, v32, v21
  v_add_f32 v32, v32, v22
  v_add_f32 v32, v32, v23
  v_mov_b32 v34, v32
  v_mov_b32 v35, v32
  s_nop 1
  v_permlane32_swap_b32 v34, v35
  v_add_f32 v36, v34, v35
  v_add_f32 v37, v34, v35
  s_nop 1
  v_permlane16_swap_b32 v36, v37
  v_add_f32 v34, v36, v37
  v_rcp_f32 v34, v34
  s_nop 0
  v_mul_f32 v28, v28, v34
  v_mul_f32 v29, v29, v34
  v_mul_f32 v30, v30, v34
  v_mul_f32 v31, v31, v34
  v_cvt_pk_bf16_f32 v208, v28, v29
  v_cvt_pk_bf16_f32 v209, v30, v31
  v_mfma_f32_16x16x16_bf16 v[16:19], v[110:111], v[78:79], 0
  v_mfma_f32_16x16x16_bf16 v[20:23], v[112:113], v[78:79], 0
  s_nop 6
  v_cndmask_b32 v16, v6, v16, s[62:63]
  v_cndmask_b32 v17, v6, v17, s[64:65]
  v_cndmask_b32 v18, v6, v18, s[66:67]
  v_cndmask_b32 v19, v6, v19, s[68:69]
  v_cndmask_b32 v20, v6, v20, s[70:71]
  v_cndmask_b32 v21, v6, v21, s[72:73]
  v_cndmask_b32 v22, v6, v22, s[74:75]
  v_cndmask_b32 v23, v6, v23, s[76:77]
  v_max3_f32 v32, v16, v17, v18
  v_max3_f32 v32, v32, v19, v20
  v_max3_f32 v32, v32, v21, v22
  v_max_f32 v32, v32, v23
  v_mov_b32 v34, v32
  v_mov_b32 v35, v32
  s_nop 1
  v_permlane32_swap_b32 v34, v35
  v_max_f32 v36, v34, v35
  v_max_f32 v37, v34, v35
  s_nop 1
  v_permlane16_swap_b32 v36, v37
  v_max_f32 v34, v36, v37
  v_mul_f32 v32, s60, v34
  v_fma_f32 v16, v16, s59, v32
  v_fma_f32 v17, v17, s59, v32
  v_fma_f32 v18, v18, s59, v32
  v_fma_f32 v19, v19, s59, v32
  v_fma_f32 v20, v20, s59, v32
  v_fma_f32 v21, v21, s59, v32
  v_fma_f32 v22, v22, s59, v32
  v_fma_f32 v23, v23, s59, v32
  v_exp_f32 v16, v16
  v_exp_f32 v17, v17
  v_exp_f32 v18, v18
  v_exp_f32 v19, v19
  v_exp_f32 v20, v20
  v_exp_f32 v21, v21
  v_exp_f32 v22, v22
  v_exp_f32 v23, v23
  v_cvt_pk_bf16_f32 v24, v16, v17
  v_cvt_pk_bf16_f32 v25, v18, v19
  v_cvt_pk_bf16_f32 v26, v20, v21
  v_cvt_pk_bf16_f32 v27, v22, v23
  v_add_f32 v32, v16, v17
  v_add_f32 v32, v32, v18
  v_mfma_f32_16x16x32_bf16 v[28:31], v[150:153], v[24:27], 0
  v_add_f32 v32, v32, v19
  v_add_f32 v32, v32, v20
  v_add_f32 v32, v32, v21
  v_add_f32 v32, v32, v22
  v_add_f32 v32, v32, v23
  v_mov_b32 v34, v32
  v_mov_b32 v35, v32
  s_nop 1
  v_permlane32_swap_b32 v34, v35
  v_add_f32 v36, v34, v35
  v_add_f32 v37, v34, v35
  s_nop 1
  v_permlane16_swap_b32 v36, v37
  v_add_f32 v34, v36, v37
  v_rcp_f32 v34, v34
  s_nop 0
  v_mul_f32 v28, v28, v34
  v_mul_f32 v29, v29, v34
  v_mul_f32 v30, v30, v34
  v_mul_f32 v31, v31, v34
  v_cvt_pk_bf16_f32 v212, v28, v29
  v_cvt_pk_bf16_f32 v213, v30, v31
  v_mfma_f32_16x16x16_bf16 v[16:19], v[114:115], v[80:81], 0
  v_mfma_f32_16x16x16_bf16 v[20:23], v[116:117], v[80:81], 0
  s_nop 6
  v_cndmask_b32 v16, v6, v16, s[44:45]
  v_cndmask_b32 v17, v6, v17, s[46:47]
  v_cndmask_b32 v18, v6, v18, s[48:49]
  v_cndmask_b32 v19, v6, v19, s[50:51]
  v_cndmask_b32 v20, v6, v20, s[70:71]
  v_cndmask_b32 v21, v6, v21, s[72:73]
  v_cndmask_b32 v22, v6, v22, s[74:75]
  v_cndmask_b32 v23, v6, v23, s[76:77]
  v_max3_f32 v32, v16, v17, v18
  v_max3_f32 v32, v32, v19, v20
  v_max3_f32 v32, v32, v21, v22
  v_max_f32 v32, v32, v23
  v_mov_b32 v34, v32
  v_mov_b32 v35, v32
  s_nop 1
  v_permlane32_swap_b32 v34, v35
  v_max_f32 v36, v34, v35
  v_max_f32 v37, v34, v35
  s_nop 1
  v_permlane16_swap_b32 v36, v37
  v_max_f32 v34, v36, v37
  v_mul_f32 v32, s60, v34
  v_fma_f32 v16, v16, s59, v32
  v_fma_f32 v17, v17, s59, v32
  v_fma_f32 v18, v18, s59, v32
  v_fma_f32 v19, v19, s59, v32
  v_fma_f32 v20, v20, s59, v32
  v_fma_f32 v21, v21, s59, v32
  v_fma_f32 v22, v22, s59, v32
  v_fma_f32 v23, v23, s59, v32
  v_exp_f32 v16, v16
  v_exp_f32 v17, v17
  v_exp_f32 v18, v18
  v_exp_f32 v19, v19
  v_exp_f32 v20, v20
  v_exp_f32 v21, v21
  v_exp_f32 v22, v22
  v_exp_f32 v23, v23
  v_cvt_pk_bf16_f32 v24, v16, v17
  v_cvt_pk_bf16_f32 v25, v18, v19
  v_cvt_pk_bf16_f32 v26, v20, v21
  v_cvt_pk_bf16_f32 v27, v22, v23
  v_add_f32 v32, v16, v17
  v_add_f32 v32, v32, v18
  v_mfma_f32_16x16x32_bf16 v[28:31], v[154:157], v[24:27], 0
  v_add_f32 v32, v32, v19
  v_add_f32 v32, v32, v20
  v_add_f32 v32, v32, v21
  v_add_f32 v32, v32, v22
  v_add_f32 v32, v32, v23
  v_mov_b32 v34, v32
  v_mov_b32 v35, v32
  s_nop 1
  v_permlane32_swap_b32 v34, v35
  v_add_f32 v36, v34, v35
  v_add_f32 v37, v34, v35
  s_nop 1
  v_permlane16_swap_b32 v36, v37
  v_add_f32 v34, v36, v37
  v_rcp_f32 v34, v34
  s_nop 0
  v_mul_f32 v28, v28, v34
  v_mul_f32 v29, v29, v34
  v_mul_f32 v30, v30, v34
  v_mul_f32 v31, v31, v34
  v_cvt_pk_bf16_f32 v202, v28, v29
  v_cvt_pk_bf16_f32 v203, v30, v31
  v_mfma_f32_16x16x16_bf16 v[16:19], v[116:117], v[82:83], 0
  v_mfma_f32_16x16x16_bf16 v[20:23], v[118:119], v[82:83], 0
  s_nop 6
  v_cndmask_b32 v16, v6, v16, s[62:63]
  v_cndmask_b32 v17, v6, v17, s[64:65]
  v_cndmask_b32 v18, v6, v18, s[66:67]
  v_cndmask_b32 v19, v6, v19, s[68:69]
  v_cndmask_b32 v20, v6, v20, s[70:71]
  v_cndmask_b32 v21, v6, v21, s[72:73]
  v_cndmask_b32 v22, v6, v22, s[74:75]
  v_cndmask_b32 v23, v6, v23, s[76:77]
  v_max3_f32 v32, v16, v17, v18
  v_max3_f32 v32, v32, v19, v20
  v_max3_f32 v32, v32, v21, v22
  v_max_f32 v32, v32, v23
  v_mov_b32 v34, v32
  v_mov_b32 v35, v32
  s_nop 1
  v_permlane32_swap_b32 v34, v35
  v_max_f32 v36, v34, v35
  v_max_f32 v37, v34, v35
  s_nop 1
  v_permlane16_swap_b32 v36, v37
  v_max_f32 v34, v36, v37
  v_mul_f32 v32, s60, v34
  v_fma_f32 v16, v16, s59, v32
  v_fma_f32 v17, v17, s59, v32
  v_fma_f32 v18, v18, s59, v32
  v_fma_f32 v19, v19, s59, v32
  v_fma_f32 v20, v20, s59, v32
  v_fma_f32 v21, v21, s59, v32
  v_fma_f32 v22, v22, s59, v32
  v_fma_f32 v23, v23, s59, v32
  v_exp_f32 v16, v16
  v_exp_f32 v17, v17
  v_exp_f32 v18, v18
  v_exp_f32 v19, v19
  v_exp_f32 v20, v20
  v_exp_f32 v21, v21
  v_exp_f32 v22, v22
  v_exp_f32 v23, v23
  v_cvt_pk_bf16_f32 v24, v16, v17
  v_cvt_pk_bf16_f32 v25, v18, v19
  v_cvt_pk_bf16_f32 v26, v20, v21
  v_cvt_pk_bf16_f32 v27, v22, v23
  v_add_f32 v32, v16, v17
  v_add_f32 v32, v32, v18
  v_mfma_f32_16x16x32_bf16 v[28:31], v[156:159], v[24:27], 0
  v_add_f32 v32, v32, v19
  v_add_f32 v32, v32, v20
  v_add_f32 v32, v32, v21
  v_add_f32 v32, v32, v22
  v_add_f32 v32, v32, v23
  v_mov_b32 v34, v32
  v_mov_b32 v35, v32
  s_nop 1
  v_permlane32_swap_b32 v34, v35
  v_add_f32 v36, v34, v35
  v_add_f32 v37, v34, v35
  s_nop 1
  v_permlane16_swap_b32 v36, v37
  v_add_f32 v34, v36, v37
  v_rcp_f32 v34, v34
  s_nop 0
  v_mul_f32 v28, v28, v34
  v_mul_f32 v29, v29, v34
  v_mul_f32 v30, v30, v34
  v_mul_f32 v31, v31, v34
  v_cvt_pk_bf16_f32 v206, v28, v29
  v_cvt_pk_bf16_f32 v207, v30, v31
  v_mfma_f32_16x16x16_bf16 v[16:19], v[118:119], v[84:85], 0
  v_mfma_f32_16x16x16_bf16 v[20:23], v[120:121], v[84:85], 0
  s_nop 6
  v_cndmask_b32 v16, v6, v16, s[62:63]
  v_cndmask_b32 v17, v6, v17, s[64:65]
  v_cndmask_b32 v18, v6, v18, s[66:67]
  v_cndmask_b32 v19, v6, v19, s[68:69]
  v_cndmask_b32 v20, v6, v20, s[70:71]
  v_cndmask_b32 v21, v6, v21, s[72:73]
  v_cndmask_b32 v22, v6, v22, s[74:75]
  v_cndmask_b32 v23, v6, v23, s[76:77]
  v_max3_f32 v32, v16, v17, v18
  v_max3_f32 v32, v32, v19, v20
  v_max3_f32 v32, v32, v21, v22
  v_max_f32 v32, v32, v23
  v_mov_b32 v34, v32
  v_mov_b32 v35, v32
  s_nop 1
  v_permlane32_swap_b32 v34, v35
  v_max_f32 v36, v34, v35
  v_max_f32 v37, v34, v35
  s_nop 1
  v_permlane16_swap_b32 v36, v37
  v_max_f32 v34, v36, v37
  v_mul_f32 v32, s60, v34
  v_fma_f32 v16, v16, s59, v32
  v_fma_f32 v17, v17, s59, v32
  v_fma_f32 v18, v18, s59, v32
  v_fma_f32 v19, v19, s59, v32
  v_fma_f32 v20, v20, s59, v32
  v_fma_f32 v21, v21, s59, v32
  v_fma_f32 v22, v22, s59, v32
  v_fma_f32 v23, v23, s59, v32
  v_exp_f32 v16, v16
  v_exp_f32 v17, v17
  v_exp_f32 v18, v18
  v_exp_f32 v19, v19
  v_exp_f32 v20, v20
  v_exp_f32 v21, v21
  v_exp_f32 v22, v22
  v_exp_f32 v23, v23
  v_cvt_pk_bf16_f32 v24, v16, v17
  v_cvt_pk_bf16_f32 v25, v18, v19
  v_cvt_pk_bf16_f32 v26, v20, v21
  v_cvt_pk_bf16_f32 v27, v22, v23
  v_add_f32 v32, v16, v17
  v_add_f32 v32, v32, v18
  v_mfma_f32_16x16x32_bf16 v[28:31], v[158:161], v[24:27], 0
  v_add_f32 v32, v32, v19
  v_add_f32 v32, v32, v20
  v_add_f32 v32, v32, v21
  v_add_f32 v32, v32, v22
  v_add_f32 v32, v32, v23
  v_mov_b32 v34, v32
  v_mov_b32 v35, v32
  s_nop 1
  v_permlane32_swap_b32 v34, v35
  v_add_f32 v36, v34, v35
  v_add_f32 v37, v34, v35
  s_nop 1
  v_permlane16_swap_b32 v36, v37
  v_add_f32 v34, v36, v37
  v_rcp_f32 v34, v34
  s_nop 0
  v_mul_f32 v28, v28, v34
  v_mul_f32 v29, v29, v34
  v_mul_f32 v30, v30, v34
  v_mul_f32 v31, v31, v34
  v_cvt_pk_bf16_f32 v210, v28, v29
  v_cvt_pk_bf16_f32 v211, v30, v31
  v_mfma_f32_16x16x16_bf16 v[16:19], v[120:121], v[86:87], 0
  v_mfma_f32_16x16x16_bf16 v[20:23], v[122:123], v[86:87], 0
  s_nop 6
  v_cndmask_b32 v16, v6, v16, s[62:63]
  v_cndmask_b32 v17, v6, v17, s[64:65]
  v_cndmask_b32 v18, v6, v18, s[66:67]
  v_cndmask_b32 v19, v6, v19, s[68:69]
  v_cndmask_b32 v20, v6, v20, s[70:71]
  v_cndmask_b32 v21, v6, v21, s[72:73]
  v_cndmask_b32 v22, v6, v22, s[74:75]
  v_cndmask_b32 v23, v6, v23, s[76:77]
  v_max3_f32 v32, v16, v17, v18
  v_max3_f32 v32, v32, v19, v20
  v_max3_f32 v32, v32, v21, v22
  v_max_f32 v32, v32, v23
  v_mov_b32 v34, v32
  v_mov_b32 v35, v32
  s_nop 1
  v_permlane32_swap_b32 v34, v35
  v_max_f32 v36, v34, v35
  v_max_f32 v37, v34, v35
  s_nop 1
  v_permlane16_swap_b32 v36, v37
  v_max_f32 v34, v36, v37
  v_mul_f32 v32, s60, v34
  v_fma_f32 v16, v16, s59, v32
  v_fma_f32 v17, v17, s59, v32
  v_fma_f32 v18, v18, s59, v32
  v_fma_f32 v19, v19, s59, v32
  v_fma_f32 v20, v20, s59, v32
  v_fma_f32 v21, v21, s59, v32
  v_fma_f32 v22, v22, s59, v32
  v_fma_f32 v23, v23, s59, v32
  v_exp_f32 v16, v16
  v_exp_f32 v17, v17
  v_exp_f32 v18, v18
  v_exp_f32 v19, v19
  v_exp_f32 v20, v20
  v_exp_f32 v21, v21
  v_exp_f32 v22, v22
  v_exp_f32 v23, v23
  v_cvt_pk_bf16_f32 v24, v16, v17
  v_cvt_pk_bf16_f32 v25, v18, v19
  v_cvt_pk_bf16_f32 v26, v20, v21
  v_cvt_pk_bf16_f32 v27, v22, v23
  v_add_f32 v32, v16, v17
  v_add_f32 v32, v32, v18
  v_mfma_f32_16x16x32_bf16 v[28:31], v[160:163], v[24:27], 0
  v_add_f32 v32, v32, v19
  v_add_f32 v32, v32, v20
  v_add_f32 v32, v32, v21
  v_add_f32 v32, v32, v22
  v_add_f32 v32, v32, v23
  v_mov_b32 v34, v32
  v_mov_b32 v35, v32
  s_nop 1
  v_permlane32_swap_b32 v34, v35
  v_add_f32 v36, v34, v35
  v_add_f32 v37, v34, v35
  s_nop 1
  v_permlane16_swap_b32 v36, v37
  v_add_f32 v34, v36, v37
  v_rcp_f32 v34, v34
  s_nop 0
  v_mul_f32 v28, v28, v34
  v_mul_f32 v29, v29, v34
  v_mul_f32 v30, v30, v34
  v_mul_f32 v31, v31, v34
  v_cvt_pk_bf16_f32 v214, v28, v29
  v_cvt_pk_bf16_f32 v215, v30, v31
  v_mov_b64 v[72:73], 0
  v_mov_b64 v[74:75], 0
  v_mov_b64 v[76:77], 0
  v_mov_b64 v[78:79], 0
  v_mov_b64 v[80:81], 0
  v_mov_b64 v[82:83], 0
  v_mov_b64 v[84:85], 0
  v_mov_b64 v[86:87], 0
  v_mov_b64 v[88:89], 0
  v_mov_b64 v[90:91], 0
  v_mov_b64 v[92:93], 0
  v_mov_b64 v[94:95], 0
  v_mov_b64 v[96:97], 0
  v_mov_b64 v[98:99], 0
  v_mov_b64 v[100:101], 0
  v_mov_b64 v[102:103], 0
  v_mov_b64 v[104:105], 0
  v_mov_b64 v[106:107], 0
  v_mov_b64 v[108:109], 0
  v_mov_b64 v[110:111], 0
  v_mov_b64 v[112:113], 0
  v_mov_b64 v[114:115], 0
  v_mov_b64 v[116:117], 0
  v_mov_b64 v[118:119], 0
  v_mov_b64 v[120:121], 0
  v_mov_b64 v[122:123], 0
  v_mov_b64 v[124:125], 0
  v_mov_b64 v[126:127], 0
  v_mov_b64 v[128:129], 0
  v_mov_b64 v[130:131], 0
  v_mov_b64 v[132:133], 0
  v_mov_b64 v[134:135], 0
  v_mov_b64 v[136:137], 0
  v_mov_b64 v[138:139], 0
  v_mov_b64 v[140:141], 0
  v_mov_b64 v[142:143], 0
  v_mov_b64 v[144:145], 0
  v_mov_b64 v[146:147], 0
  v_mov_b64 v[148:149], 0
  v_mov_b64 v[150:151], 0
  v_mov_b64 v[152:153], 0
  v_mov_b64 v[154:155], 0
  v_mov_b64 v[156:157], 0
  v_mov_b64 v[158:159], 0
  v_mov_b64 v[160:161], 0
  v_mov_b64 v[162:163], 0
  v_mov_b64 v[164:165], 0
  v_mov_b64 v[166:167], 0
  v_mov_b64 v[168:169], 0
  v_mov_b64 v[170:171], 0
  v_mov_b64 v[172:173], 0
  v_mov_b64 v[174:175], 0
  v_mov_b64 v[176:177], 0
  v_mov_b64 v[178:179], 0
  v_mov_b64 v[180:181], 0
  v_mov_b64 v[182:183], 0
  s_mov_b32 s57, 0
L_x_kb2:
  s_add_u32 s54, s54, 196608
  v_add_u32 v8, s57, v12
  ds_read_b128 v[16:19], v8 offset:0
  ds_read_b128 v[20:23], v8 offset:16384
  ds_read_b128 v[24:27], v8 offset:32768
  ds_read_b128 v[28:31], v8 offset:49152
  v_add_u32 v8, 0x10000, v8
  ds_read_b128 v[32:35], v8
  v_add_u32 v8, s57, v13
  ds_read_b128 v[36:39], v8 offset:0
  ds_read_b128 v[40:43], v8 offset:16384
  ds_read_b128 v[44:47], v8 offset:32768
  ds_read_b128 v[48:51], v8 offset:49152
  v_add_u32 v8, 0x10000, v8
  ds_read_b128 v[52:55], v8
  s_waitcnt vmcnt(8)
  v_add_u32 v5, s56, v4
  s_add_u32 s56, s56, 4096
  s_cmp_eq_u32 s56, 20480
  s_cselect_b32 s56, 0, s56
  ds_read_b64_tr_b16 v[56:57], v5 offset:0
  ds_read_b64_tr_b16 v[60:61], v5 offset:32
  ds_read_b64_tr_b16 v[58:59], v5 offset:1024
  ds_read_b64_tr_b16 v[62:63], v5 offset:1056
  ds_read_b64_tr_b16 v[64:65], v5 offset:2048
  ds_read_b64_tr_b16 v[68:69], v5 offset:2080
  ds_read_b64_tr_b16 v[66:67], v5 offset:3072
  ds_read_b64_tr_b16 v[70:71], v5 offset:3104
  s_add_u32 m0, s58, s55
  s_add_u32 s52, s54, 0
  buffer_load_dwordx4 v2, s[16:19], s52 offen lds
  s_add_u32 s52, s52, 12288
  s_add_u32 m0, m0, 1024
  s_nop 0
  buffer_load_dwordx4 v2, s[16:19], s52 offen lds
  s_add_u32 s52, s52, 86016
  s_add_u32 m0, m0, 1024
  s_nop 0
  buffer_load_dwordx4 v2, s[16:19], s52 offen lds
  s_add_u32 s52, s52, 12288
  s_add_u32 m0, m0, 1024
  s_nop 0
  buffer_load_dwordx4 v2, s[16:19], s52 offen lds
  s_add_u32 s55, s55, 4096
  s_cmp_eq_u32 s55, 20480
  s_cselect_b32 s55, 0, s55
  s_waitcnt lgkmcnt(0)
  v_mfma_f32_16x16x32_bf16 v[72:75], v[56:59], v[20:23], v[72:75]
  v_mfma_f32_16x16x32_bf16 v[76:79], v[56:59], v[24:27], v[76:79]
  v_mfma_f32_16x16x32_bf16 v[80:83], v[56:59], v[28:31], v[80:83]
  v_mfma_f32_16x16x32_bf16 v[84:87], v[56:59], v[32:35], v[84:87]
  v_mfma_f32_16x16x32_bf16 v[88:91], v[60:63], v[20:23], v[88:91]
  v_mfma_f32_16x16x32_bf16 v[92:95], v[60:63], v[24:27], v[92:95]
  v_mfma_f32_16x16x32_bf16 v[96:99], v[60:63], v[28:31], v[96:99]
  v_mfma_f32_16x16x32_bf16 v[100:103], v[60:63], v[32:35], v[100:103]
  v_mfma_f32_16x16x32_bf16 v[72:75], v[64:67], v[40:43], v[72:75]
  v_mfma_f32_16x16x32_bf16 v[76:79], v[64:67], v[44:47], v[76:79]
  v_mfma_f32_16x16x32_bf16 v[80:83], v[64:67], v[48:51], v[80:83]
  v_mfma_f32_16x16x32_bf16 v[84:87], v[64:67], v[52:55], v[84:87]
  v_mfma_f32_16x16x32_bf16 v[88:91], v[68:71], v[40:43], v[88:91]
  v_mfma_f32_16x16x32_bf16 v[92:95], v[68:71], v[44:47], v[92:95]
  v_mfma_f32_16x16x32_bf16 v[96:99], v[68:71], v[48:51], v[96:99]
  v_mfma_f32_16x16x32_bf16 v[100:103], v[68:71], v[52:55], v[100:103]
  s_waitcnt vmcnt(8)
  v_add_u32 v5, s56, v4
  s_add_u32 s56, s56, 4096
  s_cmp_eq_u32 s56, 20480
  s_cselect_b32 s56, 0, s56
  ds_read_b64_tr_b16 v[56:57], v5 offset:0
  ds_read_b64_tr_b16 v[60:61], v5 offset:32
  ds_read_b64_tr_b16 v[58:59], v5 offset:1024
  ds_read_b64_tr_b16 v[62:63], v5 offset:1056
  ds_read_b64_tr_b16 v[64:65], v5 offset:2048
  ds_read_b64_tr_b16 v[68:69], v5 offset:2080
  ds_read_b64_tr_b16 v[66:67], v5 offset:3072
  ds_read_b64_tr_b16 v[70:71], v5 offset:3104
  s_add_u32 m0, s58, s55
  s_add_u32 s52, s54, 1024
  buffer_load_dwordx4 v2, s[16:19], s52 offen lds
  s_add_u32 s52, s52, 12288
  s_add_u32 m0, m0, 1024
  s_nop 0
  buffer_load_dwordx4 v2, s[16:19], s52 offen lds
  s_add_u32 s52, s52, 86016
  s_add_u32 m0, m0, 1024
  s_nop 0
  buffer_load_dwordx4 v2, s[16:19], s52 offen lds
  s_add_u32 s52, s52, 12288
  s_add_u32 m0, m0, 1024
  s_nop 0
  buffer_load_dwordx4 v2, s[16:19], s52 offen lds
  s_add_u32 s55, s55, 4096
  s_cmp_eq_u32 s55, 20480
  s_cselect_b32 s55, 0, s55
  s_waitcnt lgkmcnt(0)
  v_mfma_f32_16x16x32_bf16 v[104:107], v[56:59], v[16:19], v[104:107]
  v_mfma_f32_16x16x32_bf16 v[108:111], v[56:59], v[20:23], v[108:111]
  v_mfma_f32_16x16x32_bf16 v[112:115], v[56:59], v[24:27], v[112:115]
  v_mfma_f32_16x16x32_bf16 v[116:119], v[56:59], v[28:31], v[116:119]
  v_mfma_f32_16x16x32_bf16 v[120:123], v[56:59], v[32:35], v[120:123]
  v_mfma_f32_16x16x32_bf16 v[124:127], v[60:63], v[16:19], v[124:127]
  v_mfma_f32_16x16x32_bf16 v[128:131], v[60:63], v[20:23], v[128:131]
  v_mfma_f32_16x16x32_bf16 v[132:135], v[60:63], v[24:27], v[132:135]
  v_mfma_f32_16x16x32_bf16 v[136:139], v[60:63], v[28:31], v[136:139]
  v_mfma_f32_16x16x32_bf16 v[140:143], v[60:63], v[32:35], v[140:143]
  v_mfma_f32_16x16x32_bf16 v[104:107], v[64:67], v[36:39], v[104:107]
  v_mfma_f32_16x16x32_bf16 v[108:111], v[64:67], v[40:43], v[108:111]
  v_mfma_f32_16x16x32_bf16 v[112:115], v[64:67], v[44:47], v[112:115]
  v_mfma_f32_16x16x32_bf16 v[116:119], v[64:67], v[48:51], v[116:119]
  v_mfma_f32_16x16x32_bf16 v[120:123], v[64:67], v[52:55], v[120:123]
  v_mfma_f32_16x16x32_bf16 v[124:127], v[68:71], v[36:39], v[124:127]
  v_mfma_f32_16x16x32_bf16 v[128:131], v[68:71], v[40:43], v[128:131]
  v_mfma_f32_16x16x32_bf16 v[132:135], v[68:71], v[44:47], v[132:135]
  v_mfma_f32_16x16x32_bf16 v[136:139], v[68:71], v[48:51], v[136:139]
  v_mfma_f32_16x16x32_bf16 v[140:143], v[68:71], v[52:55], v[140:143]
  s_waitcnt vmcnt(8)
  v_add_u32 v5, s56, v4
  s_add_u32 s56, s56, 4096
  s_cmp_eq_u32 s56, 20480
  s_cselect_b32 s56, 0, s56
  ds_read_b64_tr_b16 v[56:57], v5 offset:0
  ds_read_b64_tr_b16 v[60:61], v5 offset:32
  ds_read_b64_tr_b16 v[58:59], v5 offset:1024
  ds_read_b64_tr_b16 v[62:63], v5 offset:1056
  ds_read_b64_tr_b16 v[64:65], v5 offset:2048
  ds_read_b64_tr_b16 v[68:69], v5 offset:2080
  ds_read_b64_tr_b16 v[66:67], v5 offset:3072
  ds_read_b64_tr_b16 v[70:71], v5 offset:3104
  s_add_u32 m0, s58, s55
  s_add_u32 s52, s54, 2048
  buffer_load_dwordx4 v2, s[16:19], s52 offen lds
  s_add_u32 s52, s52, 12288
  s_add_u32 m0, m0, 1024
  s_nop 0
  buffer_load_dwordx4 v2, s[16:19], s52 offen lds
  s_add_u32 s52, s52, 86016
  s_add_u32 m0, m0, 1024
  s_nop 0
  buffer_load_dwordx4 v2, s[16:19], s52 offen lds
  s_add_u32 s52, s52, 12288
  s_add_u32 m0, m0, 1024
  s_nop 0
  buffer_load_dwordx4 v2, s[16:19], s52 offen lds
  s_add_u32 s55, s55, 4096
  s_cmp_eq_u32 s55, 20480
  s_cselect_b32 s55, 0, s55
  s_waitcnt lgkmcnt(0)
  v_mfma_f32_16x16x32_bf16 v[144:147], v[16:19], v[56:59], v[144:147]
  v_mfma_f32_16x16x32_bf16 v[148:151], v[20:23], v[56:59], v[148:151]
  v_mfma_f32_16x16x32_bf16 v[152:155], v[24:27], v[56:59], v[152:155]
  v_mfma_f32_16x16x32_bf16 v[156:159], v[28:31], v[56:59], v[156:159]
  v_mfma_f32_16x16x32_bf16 v[160:163], v[32:35], v[56:59], v[160:163]
  v_mfma_f32_16x16x32_bf16 v[164:167], v[16:19], v[60:63], v[164:167]
  v_mfma_f32_16x16x32_bf16 v[168:171], v[20:23], v[60:63], v[168:171]
  v_mfma_f32_16x16x32_bf16 v[172:175], v[24:27], v[60:63], v[172:175]
  v_mfma_f32_16x16x32_bf16 v[176:179], v[28:31], v[60:63], v[176:179]
  v_mfma_f32_16x16x32_bf16 v[180:183], v[32:35], v[60:63], v[180:183]
  v_mfma_f32_16x16x32_bf16 v[144:147], v[36:39], v[64:67], v[144:147]
  v_mfma_f32_16x16x32_bf16 v[148:151], v[40:43], v[64:67], v[148:151]
  v_mfma_f32_16x16x32_bf16 v[152:155], v[44:47], v[64:67], v[152:155]
  v_mfma_f32_16x16x32_bf16 v[156:159], v[48:51], v[64:67], v[156:159]
  v_mfma_f32_16x16x32_bf16 v[160:163], v[52:55], v[64:67], v[160:163]
  v_mfma_f32_16x16x32_bf16 v[164:167], v[36:39], v[68:71], v[164:167]
  v_mfma_f32_16x16x32_bf16 v[168:171], v[40:43], v[68:71], v[168:171]
  v_mfma_f32_16x16x32_bf16 v[172:175], v[44:47], v[68:71], v[172:175]
  v_mfma_f32_16x16x32_bf16 v[176:179], v[48:51], v[68:71], v[176:179]
  v_mfma_f32_16x16x32_bf16 v[180:183], v[52:55], v[68:71], v[180:183]
  s_add_u32 s54, s54, 196608
  s_lshl_b32 s52, s3, 8
  s_add_u32 s52, s52, 192
  s_cmp_eq_u32 s57, 768
  s_cselect_b32 s54, s52, s54
  v_add_u32 v8, s57, v14
  ds_read_b128 v[16:19], v8 offset:0
  ds_read_b128 v[20:23], v8 offset:16384
  ds_read_b128 v[24:27], v8 offset:32768
  ds_read_b128 v[28:31], v8 offset:49152
  v_add_u32 v8, 0x10000, v8
  ds_read_b128 v[32:35], v8
  v_add_u32 v8, s57, v15
  ds_read_b128 v[36:39], v8 offset:0
  ds_read_b128 v[40:43], v8 offset:16384
  ds_read_b128 v[44:47], v8 offset:32768
  ds_read_b128 v[48:51], v8 offset:49152
  v_add_u32 v8, 0x10000, v8
  ds_read_b128 v[52:55], v8
  s_waitcnt vmcnt(8)
  v_add_u32 v5, s56, v4
  s_add_u32 s56, s56, 4096
  s_cmp_eq_u32 s56, 20480
  s_cselect_b32 s56, 0, s56
  ds_read_b64_tr_b16 v[56:57], v5 offset:0
  ds_read_b64_tr_b16 v[60:61], v5 offset:32
  ds_read_b64_tr_b16 v[58:59], v5 offset:1024
  ds_read_b64_tr_b16 v[62:63], v5 offset:1056
  ds_read_b64_tr_b16 v[64:65], v5 offset:2048
  ds_read_b64_tr_b16 v[68:69], v5 offset:2080
  ds_read_b64_tr_b16 v[66:67], v5 offset:3072
  ds_read_b64_tr_b16 v[70:71], v5 offset:3104
  s_add_u32 m0, s58, s55
  s_add_u32 s52, s54, 0
  buffer_load_dwordx4 v2, s[16:19], s52 offen lds
  s_add_u32 s52, s52, 12288
  s_add_u32 m0, m0, 1024
  s_nop 0
  buffer_load_dwordx4 v2, s[16:19], s52 offen lds
  s_add_u32 s52, s52, 86016
  s_add_u32 m0, m0, 1024
  s_nop 0
  buffer_load_dwordx4 v2, s[16:19], s52 offen lds
  s_add_u32 s52, s52, 12288
  s_add_u32 m0, m0, 1024
  s_nop 0
  buffer_load_dwordx4 v2, s[16:19], s52 offen lds
  s_add_u32 s55, s55, 4096
  s_cmp_eq_u32 s55, 20480
  s_cselect_b32 s55, 0, s55
  s_waitcnt lgkmcnt(0)
  v_mfma_f32_16x16x32_bf16 v[72:75], v[56:59], v[20:23], v[72:75]
  v_mfma_f32_16x16x32_bf16 v[76:79], v[56:59], v[24:27], v[76:79]
  v_mfma_f32_16x16x32_bf16 v[80:83], v[56:59], v[28:31], v[80:83]
  v_mfma_f32_16x16x32_bf16 v[84:87], v[56:59], v[32:35], v[84:87]
  v_mfma_f32_16x16x32_bf16 v[88:91], v[60:63], v[20:23], v[88:91]
  v_mfma_f32_16x16x32_bf16 v[92:95], v[60:63], v[24:27], v[92:95]
  v_mfma_f32_16x16x32_bf16 v[96:99], v[60:63], v[28:31], v[96:99]
  v_mfma_f32_16x16x32_bf16 v[100:103], v[60:63], v[32:35], v[100:103]
  v_mfma_f32_16x16x32_bf16 v[72:75], v[64:67], v[40:43], v[72:75]
  v_mfma_f32_16x16x32_bf16 v[76:79], v[64:67], v[44:47], v[76:79]
  v_mfma_f32_16x16x32_bf16 v[80:83], v[64:67], v[48:51], v[80:83]
  v_mfma_f32_16x16x32_bf16 v[84:87], v[64:67], v[52:55], v[84:87]
  v_mfma_f32_16x16x32_bf16 v[88:91], v[68:71], v[40:43], v[88:91]
  v_mfma_f32_16x16x32_bf16 v[92:95], v[68:71], v[44:47], v[92:95]
  v_mfma_f32_16x16x32_bf16 v[96:99], v[68:71], v[48:51], v[96:99]
  v_mfma_f32_16x16x32_bf16 v[100:103], v[68:71], v[52:55], v[100:103]
  s_waitcnt vmcnt(8)
  v_add_u32 v5, s56, v4
  s_add_u32 s56, s56, 4096
  s_cmp_eq_u32 s56, 20480
  s_cselect_b32 s56, 0, s56
  ds_read_b64_tr_b16 v[56:57], v5 offset:0
  ds_read_b64_tr_b16 v[60:61], v5 offset:32
  ds_read_b64_tr_b16 v[58:59], v5 offset:1024
  ds_read_b64_tr_b16 v[62:63], v5 offset:1056
  ds_read_b64_tr_b16 v[64:65], v5 offset:2048
  ds_read_b64_tr_b16 v[68:69], v5 offset:2080
  ds_read_b64_tr_b16 v[66:67], v5 offset:3072
  ds_read_b64_tr_b16 v[70:71], v5 offset:3104
  s_add_u32 m0, s58, s55
  s_add_u32 s52, s54, 1024
  buffer_load_dwordx4 v2, s[16:19], s52 offen lds
  s_add_u32 s52, s52, 12288
  s_add_u32 m0, m0, 1024
  s_nop 0
  buffer_load_dwordx4 v2, s[16:19], s52 offen lds
  s_add_u32 s52, s52, 86016
  s_add_u32 m0, m0, 1024
  s_nop 0
  buffer_load_dwordx4 v2, s[16:19], s52 offen lds
  s_add_u32 s52, s52, 12288
  s_add_u32 m0, m0, 1024
  s_nop 0
  buffer_load_dwordx4 v2, s[16:19], s52 offen lds
  s_add_u32 s55, s55, 4096
  s_cmp_eq_u32 s55, 20480
  s_cselect_b32 s55, 0, s55
  s_waitcnt lgkmcnt(0)
  v_mfma_f32_16x16x32_bf16 v[104:107], v[56:59], v[16:19], v[104:107]
  v_mfma_f32_16x16x32_bf16 v[108:111], v[56:59], v[20:23], v[108:111]
  v_mfma_f32_16x16x32_bf16 v[112:115], v[56:59], v[24:27], v[112:115]
  v_mfma_f32_16x16x32_bf16 v[116:119], v[56:59], v[28:31], v[116:119]
  v_mfma_f32_16x16x32_bf16 v[120:123], v[56:59], v[32:35], v[120:123]
  v_mfma_f32_16x16x32_bf16 v[124:127], v[60:63], v[16:19], v[124:127]
  v_mfma_f32_16x16x32_bf16 v[128:131], v[60:63], v[20:23], v[128:131]
  v_mfma_f32_16x16x32_bf16 v[132:135], v[60:63], v[24:27], v[132:135]
  v_mfma_f32_16x16x32_bf16 v[136:139], v[60:63], v[28:31], v[136:139]
  v_mfma_f32_16x16x32_bf16 v[140:143], v[60:63], v[32:35], v[140:143]
  v_mfma_f32_16x16x32_bf16 v[104:107], v[64:67], v[36:39], v[104:107]
  v_mfma_f32_16x16x32_bf16 v[108:111], v[64:67], v[40:43], v[108:111]
  v_mfma_f32_16x16x32_bf16 v[112:115], v[64:67], v[44:47], v[112:115]
  v_mfma_f32_16x16x32_bf16 v[116:119], v[64:67], v[48:51], v[116:119]
  v_mfma_f32_16x16x32_bf16 v[120:123], v[64:67], v[52:55], v[120:123]
  v_mfma_f32_16x16x32_bf16 v[124:127], v[68:71], v[36:39], v[124:127]
  v_mfma_f32_16x16x32_bf16 v[128:131], v[68:71], v[40:43], v[128:131]
  v_mfma_f32_16x16x32_bf16 v[132:135], v[68:71], v[44:47], v[132:135]
  v_mfma_f32_16x16x32_bf16 v[136:139], v[68:71], v[48:51], v[136:139]
  v_mfma_f32_16x16x32_bf16 v[140:143], v[68:71], v[52:55], v[140:143]
  s_waitcnt vmcnt(8)
  v_add_u32 v5, s56, v4
  s_add_u32 s56, s56, 4096
  s_cmp_eq_u32 s56, 20480
  s_cselect_b32 s56, 0, s56
  ds_read_b64_tr_b16 v[56:57], v5 offset:0
  ds_read_b64_tr_b16 v[60:61], v5 offset:32
  ds_read_b64_tr_b16 v[58:59], v5 offset:1024
  ds_read_b64_tr_b16 v[62:63], v5 offset:1056
  ds_read_b64_tr_b16 v[64:65], v5 offset:2048
  ds_read_b64_tr_b16 v[68:69], v5 offset:2080
  ds_read_b64_tr_b16 v[66:67], v5 offset:3072
  ds_read_b64_tr_b16 v[70:71], v5 offset:3104
  s_add_u32 m0, s58, s55
  s_add_u32 s52, s54, 2048
  buffer_load_dwordx4 v2, s[16:19], s52 offen lds
  s_add_u32 s52, s52, 12288
  s_add_u32 m0, m0, 1024
  s_nop 0
  buffer_load_dwordx4 v2, s[16:19], s52 offen lds
  s_add_u32 s52, s52, 86016
  s_add_u32 m0, m0, 1024
  s_nop 0
  buffer_load_dwordx4 v2, s[16:19], s52 offen lds
  s_add_u32 s52, s52, 12288
  s_add_u32 m0, m0, 1024
  s_nop 0
  buffer_load_dwordx4 v2, s[16:19], s52 offen lds
  s_add_u32 s55, s55, 4096
  s_cmp_eq_u32 s55, 20480
  s_cselect_b32 s55, 0, s55
  s_waitcnt lgkmcnt(0)
  v_mfma_f32_16x16x32_bf16 v[144:147], v[16:19], v[56:59], v[144:147]
  v_mfma_f32_16x16x32_bf16 v[148:151], v[20:23], v[56:59], v[148:151]
  v_mfma_f32_16x16x32_bf16 v[152:155], v[24:27], v[56:59], v[152:155]
  v_mfma_f32_16x16x32_bf16 v[156:159], v[28:31], v[56:59], v[156:159]
  v_mfma_f32_16x16x32_bf16 v[160:163], v[32:35], v[56:59], v[160:163]
  v_mfma_f32_16x16x32_bf16 v[164:167], v[16:19], v[60:63], v[164:167]
  v_mfma_f32_16x16x32_bf16 v[168:171], v[20:23], v[60:63], v[168:171]
  v_mfma_f32_16x16x32_bf16 v[172:175], v[24:27], v[60:63], v[172:175]
  v_mfma_f32_16x16x32_bf16 v[176:179], v[28:31], v[60:63], v[176:179]
  v_mfma_f32_16x16x32_bf16 v[180:183], v[32:35], v[60:63], v[180:183]
  v_mfma_f32_16x16x32_bf16 v[144:147], v[36:39], v[64:67], v[144:147]
  v_mfma_f32_16x16x32_bf16 v[148:151], v[40:43], v[64:67], v[148:151]
  v_mfma_f32_16x16x32_bf16 v[152:155], v[44:47], v[64:67], v[152:155]
  v_mfma_f32_16x16x32_bf16 v[156:159], v[48:51], v[64:67], v[156:159]
  v_mfma_f32_16x16x32_bf16 v[160:163], v[52:55], v[64:67], v[160:163]
  v_mfma_f32_16x16x32_bf16 v[164:167], v[36:39], v[68:71], v[164:167]
  v_mfma_f32_16x16x32_bf16 v[168:171], v[40:43], v[68:71], v[168:171]
  v_mfma_f32_16x16x32_bf16 v[172:175], v[44:47], v[68:71], v[172:175]
  v_mfma_f32_16x16x32_bf16 v[176:179], v[48:51], v[68:71], v[176:179]
  v_mfma_f32_16x16x32_bf16 v[180:183], v[52:55], v[68:71], v[180:183]
  s_add_u32 s57, s57, 256
  s_cmp_lt_u32 s57, 1024
  s_cbranch_scc1 L_x_kb2
  s_nop 4
  s_nop 7
  v_cvt_pk_bf16_f32 v72, v72, v73
  v_cvt_pk_bf16_f32 v73, v74, v75
  v_cvt_pk_bf16_f32 v74, v76, v77
  v_cvt_pk_bf16_f32 v75, v78, v79
  v_cvt_pk_bf16_f32 v76, v80, v81
  v_cvt_pk_bf16_f32 v77, v82, v83
  v_cvt_pk_bf16_f32 v78, v84, v85
  v_cvt_pk_bf16_f32 v79, v86, v87
  v_cvt_pk_bf16_f32 v80, v88, v89
  v_cvt_pk_bf16_f32 v81, v90, v91
  v_cvt_pk_bf16_f32 v82, v92, v93
  v_cvt_pk_bf16_f32 v83, v94, v95
  v_cvt_pk_bf16_f32 v84, v96, v97
  v_cvt_pk_bf16_f32 v85, v98, v99
  v_cvt_pk_bf16_f32 v86, v100, v101
  v_cvt_pk_bf16_f32 v87, v102, v103
  v_cvt_pk_bf16_f32 v104, v104, v105
  v_cvt_pk_bf16_f32 v105, v106, v107
  v_cvt_pk_bf16_f32 v106, v108, v109
  v_cvt_pk_bf16_f32 v107, v110, v111
  v_cvt_pk_bf16_f32 v108, v112, v113
  v_cvt_pk_bf16_f32 v109, v114, v115
  v_cvt_pk_bf16_f32 v110, v116, v117
  v_cvt_pk_bf16_f32 v111, v118, v119
  v_cvt_pk_bf16_f32 v112, v120, v121
  v_cvt_pk_bf16_f32 v113, v122, v123
  v_cvt_pk_bf16_f32 v114, v124, v125
  v_cvt_pk_bf16_f32 v115, v126, v127
  v_cvt_pk_bf16_f32 v116, v128, v129
  v_cvt_pk_bf16_f32 v117, v130, v131
  v_cvt_pk_bf16_f32 v118, v132, v133
  v_cvt_pk_bf16_f32 v119, v134, v135
  v_cvt_pk_bf16_f32 v120, v136, v137
  v_cvt_pk_bf16_f32 v121, v138, v139
  v_cvt_pk_bf16_f32 v122, v140, v141
  v_cvt_pk_bf16_f32 v123, v142, v143
  v_cvt_pk_bf16_f32 v144, v144, v145
  v_cvt_pk_bf16_f32 v145, v146, v147
  v_cvt_pk_bf16_f32 v146, v148, v149
  v_cvt_pk_bf16_f32 v147, v150, v151
  v_cvt_pk_bf16_f32 v148, v152, v153
  v_cvt_pk_bf16_f32 v149, v154, v155
  v_cvt_pk_bf16_f32 v150, v156, v157
  v_cvt_pk_bf16_f32 v151, v158, v159
  v_cvt_pk_bf16_f32 v152, v160, v161
  v_cvt_pk_bf16_f32 v153, v162, v163
  v_cvt_pk_bf16_f32 v154, v164, v165
  v_cvt_pk_bf16_f32 v155, v166, v167
  v_cvt_pk_bf16_f32 v156, v168, v169
  v_cvt_pk_bf16_f32 v157, v170, v171
  v_cvt_pk_bf16_f32 v158, v172, v173
  v_cvt_pk_bf16_f32 v159, v174, v175
  v_cvt_pk_bf16_f32 v160, v176, v177
  v_cvt_pk_bf16_f32 v161, v178, v179
  v_cvt_pk_bf16_f32 v162, v180, v181
  v_cvt_pk_bf16_f32 v163, v182, v183
  v_mfma_f32_16x16x16_bf16 v[16:19], v[104:105], v[72:73], 0
  v_mfma_f32_16x16x16_bf16 v[20:23], v[106:107], v[72:73], 0
  s_nop 6
  v_cndmask_b32 v16, v6, v16, s[44:45]
  v_cndmask_b32 v17, v6, v17, s[46:47]
  v_cndmask_b32 v18, v6, v18, s[48:49]
  v_cndmask_b32 v19, v6, v19, s[50:51]
  v_cndmask_b32 v20, v6, v20, s[70:71]
  v_cndmask_b32 v21, v6, v21, s[72:73]
  v_cndmask_b32 v22, v6, v22, s[74:75]
  v_cndmask_b32 v23, v6, v23, s[76:77]
  v_max3_f32 v32, v16, v17, v18
  v_max3_f32 v32, v32, v19, v20
  v_max3_f32 v32, v32, v21, v22
  v_max_f32 v32, v32, v23
  v_mov_b32 v34, v32
  v_mov_b32 v35, v32
  s_nop 1
  v_permlane32_swap_b32 v34, v35
  v_max_f32 v36, v34, v35
  v_max_f32 v37, v34, v35
  s_nop 1
  v_permlane16_swap_b32 v36, v37
  v_max_f32 v34, v36, v37
  v_mul_f32 v32, s60, v34
  v_fma_f32 v16, v16, s59, v32
  v_fma_f32 v17, v17, s59, v32
  v_fma_f32 v18, v18, s59, v32
  v_fma_f32 v19, v19, s59, v32
  v_fma_f32 v20, v20, s59, v32
  v_fma_f32 v21, v21, s59, v32
  v_fma_f32 v22, v22, s59, v32
  v_fma_f32 v23, v23, s59, v32
  v_exp_f32 v16, v16
  v_exp_f32 v17, v17
  v_exp_f32 v18, v18
  v_exp_f32 v19, v19
  v_exp_f32 v20, v20
  v_exp_f32 v21, v21
  v_exp_f32 v22, v22
  v_exp_f32 v23, v23
  v_cvt_pk_bf16_f32 v24, v16, v17
  v_cvt_pk_bf16_f32 v25, v18, v19
  v_cvt_pk_bf16_f32 v26, v20, v21
  v_cvt_pk_bf16_f32 v27, v22, v23
  v_add_f32 v32, v16, v17
  v_add_f32 v32, v32, v18
  v_mfma_f32_16x16x32_bf16 v[28:31], v[144:147], v[24:27], 0
  v_add_f32 v32, v32, v19
  v_add_f32 v32, v32, v20
  v_add_f32 v32, v32, v21
  v_add_f32 v32, v32, v22
  v_add_f32 v32, v32, v23
  v_mov_b32 v34, v32
  v_mov_b32 v35, v32
  s_nop 1
  v_permlane32_swap_b32 v34, v35
  v_add_f32 v36, v34, v35
  v_add_f32 v37, v34, v35
  s_nop 1
  v_permlane16_swap_b32 v36, v37
  v_add_f32 v34, v36, v37
  v_rcp_f32 v34, v34
  s_nop 0
  v_mul_f32 v28, v28, v34
  v_mul_f32 v29, v29, v34
  v_mul_f32 v30, v30, v34
  v_mul_f32 v31, v31, v34
  v_cvt_pk_bf16_f32 v216, v28, v29
  v_cvt_pk_bf16_f32 v217, v30, v31
  v_mfma_f32_16x16x16_bf16 v[16:19], v[106:107], v[74:75], 0
  v_mfma_f32_16x16x16_bf16 v[20:23], v[108:109], v[74:75], 0
  s_nop 6
  v_cndmask_b32 v16, v6, v16, s[62:63]
  v_cndmask_b32 v17, v6, v17, s[64:65]
  v_cndmask_b32 v18, v6, v18, s[66:67]
  v_cndmask_b32 v19, v6, v19, s[68:69]
  v_cndmask_b32 v20, v6, v20, s[70:71]
  v_cndmask_b32 v21, v6, v21, s[72:73]
  v_cndmask_b32 v22, v6, v22, s[74:75]
  v_cndmask_b32 v23, v6, v23, s[76:77]
  v_max3_f32 v32, v16, v17, v18
  v_max3_f32 v32, v32, v19, v20
  v_max3_f32 v32, v32, v21, v22
  v_max_f32 v32, v32, v23
  v_mov_b32 v34, v32
  v_mov_b32 v35, v32
  s_nop 1
  v_permlane32_swap_b32 v34, v35
  v_max_f32 v36, v34, v35
  v_max_f32 v37, v34, v35
  s_nop 1
  v_permlane16_swap_b32 v36, v37
  v_max_f32 v34, v36, v37
  v_mul_f32 v32, s60, v34
  v_fma_f32 v16, v16, s59, v32
  v_fma_f32 v17, v17, s59, v32
  v_fma_f32 v18, v18, s59, v32
  v_fma_f32 v19, v19, s59, v32
  v_fma_f32 v20, v20, s59, v32
  v_fma_f32 v21, v21, s59, v32
  v_fma_f32 v22, v22, s59, v32
  v_fma_f32 v23, v23, s59, v32
  v_exp_f32 v16, v16
  v_exp_f32 v17, v17
  v_exp_f32 v18, v18
  v_exp_f32 v19, v19
  v_exp_f32 v20, v20
  v_exp_f32 v21, v21
  v_exp_f32 v22, v22
  v_exp_f32 v23, v23
  v_cvt_pk_bf16_f32 v24, v16, v17
  v_cvt_pk_bf16_f32 v25, v18, v19
  v_cvt_pk_bf16_f32 v26, v20, v21
  v_cvt_pk_bf16_f32 v27, v22, v23
  v_add_f32 v32, v16, v17
  v_add_f32 v32, v32, v18
  v_mfma_f32_16x16x32_bf16 v[28:31], v[146:149], v[24:27], 0
  v_add_f32 v32, v32, v19
  v_add_f32 v32, v32, v20
  v_add_f32 v32, v32, v21
  v_add_f32 v32, v32, v22
  v_add_f32 v32, v32, v23
  v_mov_b32 v34, v32
  v_mov_b32 v35, v32
  s_nop 1
  v_permlane32_swap_b32 v34, v35
  v_add_f32 v36, v34, v35
  v_add_f32 v37, v34, v35
  s_nop 1
  v_permlane16_swap_b32 v36, v37
  v_add_f32 v34, v36, v37
  v_rcp_f32 v34, v34
  s_nop 0
  v_mul_f32 v28, v28, v34
  v_mul_f32 v29, v29, v34
  v_mul_f32 v30, v30, v34
  v_mul_f32 v31, v31, v34
  v_cvt_pk_bf16_f32 v220, v28, v29
  v_cvt_pk_bf16_f32 v221, v30, v31
  v_mfma_f32_16x16x16_bf16 v[16:19], v[108:109], v[76:77], 0
  v_mfma_f32_16x16x16_bf16 v[20:23], v[110:111], v[76:77], 0
  s_nop 6
  v_cndmask_b32 v16, v6, v16, s[62:63]
  v_cndmask_b32 v17, v6, v17, s[64:65]
  v_cndmask_b32 v18, v6, v18, s[66:67]
  v_cndmask_b32 v19, v6, v19, s[68:69]
  v_cndmask_b32 v20, v6, v20, s[70:71]
  v_cndmask_b32 v21, v6, v21, s[72:73]
  v_cndmask_b32 v22, v6, v22, s[74:75]
  v_cndmask_b32 v23, v6, v23, s[76:77]
  v_max3_f32 v32, v16, v17, v18
  v_max3_f32 v32, v32, v19, v20
  v_max3_f32 v32, v32, v21, v22
  v_max_f32 v32, v32, v23
  v_mov_b32 v34, v32
  v_mov_b32 v35, v32
  s_nop 1
  v_permlane32_swap_b32 v34, v35
  v_max_f32 v36, v34, v35
  v_max_f32 v37, v34, v35
  s_nop 1
  v_permlane16_swap_b32 v36, v37
  v_max_f32 v34, v36, v37
  v_mul_f32 v32, s60, v34
  v_fma_f32 v16, v16, s59, v32
  v_fma_f32 v17, v17, s59, v32
  v_fma_f32 v18, v18, s59, v32
  v_fma_f32 v19, v19, s59, v32
  v_fma_f32 v20, v20, s59, v32
  v_fma_f32 v21, v21, s59, v32
  v_fma_f32 v22, v22, s59, v32
  v_fma_f32 v23, v23, s59, v32
  v_exp_f32 v16, v16
  v_exp_f32 v17, v17
  v_exp_f32 v18, v18
  v_exp_f32 v19, v19
  v_exp_f32 v20, v20
  v_exp_f32 v21, v21
  v_exp_f32 v22, v22
  v_exp_f32 v23, v23
  v_cvt_pk_bf16_f32 v24, v16, v17
  v_cvt_pk_bf16_f32 v25, v18, v19
  v_cvt_pk_bf16_f32 v26, v20, v21
  v_cvt_pk_bf16_f32 v27, v22, v23
  v_add_f32 v32, v16, v17
  v_add_f32 v32, v32, v18
  v_mfma_f32_16x16x32_bf16 v[28:31], v[148:151], v[24:27], 0
  v_add_f32 v32, v32, v19
  v_add_f32 v32, v32, v20
  v_add_f32 v32, v32, v21
  v_add_f32 v32, v32, v22
  v_add_f32 v32, v32, v23
  v_mov_b32 v34, v32
  v_mov_b32 v35, v32
  s_nop 1
  v_permlane32_swap_b32 v34, v35
  v_add_f32 v36, v34, v35
  v_add_f32 v37, v34, v35
  s_nop 1
  v_permlane16_swap_b32 v36, v37
  v_add_f32 v34, v36, v37
  v_rcp_f32 v34, v34
  s_nop 0
  v_mul_f32 v28, v28, v34
  v_mul_f32 v29, v29, v34
  v_mul_f32 v30, v30, v34
  v_mul_f32 v31, v31, v34
  v_cvt_pk_bf16_f32 v224, v28, v29
  v_cvt_pk_bf16_f32 v225, v30, v31
  v_mfma_f32_16x16x16_bf16 v[16:19], v[110:111], v[78:79], 0
  v_mfma_f32_16x16x16_bf16 v[20:23], v[112:113], v[78:79], 0
  s_nop 6
  v_cndmask_b32 v16, v6, v16, s[62:63]
  v_cndmask_b32 v17, v6, v17, s[64:65]
  v_cndmask_b32 v18, v6, v18, s[66:67]
  v_cndmask_b32 v19, v6, v19, s[68:69]
  v_cndmask_b32 v20, v6, v20, s[70:71]
  v_cndmask_b32 v21, v6, v21, s[72:73]
  v_cndmask_b32 v22, v6, v22, s[74:75]
  v_cndmask_b32 v23, v6, v23, s[76:77]
  v_max3_f32 v32, v16, v17, v18
  v_max3_f32 v32, v32, v19, v20
  v_max3_f32 v32, v32, v21, v22
  v_max_f32 v32, v32, v23
  v_mov_b32 v34, v32
  v_mov_b32 v35, v32
  s_nop 1
  v_permlane32_swap_b32 v34, v35
  v_max_f32 v36, v34, v35
  v_max_f32 v37, v34, v35
  s_nop 1
  v_permlane16_swap_b32 v36, v37
  v_max_f32 v34, v36, v37
  v_mul_f32 v32, s60, v34
  v_fma_f32 v16, v16, s59, v32
  v_fma_f32 v17, v17, s59, v32
  v_fma_f32 v18, v18, s59, v32
  v_fma_f32 v19, v19, s59, v32
  v_fma_f32 v20, v20, s59, v32
  v_fma_f32 v21, v21, s59, v32
  v_fma_f32 v22, v22, s59, v32
  v_fma_f32 v23, v23, s59, v32
  v_exp_f32 v16, v16
  v_exp_f32 v17, v17
  v_exp_f32 v18, v18
  v_exp_f32 v19, v19
  v_exp_f32 v20, v20
  v_exp_f32 v21, v21
  v_exp_f32 v22, v22
  v_exp_f32 v23, v23
  v_cvt_pk_bf16_f32 v24, v16, v17
  v_cvt_pk_bf16_f32 v25, v18, v19
  v_cvt_pk_bf16_f32 v26, v20, v21
  v_cvt_pk_bf16_f32 v27, v22, v23
  v_add_f32 v32, v16, v17
  v_add_f32 v32, v32, v18
  v_mfma_f32_16x16x32_bf16 v[28:31], v[150:153], v[24:27], 0
  v_add_f32 v32, v32, v19
  v_add_f32 v32, v32, v20
  v_add_f32 v32, v32, v21
  v_add_f32 v32, v32, v22
  v_add_f32 v32, v32, v23
  v_mov_b32 v34, v32
  v_mov_b32 v35, v32
  s_nop 1
  v_permlane32_swap_b32 v34, v35
  v_add_f32 v36, v34, v35
  v_add_f32 v37, v34, v35
  s_nop 1
  v_permlane16_swap_b32 v36, v37
  v_add_f32 v34, v36, v37
  v_rcp_f32 v34, v34
  s_nop 0
  v_mul_f32 v28, v28, v34
  v_mul_f32 v29, v29, v34
  v_mul_f32 v30, v30, v34
  v_mul_f32 v31, v31, v34
  v_cvt_pk_bf16_f32 v228, v28, v29
  v_cvt_pk_bf16_f32 v229, v30, v31
  v_mfma_f32_16x16x16_bf16 v[16:19], v[114:115], v[80:81], 0
  v_mfma_f32_16x16x16_bf16 v[20:23], v[116:117], v[80:81], 0
  s_nop 6
  v_cndmask_b32 v16, v6, v16, s[44:45]
  v_cndmask_b32 v17, v6, v17, s[46:47]
  v_cndmask_b32 v18, v6, v18, s[48:49]
  v_cndmask_b32 v19, v6, v19, s[50:51]
  v_cndmask_b32 v20, v6, v20, s[70:71]
  v_cndmask_b32 v21, v6, v21, s[72:73]
  v_cndmask_b32 v22, v6, v22, s[74:75]
  v_cndmask_b32 v23, v6, v23, s[76:77]
  v_max3_f32 v32, v16, v17, v18
  v_max3_f32 v32, v32, v19, v20
  v_max3_f32 v32, v32, v21, v22
  v_max_f32 v32, v32, v23
  v_mov_b32 v34, v32
  v_mov_b32 v35, v32
  s_nop 1
  v_permlane32_swap_b32 v34, v35
  v_max_f32 v36, v34, v35
  v_max_f32 v37, v34, v35
  s_nop 1
  v_permlane16_swap_b32 v36, v37
  v_max_f32 v34, v36, v37
  v_mul_f32 v32, s60, v34
  v_fma_f32 v16, v16, s59, v32
  v_fma_f32 v17, v17, s59, v32
  v_fma_f32 v18, v18, s59, v32
  v_fma_f32 v19, v19, s59, v32
  v_fma_f32 v20, v20, s59, v32
  v_fma_f32 v21, v21, s59, v32
  v_fma_f32 v22, v22, s59, v32
  v_fma_f32 v23, v23, s59, v32
  v_exp_f32 v16, v16
  v_exp_f32 v17, v17
  v_exp_f32 v18, v18
  v_exp_f32 v19, v19
  v_exp_f32 v20, v20
  v_exp_f32 v21, v21
  v_exp_f32 v22, v22
  v_exp_f32 v23, v23
  v_cvt_pk_bf16_f32 v24, v16, v17
  v_cvt_pk_bf16_f32 v25, v18, v19
  v_cvt_pk_bf16_f32 v26, v20, v21
  v_cvt_pk_bf16_f32 v27, v22, v23
  v_add_f32 v32, v16, v17
  v_add_f32 v32, v32, v18
  v_mfma_f32_16x16x32_bf16 v[28:31], v[154:157], v[24:27], 0
  v_add_f32 v32, v32, v19
  v_add_f32 v32, v32, v20
  v_add_f32 v32, v32, v21
  v_add_f32 v32, v32, v22
  v_add_f32 v32, v32, v23
  v_mov_b32 v34, v32
  v_mov_b32 v35, v32
  s_nop 1
  v_permlane32_swap_b32 v34, v35
  v_add_f32 v36, v34, v35
  v_add_f32 v37, v34, v35
  s_nop 1
  v_permlane16_swap_b32 v36, v37
  v_add_f32 v34, v36, v37
  v_rcp_f32 v34, v34
  s_nop 0
  v_mul_f32 v28, v28, v34
  v_mul_f32 v29, v29, v34
  v_mul_f32 v30, v30, v34
  v_mul_f32 v31, v31, v34
  v_cvt_pk_bf16_f32 v218, v28, v29
  v_cvt_pk_bf16_f32 v219, v30, v31
  v_mfma_f32_16x16x16_bf16 v[16:19], v[116:117], v[82:83], 0
  v_mfma_f32_16x16x16_bf16 v[20:23], v[118:119], v[82:83], 0
  s_nop 6
  v_cndmask_b32 v16, v6, v16, s[62:63]
  v_cndmask_b32 v17, v6, v17, s[64:65]
  v_cndmask_b32 v18, v6, v18, s[66:67]
  v_cndmask_b32 v19, v6, v19, s[68:69]
  v_cndmask_b32 v20, v6, v20, s[70:71]
  v_cndmask_b32 v21, v6, v21, s[72:73]
  v_cndmask_b32 v22, v6, v22, s[74:75]
  v_cndmask_b32 v23, v6, v23, s[76:77]
  v_max3_f32 v32, v16, v17, v18
  v_max3_f32 v32, v32, v19, v20
  v_max3_f32 v32, v32, v21, v22
  v_max_f32 v32, v32, v23
  v_mov_b32 v34, v32
  v_mov_b32 v35, v32
  s_nop 1
  v_permlane32_swap_b32 v34, v35
  v_max_f32 v36, v34, v35
  v_max_f32 v37, v34, v35
  s_nop 1
  v_permlane16_swap_b32 v36, v37
  v_max_f32 v34, v36, v37
  v_mul_f32 v32, s60, v34
  v_fma_f32 v16, v16, s59, v32
  v_fma_f32 v17, v17, s59, v32
  v_fma_f32 v18, v18, s59, v32
  v_fma_f32 v19, v19, s59, v32
  v_fma_f32 v20, v20, s59, v32
  v_fma_f32 v21, v21, s59, v32
  v_fma_f32 v22, v22, s59, v32
  v_fma_f32 v23, v23, s59, v32
  v_exp_f32 v16, v16
  v_exp_f32 v17, v17
  v_exp_f32 v18, v18
  v_exp_f32 v19, v19
  v_exp_f32 v20, v20
  v_exp_f32 v21, v21
  v_exp_f32 v22, v22
  v_exp_f32 v23, v23
  v_cvt_pk_bf16_f32 v24, v16, v17
  v_cvt_pk_bf16_f32 v25, v18, v19
  v_cvt_pk_bf16_f32 v26, v20, v21
  v_cvt_pk_bf16_f32 v27, v22, v23
  v_add_f32 v32, v16, v17
  v_add_f32 v32, v32, v18
  v_mfma_f32_16x16x32_bf16 v[28:31], v[156:159], v[24:27], 0
  v_add_f32 v32, v32, v19
  v_add_f32 v32, v32, v20
  v_add_f32 v32, v32, v21
  v_add_f32 v32, v32, v22
  v_add_f32 v32, v32, v23
  v_mov_b32 v34, v32
  v_mov_b32 v35, v32
  s_nop 1
  v_permlane32_swap_b32 v34, v35
  v_add_f32 v36, v34, v35
  v_add_f32 v37, v34, v35
  s_nop 1
  v_permlane16_swap_b32 v36, v37
  v_add_f32 v34, v36, v37
  v_rcp_f32 v34, v34
  s_nop 0
  v_mul_f32 v28, v28, v34
  v_mul_f32 v29, v29, v34
  v_mul_f32 v30, v30, v34
  v_mul_f32 v31, v31, v34
  v_cvt_pk_bf16_f32 v222, v28, v29
  v_cvt_pk_bf16_f32 v223, v30, v31
  v_mfma_f32_16x16x16_bf16 v[16:19], v[118:119], v[84:85], 0
  v_mfma_f32_16x16x16_bf16 v[20:23], v[120:121], v[84:85], 0
  s_nop 6
  v_cndmask_b32 v16, v6, v16, s[62:63]
  v_cndmask_b32 v17, v6, v17, s[64:65]
  v_cndmask_b32 v18, v6, v18, s[66:67]
  v_cndmask_b32 v19, v6, v19, s[68:69]
  v_cndmask_b32 v20, v6, v20, s[70:71]
  v_cndmask_b32 v21, v6, v21, s[72:73]
  v_cndmask_b32 v22, v6, v22, s[74:75]
  v_cndmask_b32 v23, v6, v23, s[76:77]
  v_max3_f32 v32, v16, v17, v18
  v_max3_f32 v32, v32, v19, v20
  v_max3_f32 v32, v32, v21, v22
  v_max_f32 v32, v32, v23
  v_mov_b32 v34, v32
  v_mov_b32 v35, v32
  s_nop 1
  v_permlane32_swap_b32 v34, v35
  v_max_f32 v36, v34, v35
  v_max_f32 v37, v34, v35
  s_nop 1
  v_permlane16_swap_b32 v36, v37
  v_max_f32 v34, v36, v37
  v_mul_f32 v32, s60, v34
  v_fma_f32 v16, v16, s59, v32
  v_fma_f32 v17, v17, s59, v32
  v_fma_f32 v18, v18, s59, v32
  v_fma_f32 v19, v19, s59, v32
  v_fma_f32 v20, v20, s59, v32
  v_fma_f32 v21, v21, s59, v32
  v_fma_f32 v22, v22, s59, v32
  v_fma_f32 v23, v23, s59, v32
  v_exp_f32 v16, v16
  v_exp_f32 v17, v17
  v_exp_f32 v18, v18
  v_exp_f32 v19, v19
  v_exp_f32 v20, v20
  v_exp_f32 v21, v21
  v_exp_f32 v22, v22
  v_exp_f32 v23, v23
  v_cvt_pk_bf16_f32 v24, v16, v17
  v_cvt_pk_bf16_f32 v25, v18, v19
  v_cvt_pk_bf16_f32 v26, v20, v21
  v_cvt_pk_bf16_f32 v27, v22, v23
  v_add_f32 v32, v16, v17
  v_add_f32 v32, v32, v18
  v_mfma_f32_16x16x32_bf16 v[28:31], v[158:161], v[24:27], 0
  v_add_f32 v32, v32, v19
  v_add_f32 v32, v32, v20
  v_add_f32 v32, v32, v21
  v_add_f32 v32, v32, v22
  v_add_f32 v32, v32, v23
  v_mov_b32 v34, v32
  v_mov_b32 v35, v32
  s_nop 1
  v_permlane32_swap_b32 v34, v35
  v_add_f32 v36, v34, v35
  v_add_f32 v37, v34, v35
  s_nop 1
  v_permlane16_swap_b32 v36, v37
  v_add_f32 v34, v36, v37
  v_rcp_f32 v34, v34
  s_nop 0
  v_mul_f32 v28, v28, v34
  v_mul_f32 v29, v29, v34
  v_mul_f32 v30, v30, v34
  v_mul_f32 v31, v31, v34
  v_cvt_pk_bf16_f32 v226, v28, v29
  v_cvt_pk_bf16_f32 v227, v30, v31
  v_mfma_f32_16x16x16_bf16 v[16:19], v[120:121], v[86:87], 0
  v_mfma_f32_16x16x16_bf16 v[20:23], v[122:123], v[86:87], 0
  s_nop 6
  v_cndmask_b32 v16, v6, v16, s[62:63]
  v_cndmask_b32 v17, v6, v17, s[64:65]
  v_cndmask_b32 v18, v6, v18, s[66:67]
  v_cndmask_b32 v19, v6, v19, s[68:69]
  v_cndmask_b32 v20, v6, v20, s[70:71]
  v_cndmask_b32 v21, v6, v21, s[72:73]
  v_cndmask_b32 v22, v6, v22, s[74:75]
  v_cndmask_b32 v23, v6, v23, s[76:77]
  v_max3_f32 v32, v16, v17, v18
  v_max3_f32 v32, v32, v19, v20
  v_max3_f32 v32, v32, v21, v22
  v_max_f32 v32, v32, v23
  v_mov_b32 v34, v32
  v_mov_b32 v35, v32
  s_nop 1
  v_permlane32_swap_b32 v34, v35
  v_max_f32 v36, v34, v35
  v_max_f32 v37, v34, v35
  s_nop 1
  v_permlane16_swap_b32 v36, v37
  v_max_f32 v34, v36, v37
  v_mul_f32 v32, s60, v34
  v_fma_f32 v16, v16, s59, v32
  v_fma_f32 v17, v17, s59, v32
  v_fma_f32 v18, v18, s59, v32
  v_fma_f32 v19, v19, s59, v32
  v_fma_f32 v20, v20, s59, v32
  v_fma_f32 v21, v21, s59, v32
  v_fma_f32 v22, v22, s59, v32
  v_fma_f32 v23, v23, s59, v32
  v_exp_f32 v16, v16
  v_exp_f32 v17, v17
  v_exp_f32 v18, v18
  v_exp_f32 v19, v19
  v_exp_f32 v20, v20
  v_exp_f32 v21, v21
  v_exp_f32 v22, v22
  v_exp_f32 v23, v23
  v_cvt_pk_bf16_f32 v24, v16, v17
  v_cvt_pk_bf16_f32 v25, v18, v19
  v_cvt_pk_bf16_f32 v26, v20, v21
  v_cvt_pk_bf16_f32 v27, v22, v23
  v_add_f32 v32, v16, v17
  v_add_f32 v32, v32, v18
  v_mfma_f32_16x16x32_bf16 v[28:31], v[160:163], v[24:27], 0
  v_add_f32 v32, v32, v19
  v_add_f32 v32, v32, v20
  v_add_f32 v32, v32, v21
  v_add_f32 v32, v32, v22
  v_add_f32 v32, v32, v23
  v_mov_b32 v34, v32
  v_mov_b32 v35, v32
  s_nop 1
  v_permlane32_swap_b32 v34, v35
  v_add_f32 v36, v34, v35
  v_add_f32 v37, v34, v35
  s_nop 1
  v_permlane16_swap_b32 v36, v37
  v_add_f32 v34, v36, v37
  v_rcp_f32 v34, v34
  s_nop 0
  v_mul_f32 v28, v28, v34
  v_mul_f32 v29, v29, v34
  v_mul_f32 v30, v30, v34
  v_mul_f32 v31, v31, v34
  v_cvt_pk_bf16_f32 v230, v28, v29
  v_cvt_pk_bf16_f32 v231, v30, v31
  v_mov_b64 v[72:73], 0
  v_mov_b64 v[74:75], 0
  v_mov_b64 v[76:77], 0
  v_mov_b64 v[78:79], 0
  v_mov_b64 v[80:81], 0
  v_mov_b64 v[82:83], 0
  v_mov_b64 v[84:85], 0
  v_mov_b64 v[86:87], 0
  v_mov_b64 v[88:89], 0
  v_mov_b64 v[90:91], 0
  v_mov_b64 v[92:93], 0
  v_mov_b64 v[94:95], 0
  v_mov_b64 v[96:97], 0
  v_mov_b64 v[98:99], 0
  v_mov_b64 v[100:101], 0
  v_mov_b64 v[102:103], 0
  v_mov_b64 v[104:105], 0
  v_mov_b64 v[106:107], 0
  v_mov_b64 v[108:109], 0
  v_mov_b64 v[110:111], 0
  v_mov_b64 v[112:113], 0
  v_mov_b64 v[114:115], 0
  v_mov_b64 v[116:117], 0
  v_mov_b64 v[118:119], 0
  v_mov_b64 v[120:121], 0
  v_mov_b64 v[122:123], 0
  v_mov_b64 v[124:125], 0
  v_mov_b64 v[126:127], 0
  v_mov_b64 v[128:129], 0
  v_mov_b64 v[130:131], 0
  v_mov_b64 v[132:133], 0
  v_mov_b64 v[134:135], 0
  v_mov_b64 v[136:137], 0
  v_mov_b64 v[138:139], 0
  v_mov_b64 v[140:141], 0
  v_mov_b64 v[142:143], 0
  v_mov_b64 v[144:145], 0
  v_mov_b64 v[146:147], 0
  v_mov_b64 v[148:149], 0
  v_mov_b64 v[150:151], 0
  v_mov_b64 v[152:153], 0
  v_mov_b64 v[154:155], 0
  v_mov_b64 v[156:157], 0
  v_mov_b64 v[158:159], 0
  v_mov_b64 v[160:161], 0
  v_mov_b64 v[162:163], 0
  v_mov_b64 v[164:165], 0
  v_mov_b64 v[166:167], 0
  v_mov_b64 v[168:169], 0
  v_mov_b64 v[170:171], 0
  v_mov_b64 v[172:173], 0
  v_mov_b64 v[174:175], 0
  v_mov_b64 v[176:177], 0
  v_mov_b64 v[178:179], 0
  v_mov_b64 v[180:181], 0
  v_mov_b64 v[182:183], 0
  s_mov_b32 s57, 0
L_x_kb3:
  s_add_u32 s54, s54, 196608
  v_add_u32 v8, s57, v12
  ds_read_b128 v[16:19], v8 offset:0
  ds_read_b128 v[20:23], v8 offset:16384
  ds_read_b128 v[24:27], v8 offset:32768
  ds_read_b128 v[28:31], v8 offset:49152
  v_add_u32 v8, 0x10000, v8
  ds_read_b128 v[32:35], v8
  v_add_u32 v8, s57, v13
  ds_read_b128 v[36:39], v8 offset:0
  ds_read_b128 v[40:43], v8 offset:16384
  ds_read_b128 v[44:47], v8 offset:32768
  ds_read_b128 v[48:51], v8 offset:49152
  v_add_u32 v8, 0x10000, v8
  ds_read_b128 v[52:55], v8
  s_waitcnt vmcnt(8)
  v_add_u32 v5, s56, v4
  s_add_u32 s56, s56, 4096
  s_cmp_eq_u32 s56, 20480
  s_cselect_b32 s56, 0, s56
  ds_read_b64_tr_b16 v[56:57], v5 offset:0
  ds_read_b64_tr_b16 v[60:61], v5 offset:32
  ds_read_b64_tr_b16 v[58:59], v5 offset:1024
  ds_read_b64_tr_b16 v[62:63], v5 offset:1056
  ds_read_b64_tr_b16 v[64:65], v5 offset:2048
  ds_read_b64_tr_b16 v[68:69], v5 offset:2080
  ds_read_b64_tr_b16 v[66:67], v5 offset:3072
  ds_read_b64_tr_b16 v[70:71], v5 offset:3104
  s_add_u32 m0, s58, s55
  s_add_u32 s52, s54, 0
  buffer_load_dwordx4 v2, s[16:19], s52 offen lds
  s_add_u32 s52, s52, 12288
  s_add_u32 m0, m0, 1024
  s_nop 0
  buffer_load_dwordx4 v2, s[16:19], s52 offen lds
  s_add_u32 s52, s52, 86016
  s_add_u32 m0, m0, 1024
  s_nop 0
  buffer_load_dwordx4 v2, s[16:19], s52 offen lds
  s_add_u32 s52, s52, 12288
  s_add_u32 m0, m0, 1024
  s_nop 0
  buffer_load_dwordx4 v2, s[16:19], s52 offen lds
  s_add_u32 s55, s55, 4096
  s_cmp_eq_u32 s55, 20480
  s_cselect_b32 s55, 0, s55
  s_waitcnt lgkmcnt(0)
  v_mfma_f32_16x16x32_bf16 v[72:75], v[56:59], v[20:23], v[72:75]
  v_mfma_f32_16x16x32_bf16 v[76:79], v[56:59], v[24:27], v[76:79]
  v_mfma_f32_16x16x32_bf16 v[80:83], v[56:59], v[28:31], v[80:83]
  v_mfma_f32_16x16x32_bf16 v[84:87], v[56:59], v[32:35], v[84:87]
  v_mfma_f32_16x16x32_bf16 v[88:91], v[60:63], v[20:23], v[88:91]
  v_mfma_f32_16x16x32_bf16 v[92:95], v[60:63], v[24:27], v[92:95]
  v_mfma_f32_16x16x32_bf16 v[96:99], v[60:63], v[28:31], v[96:99]
  v_mfma_f32_16x16x32_bf16 v[100:103], v[60:63], v[32:35], v[100:103]
  v_mfma_f32_16x16x32_bf16 v[72:75], v[64:67], v[40:43], v[72:75]
  v_mfma_f32_16x16x32_bf16 v[76:79], v[64:67], v[44:47], v[76:79]
  v_mfma_f32_16x16x32_bf16 v[80:83], v[64:67], v[48:51], v[80:83]
  v_mfma_f32_16x16x32_bf16 v[84:87], v[64:67], v[52:55], v[84:87]
  v_mfma_f32_16x16x32_bf16 v[88:91], v[68:71], v[40:43], v[88:91]
  v_mfma_f32_16x16x32_bf16 v[92:95], v[68:71], v[44:47], v[92:95]
  v_mfma_f32_16x16x32_bf16 v[96:99], v[68:71], v[48:51], v[96:99]
  v_mfma_f32_16x16x32_bf16 v[100:103], v[68:71], v[52:55], v[100:103]
  s_waitcnt vmcnt(8)
  v_add_u32 v5, s56, v4
  s_add_u32 s56, s56, 4096
  s_cmp_eq_u32 s56, 20480
  s_cselect_b32 s56, 0, s56
  ds_read_b64_tr_b16 v[56:57], v5 offset:0
  ds_read_b64_tr_b16 v[60:61], v5 offset:32
  ds_read_b64_tr_b16 v[58:59], v5 offset:1024
  ds_read_b64_tr_b16 v[62:63], v5 offset:1056
  ds_read_b64_tr_b16 v[64:65], v5 offset:2048
  ds_read_b64_tr_b16 v[68:69], v5 offset:2080
  ds_read_b64_tr_b16 v[66:67], v5 offset:3072
  ds_read_b64_tr_b16 v[70:71], v5 offset:3104
  s_add_u32 m0, s58, s55
  s_add_u32 s52, s54, 1024
  buffer_load_dwordx4 v2, s[16:19], s52 offen lds
  s_add_u32 s52, s52, 12288
  s_add_u32 m0, m0, 1024
  s_nop 0
  buffer_load_dwordx4 v2, s[16:19], s52 offen lds
  s_add_u32 s52, s52, 86016
  s_add_u32 m0, m0, 1024
  s_nop 0
  buffer_load_dwordx4 v2, s[16:19], s52 offen lds
  s_add_u32 s52, s52, 12288
  s_add_u32 m0, m0, 1024
  s_nop 0
  buffer_load_dwordx4 v2, s[16:19], s52 offen lds
  s_add_u32 s55, s55, 4096
  s_cmp_eq_u32 s55, 20480
  s_cselect_b32 s55, 0, s55
  s_waitcnt lgkmcnt(0)
  v_mfma_f32_16x16x32_bf16 v[104:107], v[56:59], v[16:19], v[104:107]
  v_mfma_f32_16x16x32_bf16 v[108:111], v[56:59], v[20:23], v[108:111]
  v_mfma_f32_16x16x32_bf16 v[112:115], v[56:59], v[24:27], v[112:115]
  v_mfma_f32_16x16x32_bf16 v[116:119], v[56:59], v[28:31], v[116:119]
  v_mfma_f32_16x16x32_bf16 v[120:123], v[56:59], v[32:35], v[120:123]
  v_mfma_f32_16x16x32_bf16 v[124:127], v[60:63], v[16:19], v[124:127]
  v_mfma_f32_16x16x32_bf16 v[128:131], v[60:63], v[20:23], v[128:131]
  v_mfma_f32_16x16x32_bf16 v[132:135], v[60:63], v[24:27], v[132:135]
  v_mfma_f32_16x16x32_bf16 v[136:139], v[60:63], v[28:31], v[136:139]
  v_mfma_f32_16x16x32_bf16 v[140:143], v[60:63], v[32:35], v[140:143]
  v_mfma_f32_16x16x32_bf16 v[104:107], v[64:67], v[36:39], v[104:107]
  v_mfma_f32_16x16x32_bf16 v[108:111], v[64:67], v[40:43], v[108:111]
  v_mfma_f32_16x16x32_bf16 v[112:115], v[64:67], v[44:47], v[112:115]
  v_mfma_f32_16x16x32_bf16 v[116:119], v[64:67], v[48:51], v[116:119]
  v_mfma_f32_16x16x32_bf16 v[120:123], v[64:67], v[52:55], v[120:123]
  v_mfma_f32_16x16x32_bf16 v[124:127], v[68:71], v[36:39], v[124:127]
  v_mfma_f32_16x16x32_bf16 v[128:131], v[68:71], v[40:43], v[128:131]
  v_mfma_f32_16x16x32_bf16 v[132:135], v[68:71], v[44:47], v[132:135]
  v_mfma_f32_16x16x32_bf16 v[136:139], v[68:71], v[48:51], v[136:139]
  v_mfma_f32_16x16x32_bf16 v[140:143], v[68:71], v[52:55], v[140:143]
  s_waitcnt vmcnt(8)
  v_add_u32 v5, s56, v4
  s_add_u32 s56, s56, 4096
  s_cmp_eq_u32 s56, 20480
  s_cselect_b32 s56, 0, s56
  ds_read_b64_tr_b16 v[56:57], v5 offset:0
  ds_read_b64_tr_b16 v[60:61], v5 offset:32
  ds_read_b64_tr_b16 v[58:59], v5 offset:1024
  ds_read_b64_tr_b16 v[62:63], v5 offset:1056
  ds_read_b64_tr_b16 v[64:65], v5 offset:2048
  ds_read_b64_tr_b16 v[68:69], v5 offset:2080
  ds_read_b64_tr_b16 v[66:67], v5 offset:3072
  ds_read_b64_tr_b16 v[70:71], v5 offset:3104
  s_add_u32 m0, s58, s55
  s_add_u32 s52, s54, 2048
  buffer_load_dwordx4 v2, s[16:19], s52 offen lds
  s_add_u32 s52, s52, 12288
  s_add_u32 m0, m0, 1024
  s_nop 0
  buffer_load_dwordx4 v2, s[16:19], s52 offen lds
  s_add_u32 s52, s52, 86016
  s_add_u32 m0, m0, 1024
  s_nop 0
  buffer_load_dwordx4 v2, s[16:19], s52 offen lds
  s_add_u32 s52, s52, 12288
  s_add_u32 m0, m0, 1024
  s_nop 0
  buffer_load_dwordx4 v2, s[16:19], s52 offen lds
  s_add_u32 s55, s55, 4096
  s_cmp_eq_u32 s55, 20480
  s_cselect_b32 s55, 0, s55
  s_waitcnt lgkmcnt(0)
  v_mfma_f32_16x16x32_bf16 v[144:147], v[16:19], v[56:59], v[144:147]
  v_mfma_f32_16x16x32_bf16 v[148:151], v[20:23], v[56:59], v[148:151]
  v_mfma_f32_16x16x32_bf16 v[152:155], v[24:27], v[56:59], v[152:155]
  v_mfma_f32_16x16x32_bf16 v[156:159], v[28:31], v[56:59], v[156:159]
  v_mfma_f32_16x16x32_bf16 v[160:163], v[32:35], v[56:59], v[160:163]
  v_mfma_f32_16x16x32_bf16 v[164:167], v[16:19], v[60:63], v[164:167]
  v_mfma_f32_16x16x32_bf16 v[168:171], v[20:23], v[60:63], v[168:171]
  v_mfma_f32_16x16x32_bf16 v[172:175], v[24:27], v[60:63], v[172:175]
  v_mfma_f32_16x16x32_bf16 v[176:179], v[28:31], v[60:63], v[176:179]
  v_mfma_f32_16x16x32_bf16 v[180:183], v[32:35], v[60:63], v[180:183]
  v_mfma_f32_16x16x32_bf16 v[144:147], v[36:39], v[64:67], v[144:147]
  v_mfma_f32_16x16x32_bf16 v[148:151], v[40:43], v[64:67], v[148:151]
  v_mfma_f32_16x16x32_bf16 v[152:155], v[44:47], v[64:67], v[152:155]
  v_mfma_f32_16x16x32_bf16 v[156:159], v[48:51], v[64:67], v[156:159]
  v_mfma_f32_16x16x32_bf16 v[160:163], v[52:55], v[64:67], v[160:163]
  v_mfma_f32_16x16x32_bf16 v[164:167], v[36:39], v[68:71], v[164:167]
  v_mfma_f32_16x16x32_bf16 v[168:171], v[40:43], v[68:71], v[168:171]
  v_mfma_f32_16x16x32_bf16 v[172:175], v[44:47], v[68:71], v[172:175]
  v_mfma_f32_16x16x32_bf16 v[176:179], v[48:51], v[68:71], v[176:179]
  v_mfma_f32_16x16x32_bf16 v[180:183], v[52:55], v[68:71], v[180:183]
  s_add_u32 s54, s54, 196608
  s_lshl_b32 s52, s3, 8
  s_add_u32 s52, s52, 192
  s_cmp_eq_u32 s57, 768
  s_cselect_b32 s54, s52, s54
  v_add_u32 v8, s57, v14
  ds_read_b128 v[16:19], v8 offset:0
  ds_read_b128 v[20:23], v8 offset:16384
  ds_read_b128 v[24:27], v8 offset:32768
  ds_read_b128 v[28:31], v8 offset:49152
  v_add_u32 v8, 0x10000, v8
  ds_read_b128 v[32:35], v8
  v_add_u32 v8, s57, v15
  ds_read_b128 v[36:39], v8 offset:0
  ds_read_b128 v[40:43], v8 offset:16384
  ds_read_b128 v[44:47], v8 offset:32768
  ds_read_b128 v[48:51], v8 offset:49152
  v_add_u32 v8, 0x10000, v8
  ds_read_b128 v[52:55], v8
  s_waitcnt vmcnt(8)
  v_add_u32 v5, s56, v4
  s_add_u32 s56, s56, 4096
  s_cmp_eq_u32 s56, 20480
  s_cselect_b32 s56, 0, s56
  ds_read_b64_tr_b16 v[56:57], v5 offset:0
  ds_read_b64_tr_b16 v[60:61], v5 offset:32
  ds_read_b64_tr_b16 v[58:59], v5 offset:1024
  ds_read_b64_tr_b16 v[62:63], v5 offset:1056
  ds_read_b64_tr_b16 v[64:65], v5 offset:2048
  ds_read_b64_tr_b16 v[68:69], v5 offset:2080
  ds_read_b64_tr_b16 v[66:67], v5 offset:3072
  ds_read_b64_tr_b16 v[70:71], v5 offset:3104
  s_add_u32 m0, s58, s55
  s_add_u32 s52, s54, 0
  buffer_load_dwordx4 v2, s[16:19], s52 offen lds
  s_add_u32 s52, s52, 12288
  s_add_u32 m0, m0, 1024
  s_nop 0
  buffer_load_dwordx4 v2, s[16:19], s52 offen lds
  s_add_u32 s52, s52, 86016
  s_add_u32 m0, m0, 1024
  s_nop 0
  buffer_load_dwordx4 v2, s[16:19], s52 offen lds
  s_add_u32 s52, s52, 12288
  s_add_u32 m0, m0, 1024
  s_nop 0
  buffer_load_dwordx4 v2, s[16:19], s52 offen lds
  s_add_u32 s55, s55, 4096
  s_cmp_eq_u32 s55, 20480
  s_cselect_b32 s55, 0, s55
  s_waitcnt lgkmcnt(0)
  v_mfma_f32_16x16x32_bf16 v[72:75], v[56:59], v[20:23], v[72:75]
  v_mfma_f32_16x16x32_bf16 v[76:79], v[56:59], v[24:27], v[76:79]
  v_mfma_f32_16x16x32_bf16 v[80:83], v[56:59], v[28:31], v[80:83]
  v_mfma_f32_16x16x32_bf16 v[84:87], v[56:59], v[32:35], v[84:87]
  v_mfma_f32_16x16x32_bf16 v[88:91], v[60:63], v[20:23], v[88:91]
  v_mfma_f32_16x16x32_bf16 v[92:95], v[60:63], v[24:27], v[92:95]
  v_mfma_f32_16x16x32_bf16 v[96:99], v[60:63], v[28:31], v[96:99]
  v_mfma_f32_16x16x32_bf16 v[100:103], v[60:63], v[32:35], v[100:103]
  v_mfma_f32_16x16x32_bf16 v[72:75], v[64:67], v[40:43], v[72:75]
  v_mfma_f32_16x16x32_bf16 v[76:79], v[64:67], v[44:47], v[76:79]
  v_mfma_f32_16x16x32_bf16 v[80:83], v[64:67], v[48:51], v[80:83]
  v_mfma_f32_16x16x32_bf16 v[84:87], v[64:67], v[52:55], v[84:87]
  v_mfma_f32_16x16x32_bf16 v[88:91], v[68:71], v[40:43], v[88:91]
  v_mfma_f32_16x16x32_bf16 v[92:95], v[68:71], v[44:47], v[92:95]
  v_mfma_f32_16x16x32_bf16 v[96:99], v[68:71], v[48:51], v[96:99]
  v_mfma_f32_16x16x32_bf16 v[100:103], v[68:71], v[52:55], v[100:103]
  s_waitcnt vmcnt(8)
  v_add_u32 v5, s56, v4
  s_add_u32 s56, s56, 4096
  s_cmp_eq_u32 s56, 20480
  s_cselect_b32 s56, 0, s56
  ds_read_b64_tr_b16 v[56:57], v5 offset:0
  ds_read_b64_tr_b16 v[60:61], v5 offset:32
  ds_read_b64_tr_b16 v[58:59], v5 offset:1024
  ds_read_b64_tr_b16 v[62:63], v5 offset:1056
  ds_read_b64_tr_b16 v[64:65], v5 offset:2048
  ds_read_b64_tr_b16 v[68:69], v5 offset:2080
  ds_read_b64_tr_b16 v[66:67], v5 offset:3072
  ds_read_b64_tr_b16 v[70:71], v5 offset:3104
  s_add_u32 m0, s58, s55
  s_add_u32 s52, s54, 1024
  buffer_load_dwordx4 v2, s[16:19], s52 offen lds
  s_add_u32 s52, s52, 12288
  s_add_u32 m0, m0, 1024
  s_nop 0
  buffer_load_dwordx4 v2, s[16:19], s52 offen lds
  s_add_u32 s52, s52, 86016
  s_add_u32 m0, m0, 1024
  s_nop 0
  buffer_load_dwordx4 v2, s[16:19], s52 offen lds
  s_add_u32 s52, s52, 12288
  s_add_u32 m0, m0, 1024
  s_nop 0
  buffer_load_dwordx4 v2, s[16:19], s52 offen lds
  s_add_u32 s55, s55, 4096
  s_cmp_eq_u32 s55, 20480
  s_cselect_b32 s55, 0, s55
  s_waitcnt lgkmcnt(0)
  v_mfma_f32_16x16x32_bf16 v[104:107], v[56:59], v[16:19], v[104:107]
  v_mfma_f32_16x16x32_bf16 v[108:111], v[56:59], v[20:23], v[108:111]
  v_mfma_f32_16x16x32_bf16 v[112:115], v[56:59], v[24:27], v[112:115]
  v_mfma_f32_16x16x32_bf16 v[116:119], v[56:59], v[28:31], v[116:119]
  v_mfma_f32_16x16x32_bf16 v[120:123], v[56:59], v[32:35], v[120:123]
  v_mfma_f32_16x16x32_bf16 v[124:127], v[60:63], v[16:19], v[124:127]
  v_mfma_f32_16x16x32_bf16 v[128:131], v[60:63], v[20:23], v[128:131]
  v_mfma_f32_16x16x32_bf16 v[132:135], v[60:63], v[24:27], v[132:135]
  v_mfma_f32_16x16x32_bf16 v[136:139], v[60:63], v[28:31], v[136:139]
  v_mfma_f32_16x16x32_bf16 v[140:143], v[60:63], v[32:35], v[140:143]
  v_mfma_f32_16x16x32_bf16 v[104:107], v[64:67], v[36:39], v[104:107]
  v_mfma_f32_16x16x32_bf16 v[108:111], v[64:67], v[40:43], v[108:111]
  v_mfma_f32_16x16x32_bf16 v[112:115], v[64:67], v[44:47], v[112:115]
  v_mfma_f32_16x16x32_bf16 v[116:119], v[64:67], v[48:51], v[116:119]
  v_mfma_f32_16x16x32_bf16 v[120:123], v[64:67], v[52:55], v[120:123]
  v_mfma_f32_16x16x32_bf16 v[124:127], v[68:71], v[36:39], v[124:127]
  v_mfma_f32_16x16x32_bf16 v[128:131], v[68:71], v[40:43], v[128:131]
  v_mfma_f32_16x16x32_bf16 v[132:135], v[68:71], v[44:47], v[132:135]
  v_mfma_f32_16x16x32_bf16 v[136:139], v[68:71], v[48:51], v[136:139]
  v_mfma_f32_16x16x32_bf16 v[140:143], v[68:71], v[52:55], v[140:143]
  s_waitcnt vmcnt(8)
  v_add_u32 v5, s56, v4
  s_add_u32 s56, s56, 4096
  s_cmp_eq_u32 s56, 20480
  s_cselect_b32 s56, 0, s56
  ds_read_b64_tr_b16 v[56:57], v5 offset:0
  ds_read_b64_tr_b16 v[60:61], v5 offset:32
  ds_read_b64_tr_b16 v[58:59], v5 offset:1024
  ds_read_b64_tr_b16 v[62:63], v5 offset:1056
  ds_read_b64_tr_b16 v[64:65], v5 offset:2048
  ds_read_b64_tr_b16 v[68:69], v5 offset:2080
  ds_read_b64_tr_b16 v[66:67], v5 offset:3072
  ds_read_b64_tr_b16 v[70:71], v5 offset:3104
  s_add_u32 m0, s58, s55
  s_add_u32 s52, s54, 2048
  buffer_load_dwordx4 v2, s[16:19], s52 offen lds
  s_add_u32 s52, s52, 12288
  s_add_u32 m0, m0, 1024
  s_nop 0
  buffer_load_dwordx4 v2, s[16:19], s52 offen lds
  s_add_u32 s52, s52, 86016
  s_add_u32 m0, m0, 1024
  s_nop 0
  buffer_load_dwordx4 v2, s[16:19], s52 offen lds
  s_add_u32 s52, s52, 12288
  s_add_u32 m0, m0, 1024
  s_nop 0
  buffer_load_dwordx4 v2, s[16:19], s52 offen lds
  s_add_u32 s55, s55, 4096
  s_cmp_eq_u32 s55, 20480
  s_cselect_b32 s55, 0, s55
  s_waitcnt lgkmcnt(0)
  v_mfma_f32_16x16x32_bf16 v[144:147], v[16:19], v[56:59], v[144:147]
  v_mfma_f32_16x16x32_bf16 v[148:151], v[20:23], v[56:59], v[148:151]
  v_mfma_f32_16x16x32_bf16 v[152:155], v[24:27], v[56:59], v[152:155]
  v_mfma_f32_16x16x32_bf16 v[156:159], v[28:31], v[56:59], v[156:159]
  v_mfma_f32_16x16x32_bf16 v[160:163], v[32:35], v[56:59], v[160:163]
  v_mfma_f32_16x16x32_bf16 v[164:167], v[16:19], v[60:63], v[164:167]
  v_mfma_f32_16x16x32_bf16 v[168:171], v[20:23], v[60:63], v[168:171]
  v_mfma_f32_16x16x32_bf16 v[172:175], v[24:27], v[60:63], v[172:175]
  v_mfma_f32_16x16x32_bf16 v[176:179], v[28:31], v[60:63], v[176:179]
  v_mfma_f32_16x16x32_bf16 v[180:183], v[32:35], v[60:63], v[180:183]
  v_mfma_f32_16x16x32_bf16 v[144:147], v[36:39], v[64:67], v[144:147]
  v_mfma_f32_16x16x32_bf16 v[148:151], v[40:43], v[64:67], v[148:151]
  v_mfma_f32_16x16x32_bf16 v[152:155], v[44:47], v[64:67], v[152:155]
  v_mfma_f32_16x16x32_bf16 v[156:159], v[48:51], v[64:67], v[156:159]
  v_mfma_f32_16x16x32_bf16 v[160:163], v[52:55], v[64:67], v[160:163]
  v_mfma_f32_16x16x32_bf16 v[164:167], v[36:39], v[68:71], v[164:167]
  v_mfma_f32_16x16x32_bf16 v[168:171], v[40:43], v[68:71], v[168:171]
  v_mfma_f32_16x16x32_bf16 v[172:175], v[44:47], v[68:71], v[172:175]
  v_mfma_f32_16x16x32_bf16 v[176:179], v[48:51], v[68:71], v[176:179]
  v_mfma_f32_16x16x32_bf16 v[180:183], v[52:55], v[68:71], v[180:183]
  s_add_u32 s57, s57, 256
  s_cmp_lt_u32 s57, 1024
  s_cbranch_scc1 L_x_kb3
  s_nop 4
  s_nop 7
  v_cvt_pk_bf16_f32 v72, v72, v73
  v_cvt_pk_bf16_f32 v73, v74, v75
  v_cvt_pk_bf16_f32 v74, v76, v77
  v_cvt_pk_bf16_f32 v75, v78, v79
  v_cvt_pk_bf16_f32 v76, v80, v81
  v_cvt_pk_bf16_f32 v77, v82, v83
  v_cvt_pk_bf16_f32 v78, v84, v85
  v_cvt_pk_bf16_f32 v79, v86, v87
  v_cvt_pk_bf16_f32 v80, v88, v89
  v_cvt_pk_bf16_f32 v81, v90, v91
  v_cvt_pk_bf16_f32 v82, v92, v93
  v_cvt_pk_bf16_f32 v83, v94, v95
  v_cvt_pk_bf16_f32 v84, v96, v97
  v_cvt_pk_bf16_f32 v85, v98, v99
  v_cvt_pk_bf16_f32 v86, v100, v101
  v_cvt_pk_bf16_f32 v87, v102, v103
  v_cvt_pk_bf16_f32 v104, v104, v105
  v_cvt_pk_bf16_f32 v105, v106, v107
  v_cvt_pk_bf16_f32 v106, v108, v109
  v_cvt_pk_bf16_f32 v107, v110, v111
  v_cvt_pk_bf16_f32 v108, v112, v113
  v_cvt_pk_bf16_f32 v109, v114, v115
  v_cvt_pk_bf16_f32 v110, v116, v117
  v_cvt_pk_bf16_f32 v111, v118, v119
  v_cvt_pk_bf16_f32 v112, v120, v121
  v_cvt_pk_bf16_f32 v113, v122, v123
  v_cvt_pk_bf16_f32 v114, v124, v125
  v_cvt_pk_bf16_f32 v115, v126, v127
  v_cvt_pk_bf16_f32 v116, v128, v129
  v_cvt_pk_bf16_f32 v117, v130, v131
  v_cvt_pk_bf16_f32 v118, v132, v133
  v_cvt_pk_bf16_f32 v119, v134, v135
  v_cvt_pk_bf16_f32 v120, v136, v137
  v_cvt_pk_bf16_f32 v121, v138, v139
  v_cvt_pk_bf16_f32 v122, v140, v141
  v_cvt_pk_bf16_f32 v123, v142, v143
  v_cvt_pk_bf16_f32 v144, v144, v145
  v_cvt_pk_bf16_f32 v145, v146, v147
  v_cvt_pk_bf16_f32 v146, v148, v149
  v_cvt_pk_bf16_f32 v147, v150, v151
  v_cvt_pk_bf16_f32 v148, v152, v153
  v_cvt_pk_bf16_f32 v149, v154, v155
  v_cvt_pk_bf16_f32 v150, v156, v157
  v_cvt_pk_bf16_f32 v151, v158, v159
  v_cvt_pk_bf16_f32 v152, v160, v161
  v_cvt_pk_bf16_f32 v153, v162, v163
  v_cvt_pk_bf16_f32 v154, v164, v165
  v_cvt_pk_bf16_f32 v155, v166, v167
  v_cvt_pk_bf16_f32 v156, v168, v169
  v_cvt_pk_bf16_f32 v157, v170, v171
  v_cvt_pk_bf16_f32 v158, v172, v173
  v_cvt_pk_bf16_f32 v159, v174, v175
  v_cvt_pk_bf16_f32 v160, v176, v177
  v_cvt_pk_bf16_f32 v161, v178, v179
  v_cvt_pk_bf16_f32 v162, v180, v181
  v_cvt_pk_bf16_f32 v163, v182, v183
  v_mfma_f32_16x16x16_bf16 v[16:19], v[104:105], v[72:73], 0
  v_mfma_f32_16x16x16_bf16 v[20:23], v[106:107], v[72:73], 0
  s_nop 6
  v_cndmask_b32 v16, v6, v16, s[44:45]
  v_cndmask_b32 v17, v6, v17, s[46:47]
  v_cndmask_b32 v18, v6, v18, s[48:49]
  v_cndmask_b32 v19, v6, v19, s[50:51]
  v_cndmask_b32 v20, v6, v20, s[70:71]
  v_cndmask_b32 v21, v6, v21, s[72:73]
  v_cndmask_b32 v22, v6, v22, s[74:75]
  v_cndmask_b32 v23, v6, v23, s[76:77]
  v_max3_f32 v32, v16, v17, v18
  v_max3_f32 v32, v32, v19, v20
  v_max3_f32 v32, v32, v21, v22
  v_max_f32 v32, v32, v23
  v_mov_b32 v34, v32
  v_mov_b32 v35, v32
  s_nop 1
  v_permlane32_swap_b32 v34, v35
  v_max_f32 v36, v34, v35
  v_max_f32 v37, v34, v35
  s_nop 1
  v_permlane16_swap_b32 v36, v37
  v_max_f32 v34, v36, v37
  v_mul_f32 v32, s60, v34
  v_fma_f32 v16, v16, s59, v32
  v_fma_f32 v17, v17, s59, v32
  v_fma_f32 v18, v18, s59, v32
  v_fma_f32 v19, v19, s59, v32
  v_fma_f32 v20, v20, s59, v32
  v_fma_f32 v21, v21, s59, v32
  v_fma_f32 v22, v22, s59, v32
  v_fma_f32 v23, v23, s59, v32
  v_exp_f32 v16, v16
  v_exp_f32 v17, v17
  v_exp_f32 v18, v18
  v_exp_f32 v19, v19
  v_exp_f32 v20, v20
  v_exp_f32 v21, v21
  v_exp_f32 v22, v22
  v_exp_f32 v23, v23
  v_cvt_pk_bf16_f32 v24, v16, v17
  v_cvt_pk_bf16_f32 v25, v18, v19
  v_cvt_pk_bf16_f32 v26, v20, v21
  v_cvt_pk_bf16_f32 v27, v22, v23
  v_add_f32 v32, v16, v17
  v_add_f32 v32, v32, v18
  v_mfma_f32_16x16x32_bf16 v[28:31], v[144:147], v[24:27], 0
  v_add_f32 v32, v32, v19
  v_add_f32 v32, v32, v20
  v_add_f32 v32, v32, v21
  v_add_f32 v32, v32, v22
  v_add_f32 v32, v32, v23
  v_mov_b32 v34, v32
  v_mov_b32 v35, v32
  s_nop 1
  v_permlane32_swap_b32 v34, v35
  v_add_f32 v36, v34, v35
  v_add_f32 v37, v34, v35
  s_nop 1
  v_permlane16_swap_b32 v36, v37
  v_add_f32 v34, v36, v37
  v_rcp_f32 v34, v34
  s_nop 0
  v_mul_f32 v28, v28, v34
  v_mul_f32 v29, v29, v34
  v_mul_f32 v30, v30, v34
  v_mul_f32 v31, v31, v34
  v_cvt_pk_bf16_f32 v232, v28, v29
  v_cvt_pk_bf16_f32 v233, v30, v31
  v_mfma_f32_16x16x16_bf16 v[16:19], v[106:107], v[74:75], 0
  v_mfma_f32_16x16x16_bf16 v[20:23], v[108:109], v[74:75], 0
  s_nop 6
  v_cndmask_b32 v16, v6, v16, s[62:63]
  v_cndmask_b32 v17, v6, v17, s[64:65]
  v_cndmask_b32 v18, v6, v18, s[66:67]
  v_cndmask_b32 v19, v6, v19, s[68:69]
  v_cndmask_b32 v20, v6, v20, s[70:71]
  v_cndmask_b32 v21, v6, v21, s[72:73]
  v_cndmask_b32 v22, v6, v22, s[74:75]
  v_cndmask_b32 v23, v6, v23, s[76:77]
  v_max3_f32 v32, v16, v17, v18
  v_max3_f32 v32, v32, v19, v20
  v_max3_f32 v32, v32, v21, v22
  v_max_f32 v32, v32, v23
  v_mov_b32 v34, v32
  v_mov_b32 v35, v32
  s_nop 1
  v_permlane32_swap_b32 v34, v35
  v_max_f32 v36, v34, v35
  v_max_f32 v37, v34, v35
  s_nop 1
  v_permlane16_swap_b32 v36, v37
  v_max_f32 v34, v36, v37
  v_mul_f32 v32, s60, v34
  v_fma_f32 v16, v16, s59, v32
  v_fma_f32 v17, v17, s59, v32
  v_fma_f32 v18, v18, s59, v32
  v_fma_f32 v19, v19, s59, v32
  v_fma_f32 v20, v20, s59, v32
  v_fma_f32 v21, v21, s59, v32
  v_fma_f32 v22, v22, s59, v32
  v_fma_f32 v23, v23, s59, v32
  v_exp_f32 v16, v16
  v_exp_f32 v17, v17
  v_exp_f32 v18, v18
  v_exp_f32 v19, v19
  v_exp_f32 v20, v20
  v_exp_f32 v21, v21
  v_exp_f32 v22, v22
  v_exp_f32 v23, v23
  v_cvt_pk_bf16_f32 v24, v16, v17
  v_cvt_pk_bf16_f32 v25, v18, v19
  v_cvt_pk_bf16_f32 v26, v20, v21
  v_cvt_pk_bf16_f32 v27, v22, v23
  v_add_f32 v32, v16, v17
  v_add_f32 v32, v32, v18
  v_mfma_f32_16x16x32_bf16 v[28:31], v[146:149], v[24:27], 0
  v_add_f32 v32, v32, v19
  v_add_f32 v32, v32, v20
  v_add_f32 v32, v32, v21
  v_add_f32 v32, v32, v22
  v_add_f32 v32, v32, v23
  v_mov_b32 v34, v32
  v_mov_b32 v35, v32
  s_nop 1
  v_permlane32_swap_b32 v34, v35
  v_add_f32 v36, v34, v35
  v_add_f32 v37, v34, v35
  s_nop 1
  v_permlane16_swap_b32 v36, v37
  v_add_f32 v34, v36, v37
  v_rcp_f32 v34, v34
  s_nop 0
  v_mul_f32 v28, v28, v34
  v_mul_f32 v29, v29, v34
  v_mul_f32 v30, v30, v34
  v_mul_f32 v31, v31, v34
  v_cvt_pk_bf16_f32 v236, v28, v29
  v_cvt_pk_bf16_f32 v237, v30, v31
  v_mfma_f32_16x16x16_bf16 v[16:19], v[108:109], v[76:77], 0
  v_mfma_f32_16x16x16_bf16 v[20:23], v[110:111], v[76:77], 0
  s_nop 6
  v_cndmask_b32 v16, v6, v16, s[62:63]
  v_cndmask_b32 v17, v6, v17, s[64:65]
  v_cndmask_b32 v18, v6, v18, s[66:67]
  v_cndmask_b32 v19, v6, v19, s[68:69]
  v_cndmask_b32 v20, v6, v20, s[70:71]
  v_cndmask_b32 v21, v6, v21, s[72:73]
  v_cndmask_b32 v22, v6, v22, s[74:75]
  v_cndmask_b32 v23, v6, v23, s[76:77]
  v_max3_f32 v32, v16, v17, v18
  v_max3_f32 v32, v32, v19, v20
  v_max3_f32 v32, v32, v21, v22
  v_max_f32 v32, v32, v23
  v_mov_b32 v34, v32
  v_mov_b32 v35, v32
  s_nop 1
  v_permlane32_swap_b32 v34, v35
  v_max_f32 v36, v34, v35
  v_max_f32 v37, v34, v35
  s_nop 1
  v_permlane16_swap_b32 v36, v37
  v_max_f32 v34, v36, v37
  v_mul_f32 v32, s60, v34
  v_fma_f32 v16, v16, s59, v32
  v_fma_f32 v17, v17, s59, v32
  v_fma_f32 v18, v18, s59, v32
  v_fma_f32 v19, v19, s59, v32
  v_fma_f32 v20, v20, s59, v32
  v_fma_f32 v21, v21, s59, v32
  v_fma_f32 v22, v22, s59, v32
  v_fma_f32 v23, v23, s59, v32
  v_exp_f32 v16, v16
  v_exp_f32 v17, v17
  v_exp_f32 v18, v18
  v_exp_f32 v19, v19
  v_exp_f32 v20, v20
  v_exp_f32 v21, v21
  v_exp_f32 v22, v22
  v_exp_f32 v23, v23
  v_cvt_pk_bf16_f32 v24, v16, v17
  v_cvt_pk_bf16_f32 v25, v18, v19
  v_cvt_pk_bf16_f32 v26, v20, v21
  v_cvt_pk_bf16_f32 v27, v22, v23
  v_add_f32 v32, v16, v17
  v_add_f32 v32, v32, v18
  v_mfma_f32_16x16x32_bf16 v[28:31], v[148:151], v[24:27], 0
  v_add_f32 v32, v32, v19
  v_add_f32 v32, v32, v20
  v_add_f32 v32, v32, v21
  v_add_f32 v32, v32, v22
  v_add_f32 v32, v32, v23
  v_mov_b32 v34, v32
  v_mov_b32 v35, v32
  s_nop 1
  v_permlane32_swap_b32 v34, v35
  v_add_f32 v36, v34, v35
  v_add_f32 v37, v34, v35
  s_nop 1
  v_permlane16_swap_b32 v36, v37
  v_add_f32 v34, v36, v37
  v_rcp_f32 v34, v34
  s_nop 0
  v_mul_f32 v28, v28, v34
  v_mul_f32 v29, v29, v34
  v_mul_f32 v30, v30, v34
  v_mul_f32 v31, v31, v34
  v_cvt_pk_bf16_f32 v240, v28, v29
  v_cvt_pk_bf16_f32 v241, v30, v31
  v_mfma_f32_16x16x16_bf16 v[16:19], v[110:111], v[78:79], 0
  v_mfma_f32_16x16x16_bf16 v[20:23], v[112:113], v[78:79], 0
  s_nop 6
  v_cndmask_b32 v16, v6, v16, s[62:63]
  v_cndmask_b32 v17, v6, v17, s[64:65]
  v_cndmask_b32 v18, v6, v18, s[66:67]
  v_cndmask_b32 v19, v6, v19, s[68:69]
  v_cndmask_b32 v20, v6, v20, s[70:71]
  v_cndmask_b32 v21, v6, v21, s[72:73]
  v_cndmask_b32 v22, v6, v22, s[74:75]
  v_cndmask_b32 v23, v6, v23, s[76:77]
  v_max3_f32 v32, v16, v17, v18
  v_max3_f32 v32, v32, v19, v20
  v_max3_f32 v32, v32, v21, v22
  v_max_f32 v32, v32, v23
  v_mov_b32 v34, v32
  v_mov_b32 v35, v32
  s_nop 1
  v_permlane32_swap_b32 v34, v35
  v_max_f32 v36, v34, v35
  v_max_f32 v37, v34, v35
  s_nop 1
  v_permlane16_swap_b32 v36, v37
  v_max_f32 v34, v36, v37
  v_mul_f32 v32, s60, v34
  v_fma_f32 v16, v16, s59, v32
  v_fma_f32 v17, v17, s59, v32
  v_fma_f32 v18, v18, s59, v32
  v_fma_f32 v19, v19, s59, v32
  v_fma_f32 v20, v20, s59, v32
  v_fma_f32 v21, v21, s59, v32
  v_fma_f32 v22, v22, s59, v32
  v_fma_f32 v23, v23, s59, v32
  v_exp_f32 v16, v16
  v_exp_f32 v17, v17
  v_exp_f32 v18, v18
  v_exp_f32 v19, v19
  v_exp_f32 v20, v20
  v_exp_f32 v21, v21
  v_exp_f32 v22, v22
  v_exp_f32 v23, v23
  v_cvt_pk_bf16_f32 v24, v16, v17
  v_cvt_pk_bf16_f32 v25, v18, v19
  v_cvt_pk_bf16_f32 v26, v20, v21
  v_cvt_pk_bf16_f32 v27, v22, v23
  v_add_f32 v32, v16, v17
  v_add_f32 v32, v32, v18
  v_mfma_f32_16x16x32_bf16 v[28:31], v[150:153], v[24:27], 0
  v_add_f32 v32, v32, v19
  v_add_f32 v32, v32, v20
  v_add_f32 v32, v32, v21
  v_add_f32 v32, v32, v22
  v_add_f32 v32, v32, v23
  v_mov_b32 v34, v32
  v_mov_b32 v35, v32
  s_nop 1
  v_permlane32_swap_b32 v34, v35
  v_add_f32 v36, v34, v35
  v_add_f32 v37, v34, v35
  s_nop 1
  v_permlane16_swap_b32 v36, v37
  v_add_f32 v34, v36, v37
  v_rcp_f32 v34, v34
  s_nop 0
  v_mul_f32 v28, v28, v34
  v_mul_f32 v29, v29, v34
  v_mul_f32 v30, v30, v34
  v_mul_f32 v31, v31, v34
  v_cvt_pk_bf16_f32 v244, v28, v29
  v_cvt_pk_bf16_f32 v245, v30, v31
  v_mfma_f32_16x16x16_bf16 v[16:19], v[114:115], v[80:81], 0
  v_mfma_f32_16x16x16_bf16 v[20:23], v[116:117], v[80:81], 0
  s_nop 6
  v_cndmask_b32 v16, v6, v16, s[44:45]
  v_cndmask_b32 v17, v6, v17, s[46:47]
  v_cndmask_b32 v18, v6, v18, s[48:49]
  v_cndmask_b32 v19, v6, v19, s[50:51]
  v_cndmask_b32 v20, v6, v20, s[70:71]
  v_cndmask_b32 v21, v6, v21, s[72:73]
  v_cndmask_b32 v22, v6, v22, s[74:75]
  v_cndmask_b32 v23, v6, v23, s[76:77]
  v_max3_f32 v32, v16, v17, v18
  v_max3_f32 v32, v32, v19, v20
  v_max3_f32 v32, v32, v21, v22
  v_max_f32 v32, v32, v23
  v_mov_b32 v34, v32
  v_mov_b32 v35, v32
  s_nop 1
  v_permlane32_swap_b32 v34, v35
  v_max_f32 v36, v34, v35
  v_max_f32 v37, v34, v35
  s_nop 1
  v_permlane16_swap_b32 v36, v37
  v_max_f32 v34, v36, v37
  v_mul_f32 v32, s60, v34
  v_fma_f32 v16, v16, s59, v32
  v_fma_f32 v17, v17, s59, v32
  v_fma_f32 v18, v18, s59, v32
  v_fma_f32 v19, v19, s59, v32
  v_fma_f32 v20, v20, s59, v32
  v_fma_f32 v21, v21, s59, v32
  v_fma_f32 v22, v22, s59, v32
  v_fma_f32 v23, v23, s59, v32
  v_exp_f32 v16, v16
  v_exp_f32 v17, v17
  v_exp_f32 v18, v18
  v_exp_f32 v19, v19
  v_exp_f32 v20, v20
  v_exp_f32 v21, v21
  v_exp_f32 v22, v22
  v_exp_f32 v23, v23
  v_cvt_pk_bf16_f32 v24, v16, v17
  v_cvt_pk_bf16_f32 v25, v18, v19
  v_cvt_pk_bf16_f32 v26, v20, v21
  v_cvt_pk_bf16_f32 v27, v22, v23
  v_add_f32 v32, v16, v17
  v_add_f32 v32, v32, v18
  v_mfma_f32_16x16x32_bf16 v[28:31], v[154:157], v[24:27], 0
  v_add_f32 v32, v32, v19
  v_add_f32 v32, v32, v20
  v_add_f32 v32, v32, v21
  v_add_f32 v32, v32, v22
  v_add_f32 v32, v32, v23
  v_mov_b32 v34, v32
  v_mov_b32 v35, v32
  s_nop 1
  v_permlane32_swap_b32 v34, v35
  v_add_f32 v36, v34, v35
  v_add_f32 v37, v34, v35
  s_nop 1
  v_permlane16_swap_b32 v36, v37
  v_add_f32 v34, v36, v37
  v_rcp_f32 v34, v34
  s_nop 0
  v_mul_f32 v28, v28, v34
  v_mul_f32 v29, v29, v34
  v_mul_f32 v30, v30, v34
  v_mul_f32 v31, v31, v34
  v_cvt_pk_bf16_f32 v234, v28, v29
  v_cvt_pk_bf16_f32 v235, v30, v31
  v_mfma_f32_16x16x16_bf16 v[16:19], v[116:117], v[82:83], 0
  v_mfma_f32_16x16x16_bf16 v[20:23], v[118:119], v[82:83], 0
  s_nop 6
  v_cndmask_b32 v16, v6, v16, s[62:63]
  v_cndmask_b32 v17, v6, v17, s[64:65]
  v_cndmask_b32 v18, v6, v18, s[66:67]
  v_cndmask_b32 v19, v6, v19, s[68:69]
  v_cndmask_b32 v20, v6, v20, s[70:71]
  v_cndmask_b32 v21, v6, v21, s[72:73]
  v_cndmask_b32 v22, v6, v22, s[74:75]
  v_cndmask_b32 v23, v6, v23, s[76:77]
  v_max3_f32 v32, v16, v17, v18
  v_max3_f32 v32, v32, v19, v20
  v_max3_f32 v32, v32, v21, v22
  v_max_f32 v32, v32, v23
  v_mov_b32 v34, v32
  v_mov_b32 v35, v32
  s_nop 1
  v_permlane32_swap_b32 v34, v35
  v_max_f32 v36, v34, v35
  v_max_f32 v37, v34, v35
  s_nop 1
  v_permlane16_swap_b32 v36, v37
  v_max_f32 v34, v36, v37
  v_mul_f32 v32, s60, v34
  v_fma_f32 v16, v16, s59, v32
  v_fma_f32 v17, v17, s59, v32
  v_fma_f32 v18, v18, s59, v32
  v_fma_f32 v19, v19, s59, v32
  v_fma_f32 v20, v20, s59, v32
  v_fma_f32 v21, v21, s59, v32
  v_fma_f32 v22, v22, s59, v32
  v_fma_f32 v23, v23, s59, v32
  v_exp_f32 v16, v16
  v_exp_f32 v17, v17
  v_exp_f32 v18, v18
  v_exp_f32 v19, v19
  v_exp_f32 v20, v20
  v_exp_f32 v21, v21
  v_exp_f32 v22, v22
  v_exp_f32 v23, v23
  v_cvt_pk_bf16_f32 v24, v16, v17
  v_cvt_pk_bf16_f32 v25, v18, v19
  v_cvt_pk_bf16_f32 v26, v20, v21
  v_cvt_pk_bf16_f32 v27, v22, v23
  v_add_f32 v32, v16, v17
  v_add_f32 v32, v32, v18
  v_mfma_f32_16x16x32_bf16 v[28:31], v[156:159], v[24:27], 0
  v_add_f32 v32, v32, v19
  v_add_f32 v32, v32, v20
  v_add_f32 v32, v32, v21
  v_add_f32 v32, v32, v22
  v_add_f32 v32, v32, v23
  v_mov_b32 v34, v32
  v_mov_b32 v35, v32
  s_nop 1
  v_permlane32_swap_b32 v34, v35
  v_add_f32 v36, v34, v35
  v_add_f32 v37, v34, v35
  s_nop 1
  v_permlane16_swap_b32 v36, v37
  v_add_f32 v34, v36, v37
  v_rcp_f32 v34, v34
  s_nop 0
  v_mul_f32 v28, v28, v34
  v_mul_f32 v29, v29, v34
  v_mul_f32 v30, v30, v34
  v_mul_f32 v31, v31, v34
  v_cvt_pk_bf16_f32 v238, v28, v29
  v_cvt_pk_bf16_f32 v239, v30, v31
  v_mfma_f32_16x16x16_bf16 v[16:19], v[118:119], v[84:85], 0
  v_mfma_f32_16x16x16_bf16 v[20:23], v[120:121], v[84:85], 0
  s_nop 6
  v_cndmask_b32 v16, v6, v16, s[62:63]
  v_cndmask_b32 v17, v6, v17, s[64:65]
  v_cndmask_b32 v18, v6, v18, s[66:67]
  v_cndmask_b32 v19, v6, v19, s[68:69]
  v_cndmask_b32 v20, v6, v20, s[70:71]
  v_cndmask_b32 v21, v6, v21, s[72:73]
  v_cndmask_b32 v22, v6, v22, s[74:75]
  v_cndmask_b32 v23, v6, v23, s[76:77]
  v_max3_f32 v32, v16, v17, v18
  v_max3_f32 v32, v32, v19, v20
  v_max3_f32 v32, v32, v21, v22
  v_max_f32 v32, v32, v23
  v_mov_b32 v34, v32
  v_mov_b32 v35, v32
  s_nop 1
  v_permlane32_swap_b32 v34, v35
  v_max_f32 v36, v34, v35
  v_max_f32 v37, v34, v35
  s_nop 1
  v_permlane16_swap_b32 v36, v37
  v_max_f32 v34, v36, v37
  v_mul_f32 v32, s60, v34
  v_fma_f32 v16, v16, s59, v32
  v_fma_f32 v17, v17, s59, v32
  v_fma_f32 v18, v18, s59, v32
  v_fma_f32 v19, v19, s59, v32
  v_fma_f32 v20, v20, s59, v32
  v_fma_f32 v21, v21, s59, v32
  v_fma_f32 v22, v22, s59, v32
  v_fma_f32 v23, v23, s59, v32
  v_exp_f32 v16, v16
  v_exp_f32 v17, v17
  v_exp_f32 v18, v18
  v_exp_f32 v19, v19
  v_exp_f32 v20, v20
  v_exp_f32 v21, v21
  v_exp_f32 v22, v22
  v_exp_f32 v23, v23
  v_cvt_pk_bf16_f32 v24, v16, v17
  v_cvt_pk_bf16_f32 v25, v18, v19
  v_cvt_pk_bf16_f32 v26, v20, v21
  v_cvt_pk_bf16_f32 v27, v22, v23
  v_add_f32 v32, v16, v17
  v_add_f32 v32, v32, v18
  v_mfma_f32_16x16x32_bf16 v[28:31], v[158:161], v[24:27], 0
  v_add_f32 v32, v32, v19
  v_add_f32 v32, v32, v20
  v_add_f32 v32, v32, v21
  v_add_f32 v32, v32, v22
  v_add_f32 v32, v32, v23
  v_mov_b32 v34, v32
  v_mov_b32 v35, v32
  s_nop 1
  v_permlane32_swap_b32 v34, v35
  v_add_f32 v36, v34, v35
  v_add_f32 v37, v34, v35
  s_nop 1
  v_permlane16_swap_b32 v36, v37
  v_add_f32 v34, v36, v37
  v_rcp_f32 v34, v34
  s_nop 0
  v_mul_f32 v28, v28, v34
  v_mul_f32 v29, v29, v34
  v_mul_f32 v30, v30, v34
  v_mul_f32 v31, v31, v34
  v_cvt_pk_bf16_f32 v242, v28, v29
  v_cvt_pk_bf16_f32 v243, v30, v31
  v_mfma_f32_16x16x16_bf16 v[16:19], v[120:121], v[86:87], 0
  v_mfma_f32_16x16x16_bf16 v[20:23], v[122:123], v[86:87], 0
  s_nop 6
  v_cndmask_b32 v16, v6, v16, s[62:63]
  v_cndmask_b32 v17, v6, v17, s[64:65]
  v_cndmask_b32 v18, v6, v18, s[66:67]
  v_cndmask_b32 v19, v6, v19, s[68:69]
  v_cndmask_b32 v20, v6, v20, s[70:71]
  v_cndmask_b32 v21, v6, v21, s[72:73]
  v_cndmask_b32 v22, v6, v22, s[74:75]
  v_cndmask_b32 v23, v6, v23, s[76:77]
  v_max3_f32 v32, v16, v17, v18
  v_max3_f32 v32, v32, v19, v20
  v_max3_f32 v32, v32, v21, v22
  v_max_f32 v32, v32, v23
  v_mov_b32 v34, v32
  v_mov_b32 v35, v32
  s_nop 1
  v_permlane32_swap_b32 v34, v35
  v_max_f32 v36, v34, v35
  v_max_f32 v37, v34, v35
  s_nop 1
  v_permlane16_swap_b32 v36, v37
  v_max_f32 v34, v36, v37
  v_mul_f32 v32, s60, v34
  v_fma_f32 v16, v16, s59, v32
  v_fma_f32 v17, v17, s59, v32
  v_fma_f32 v18, v18, s59, v32
  v_fma_f32 v19, v19, s59, v32
  v_fma_f32 v20, v20, s59, v32
  v_fma_f32 v21, v21, s59, v32
  v_fma_f32 v22, v22, s59, v32
  v_fma_f32 v23, v23, s59, v32
  v_exp_f32 v16, v16
  v_exp_f32 v17, v17
  v_exp_f32 v18, v18
  v_exp_f32 v19, v19
  v_exp_f32 v20, v20
  v_exp_f32 v21, v21
  v_exp_f32 v22, v22
  v_exp_f32 v23, v23
  v_cvt_pk_bf16_f32 v24, v16, v17
  v_cvt_pk_bf16_f32 v25, v18, v19
  v_cvt_pk_bf16_f32 v26, v20, v21
  v_cvt_pk_bf16_f32 v27, v22, v23
  v_add_f32 v32, v16, v17
  v_add_f32 v32, v32, v18
  v_mfma_f32_16x16x32_bf16 v[28:31], v[160:163], v[24:27], 0
  v_add_f32 v32, v32, v19
  v_add_f32 v32, v32, v20
  v_add_f32 v32, v32, v21
  v_add_f32 v32, v32, v22
  v_add_f32 v32, v32, v23
  v_mov_b32 v34, v32
  v_mov_b32 v35, v32
  s_nop 1
  v_permlane32_swap_b32 v34, v35
  v_add_f32 v36, v34, v35
  v_add_f32 v37, v34, v35
  s_nop 1
  v_permlane16_swap_b32 v36, v37
  v_add_f32 v34, v36, v37
  v_rcp_f32 v34, v34
  s_nop 0
  v_mul_f32 v28, v28, v34
  v_mul_f32 v29, v29, v34
  v_mul_f32 v30, v30, v34
  v_mul_f32 v31, v31, v34
  v_cvt_pk_bf16_f32 v246, v28, v29
  v_cvt_pk_bf16_f32 v247, v30, v31
  s_waitcnt vmcnt(0)
  s_barrier
  s_lshl_b32 s54, s3, 8
  s_mov_b32 s55, 0
  s_mov_b32 s56, 0
  s_add_u32 m0, s58, s55
  s_add_u32 s52, s54, 0
  buffer_load_dwordx4 v3, s[20:23], s52 offen lds
  s_add_u32 s52, s52, 16384
  s_add_u32 m0, m0, 1024
  s_nop 0
  buffer_load_dwordx4 v3, s[20:23], s52 offen lds
  s_add_u32 s52, s52, 16384
  s_add_u32 m0, m0, 1024
  s_nop 0
  buffer_load_dwordx4 v3, s[20:23], s52 offen lds
  s_add_u32 s52, s52, 16384
  s_add_u32 m0, m0, 1024
  s_nop 0
  buffer_load_dwordx4 v3, s[20:23], s52 offen lds
  s_add_u32 s55, s55, 4096
  s_cmp_eq_u32 s55, 20480
  s_cselect_b32 s55, 0, s55
  s_add_u32 m0, s58, s55
  s_add_u32 s52, s54, 64
  buffer_load_dwordx4 v3, s[20:23], s52 offen lds
  s_add_u32 s52, s52, 16384
  s_add_u32 m0, m0, 1024
  s_nop 0
  buffer_load_dwordx4 v3, s[20:23], s52 offen lds
  s_add_u32 s52, s52, 16384
  s_add_u32 m0, m0, 1024
  s_nop 0
  buffer_load_dwordx4 v3, s[20:23], s52 offen lds
  s_add_u32 s52, s52, 16384
  s_add_u32 m0, m0, 1024
  s_nop 0
  buffer_load_dwordx4 v3, s[20:23], s52 offen lds
  s_add_u32 s55, s55, 4096
  s_cmp_eq_u32 s55, 20480
  s_cselect_b32 s55, 0, s55
  s_add_u32 m0, s58, s55
  s_add_u32 s52, s54, 128
  buffer_load_dwordx4 v3, s[20:23], s52 offen lds
  s_add_u32 s52, s52, 16384
  s_add_u32 m0, m0, 1024
  s_nop 0
  buffer_load_dwordx4 v3, s[20:23], s52 offen lds
  s_add_u32 s52, s52, 16384
  s_add_u32 m0, m0, 1024
  s_nop 0
  buffer_load_dwordx4 v3, s[20:23], s52 offen lds
  s_add_u32 s52, s52, 16384
  s_add_u32 m0, m0, 1024
  s_nop 0
  buffer_load_dwordx4 v3, s[20:23], s52 offen lds
  s_add_u32 s55, s55, 4096
  s_cmp_eq_u32 s55, 20480
  s_cselect_b32 s55, 0, s55
  s_add_u32 m0, s58, s55
  s_add_u32 s52, s54, 192
  buffer_load_dwordx4 v3, s[20:23], s52 offen lds
  s_add_u32 s52, s52, 16384
  s_add_u32 m0, m0, 1024
  s_nop 0
  buffer_load_dwordx4 v3, s[20:23], s52 offen lds
  s_add_u32 s52, s52, 16384
  s_add_u32 m0, m0, 1024
  s_nop 0
  buffer_load_dwordx4 v3, s[20:23], s52 offen lds
  s_add_u32 s52, s52, 16384
  s_add_u32 m0, m0, 1024
  s_nop 0
  buffer_load_dwordx4 v3, s[20:23], s52 offen lds
  s_add_u32 s55, s55, 4096
  s_cmp_eq_u32 s55, 20480
  s_cselect_b32 s55, 0, s55
  s_lshl_b32 s52, s3, 14
  v_add_u32 v8, s52, v1
  ds_write_b128 v8, v[184:187] offset:0
  ds_write_b128 v8, v[188:191] offset:1024
  ds_write_b128 v8, v[192:195] offset:2048
  ds_write_b128 v8, v[196:199] offset:3072
  ds_write_b128 v8, v[200:203] offset:4096
  ds_write_b128 v8, v[204:207] offset:5120
  ds_write_b128 v8, v[208:211] offset:6144
  ds_write_b128 v8, v[212:215] offset:7168
  ds_write_b128 v8, v[216:219] offset:8192
  ds_write_b128 v8, v[220:223] offset:9216
  ds_write_b128 v8, v[224:227] offset:10240
  ds_write_b128 v8, v[228:231] offset:11264
  ds_write_b128 v8, v[232:235] offset:12288
  ds_write_b128 v8, v[236:239] offset:13312
  ds_write_b128 v8, v[240:243] offset:14336
  ds_write_b128 v8, v[244:247] offset:15360
  v_mov_b64 v[72:73], 0
  v_mov_b64 v[74:75], 0
  v_mov_b64 v[76:77], 0
  v_mov_b64 v[78:79], 0
  v_mov_b64 v[80:81], 0
  v_mov_b64 v[82:83], 0
  v_mov_b64 v[84:85], 0
  v_mov_b64 v[86:87], 0
  v_mov_b64 v[88:89], 0
  v_mov_b64 v[90:91], 0
  v_mov_b64 v[92:93], 0
  v_mov_b64 v[94:95], 0
  v_mov_b64 v[96:97], 0
  v_mov_b64 v[98:99], 0
  v_mov_b64 v[100:101], 0
  v_mov_b64 v[102:103], 0
  v_mov_b64 v[104:105], 0
  v_mov_b64 v[106:107], 0
  v_mov_b64 v[108:109], 0
  v_mov_b64 v[110:111], 0
  v_mov_b64 v[112:113], 0
  v_mov_b64 v[114:115], 0
  v_mov_b64 v[116:117], 0
  v_mov_b64 v[118:119], 0
  v_mov_b64 v[120:121], 0
  v_mov_b64 v[122:123], 0
  v_mov_b64 v[124:125], 0
  v_mov_b64 v[126:127], 0
  v_mov_b64 v[128:129], 0
  v_mov_b64 v[130:131], 0
  v_mov_b64 v[132:133], 0
  v_mov_b64 v[134:135], 0
  v_mov_b64 v[136:137], 0
  v_mov_b64 v[138:139], 0
  v_mov_b64 v[140:141], 0
  v_mov_b64 v[142:143], 0
  v_mov_b64 v[144:145], 0
  v_mov_b64 v[146:147], 0
  v_mov_b64 v[148:149], 0
  v_mov_b64 v[150:151], 0
  v_mov_b64 v[152:153], 0
  v_mov_b64 v[154:155], 0
  v_mov_b64 v[156:157], 0
  v_mov_b64 v[158:159], 0
  v_mov_b64 v[160:161], 0
  v_mov_b64 v[162:163], 0
  v_mov_b64 v[164:165], 0
  v_mov_b64 v[166:167], 0
  v_mov_b64 v[168:169], 0
  v_mov_b64 v[170:171], 0
  v_mov_b64 v[172:173], 0
  v_mov_b64 v[174:175], 0
  v_mov_b64 v[176:177], 0
  v_mov_b64 v[178:179], 0
  v_mov_b64 v[180:181], 0
  v_mov_b64 v[182:183], 0
  s_waitcnt lgkmcnt(0)
  s_barrier
  v_mov_b64 v[184:185], 0
  v_mov_b64 v[186:187], 0
  v_mov_b64 v[188:189], 0
  v_mov_b64 v[190:191], 0
  v_mov_b64 v[192:193], 0
  v_mov_b64 v[194:195], 0
  v_mov_b64 v[196:197], 0
  v_mov_b64 v[198:199], 0
  s_mov_b32 s57, 0
L_x_o:
  s_add_u32 s54, s54, 0x10000
  s_and_b32 s54, s54, 0x7ffff
  v_add_u32 v8, s57, v1
  ds_read_b128 v[16:19], v8 offset:0
  ds_read_b128 v[20:23], v8 offset:1024
  ds_read_b128 v[24:27], v8 offset:2048
  ds_read_b128 v[28:31], v8 offset:3072
  ds_read_b128 v[32:35], v8 offset:4096
  ds_read_b128 v[36:39], v8 offset:5120
  ds_read_b128 v[40:43], v8 offset:6144
  ds_read_b128 v[44:47], v8 offset:7168
  s_waitcnt vmcnt(12)
  v_add_u32 v5, s56, v4
  s_add_u32 s56, s56, 4096
  s_cmp_eq_u32 s56, 20480
  s_cselect_b32 s56, 0, s56
  ds_read_b64_tr_b16 v[56:57], v5 offset:0
  ds_read_b64_tr_b16 v[60:61], v5 offset:32
  ds_read_b64_tr_b16 v[58:59], v5 offset:1024
  ds_read_b64_tr_b16 v[62:63], v5 offset:1056
  ds_read_b64_tr_b16 v[64:65], v5 offset:2048
  ds_read_b64_tr_b16 v[68:69], v5 offset:2080
  ds_read_b64_tr_b16 v[66:67], v5 offset:3072
  ds_read_b64_tr_b16 v[70:71], v5 offset:3104
  s_add_u32 m0, s58, s55
  s_add_u32 s52, s54, 0
  buffer_load_dwordx4 v3, s[20:23], s52 offen lds
  s_add_u32 s52, s52, 16384
  s_add_u32 m0, m0, 1024
  s_nop 0
  buffer_load_dwordx4 v3, s[20:23], s52 offen lds
  s_add_u32 s52, s52, 16384
  s_add_u32 m0, m0, 1024
  s_nop 0
  buffer_load_dwordx4 v3, s[20:23], s52 offen lds
  s_add_u32 s52, s52, 16384
  s_add_u32 m0, m0, 1024
  s_nop 0
  buffer_load_dwordx4 v3, s[20:23], s52 offen lds
  s_add_u32 s55, s55, 4096
  s_cmp_eq_u32 s55, 20480
  s_cselect_b32 s55, 0, s55
  s_waitcnt lgkmcnt(0)
  v_mfma_f32_16x16x32_bf16 v[72:75], v[56:59], v[16:19], v[72:75]
  v_mfma_f32_16x16x32_bf16 v[76:79], v[56:59], v[20:23], v[76:79]
  v_mfma_f32_16x16x32_bf16 v[80:83], v[56:59], v[24:27], v[80:83]
  v_mfma_f32_16x16x32_bf16 v[84:87], v[56:59], v[28:31], v[84:87]
  v_mfma_f32_16x16x32_bf16 v[88:91], v[60:63], v[16:19], v[88:91]
  v_mfma_f32_16x16x32_bf16 v[92:95], v[60:63], v[20:23], v[92:95]
  v_mfma_f32_16x16x32_bf16 v[96:99], v[60:63], v[24:27], v[96:99]
  v_mfma_f32_16x16x32_bf16 v[100:103], v[60:63], v[28:31], v[100:103]
  v_mfma_f32_16x16x32_bf16 v[72:75], v[64:67], v[32:35], v[72:75]
  v_mfma_f32_16x16x32_bf16 v[76:79], v[64:67], v[36:39], v[76:79]
  v_mfma_f32_16x16x32_bf16 v[80:83], v[64:67], v[40:43], v[80:83]
  v_mfma_f32_16x16x32_bf16 v[84:87], v[64:67], v[44:47], v[84:87]
  v_mfma_f32_16x16x32_bf16 v[88:91], v[68:71], v[32:35], v[88:91]
  v_mfma_f32_16x16x32_bf16 v[92:95], v[68:71], v[36:39], v[92:95]
  v_mfma_f32_16x16x32_bf16 v[96:99], v[68:71], v[40:43], v[96:99]
  v_mfma_f32_16x16x32_bf16 v[100:103], v[68:71], v[44:47], v[100:103]
  s_waitcnt vmcnt(12)
  v_add_u32 v5, s56, v4
  s_add_u32 s56, s56, 4096
  s_cmp_eq_u32 s56, 20480
  s_cselect_b32 s56, 0, s56
  ds_read_b64_tr_b16 v[56:57], v5 offset:0
  ds_read_b64_tr_b16 v[60:61], v5 offset:32
  ds_read_b64_tr_b16 v[58:59], v5 offset:1024
  ds_read_b64_tr_b16 v[62:63], v5 offset:1056
  ds_read_b64_tr_b16 v[64:65], v5 offset:2048
  ds_read_b64_tr_b16 v[68:69], v5 offset:2080
  ds_read_b64_tr_b16 v[66:67], v5 offset:3072
  ds_read_b64_tr_b16 v[70:71], v5 offset:3104
  s_add_u32 m0, s58, s55
  s_add_u32 s52, s54, 64
  buffer_load_dwordx4 v3, s[20:23], s52 offen lds
  s_add_u32 s52, s52, 16384
  s_add_u32 m0, m0, 1024
  s_nop 0
  buffer_load_dwordx4 v3, s[20:23], s52 offen lds
  s_add_u32 s52, s52, 16384
  s_add_u32 m0, m0, 1024
  s_nop 0
  buffer_load_dwordx4 v3, s[20:23], s52 offen lds
  s_add_u32 s52, s52, 16384
  s_add_u32 m0, m0, 1024
  s_nop 0
  buffer_load_dwordx4 v3, s[20:23], s52 offen lds
  s_add_u32 s55, s55, 4096
  s_cmp_eq_u32 s55, 20480
  s_cselect_b32 s55, 0, s55
  s_waitcnt lgkmcnt(0)
  v_mfma_f32_16x16x32_bf16 v[104:107], v[56:59], v[16:19], v[104:107]
  v_mfma_f32_16x16x32_bf16 v[108:111], v[56:59], v[20:23], v[108:111]
  v_mfma_f32_16x16x32_bf16 v[112:115], v[56:59], v[24:27], v[112:115]
  v_mfma_f32_16x16x32_bf16 v[116:119], v[56:59], v[28:31], v[116:119]
  v_mfma_f32_16x16x32_bf16 v[120:123], v[60:63], v[16:19], v[120:123]
  v_mfma_f32_16x16x32_bf16 v[124:127], v[60:63], v[20:23], v[124:127]
  v_mfma_f32_16x16x32_bf16 v[128:131], v[60:63], v[24:27], v[128:131]
  v_mfma_f32_16x16x32_bf16 v[132:135], v[60:63], v[28:31], v[132:135]
  v_mfma_f32_16x16x32_bf16 v[104:107], v[64:67], v[32:35], v[104:107]
  v_mfma_f32_16x16x32_bf16 v[108:111], v[64:67], v[36:39], v[108:111]
  v_mfma_f32_16x16x32_bf16 v[112:115], v[64:67], v[40:43], v[112:115]
  v_mfma_f32_16x16x32_bf16 v[116:119], v[64:67], v[44:47], v[116:119]
  v_mfma_f32_16x16x32_bf16 v[120:123], v[68:71], v[32:35], v[120:123]
  v_mfma_f32_16x16x32_bf16 v[124:127], v[68:71], v[36:39], v[124:127]
  v_mfma_f32_16x16x32_bf16 v[128:131], v[68:71], v[40:43], v[128:131]
  v_mfma_f32_16x16x32_bf16 v[132:135], v[68:71], v[44:47], v[132:135]
  s_waitcnt vmcnt(12)
  v_add_u32 v5, s56, v4
  s_add_u32 s56, s56, 4096
  s_cmp_eq_u32 s56, 20480
  s_cselect_b32 s56, 0, s56
  ds_read_b64_tr_b16 v[56:57], v5 offset:0
  ds_read_b64_tr_b16 v[60:61], v5 offset:32
  ds_read_b64_tr_b16 v[58:59], v5 offset:1024
  ds_read_b64_tr_b16 v[62:63], v5 offset:1056
  ds_read_b64_tr_b16 v[64:65], v5 offset:2048
  ds_read_b64_tr_b16 v[68:69], v5 offset:2080
  ds_read_b64_tr_b16 v[66:67], v5 offset:3072
  ds_read_b64_tr_b16 v[70:71], v5 offset:3104
  s_add_u32 m0, s58, s55
  s_add_u32 s52, s54, 128
  buffer_load_dwordx4 v3, s[20:23], s52 offen lds
  s_add_u32 s52, s52, 16384
  s_add_u32 m0, m0, 1024
  s_nop 0
  buffer_load_dwordx4 v3, s[20:23], s52 offen lds
  s_add_u32 s52, s52, 16384
  s_add_u32 m0, m0, 1024
  s_nop 0
  buffer_load_dwordx4 v3, s[20:23], s52 offen lds
  s_add_u32 s52, s52, 16384
  s_add_u32 m0, m0, 1024
  s_nop 0
  buffer_load_dwordx4 v3, s[20:23], s52 offen lds
  s_add_u32 s55, s55, 4096
  s_cmp_eq_u32 s55, 20480
  s_cselect_b32 s55, 0, s55
  s_waitcnt lgkmcnt(0)
  v_mfma_f32_16x16x32_bf16 v[136:139], v[56:59], v[16:19], v[136:139]
  v_mfma_f32_16x16x32_bf16 v[140:143], v[56:59], v[20:23], v[140:143]
  v_mfma_f32_16x16x32_bf16 v[144:147], v[56:59], v[24:27], v[144:147]
  v_mfma_f32_16x16x32_bf16 v[148:151], v[56:59], v[28:31], v[148:151]
  v_mfma_f32_16x16x32_bf16 v[152:155], v[60:63], v[16:19], v[152:155]
  v_mfma_f32_16x16x32_bf16 v[156:159], v[60:63], v[20:23], v[156:159]
  v_mfma_f32_16x16x32_bf16 v[160:163], v[60:63], v[24:27], v[160:163]
  v_mfma_f32_16x16x32_bf16 v[164:167], v[60:63], v[28:31], v[164:167]
  v_mfma_f32_16x16x32_bf16 v[136:139], v[64:67], v[32:35], v[136:139]
  v_mfma_f32_16x16x32_bf16 v[140:143], v[64:67], v[36:39], v[140:143]
  v_mfma_f32_16x16x32_bf16 v[144:147], v[64:67], v[40:43], v[144:147]
  v_mfma_f32_16x16x32_bf16 v[148:151], v[64:67], v[44:47], v[148:151]
  v_mfma_f32_16x16x32_bf16 v[152:155], v[68:71], v[32:35], v[152:155]
  v_mfma_f32_16x16x32_bf16 v[156:159], v[68:71], v[36:39], v[156:159]
  v_mfma_f32_16x16x32_bf16 v[160:163], v[68:71], v[40:43], v[160:163]
  v_mfma_f32_16x16x32_bf16 v[164:167], v[68:71], v[44:47], v[164:167]
  s_waitcnt vmcnt(12)
  v_add_u32 v5, s56, v4
  s_add_u32 s56, s56, 4096
  s_cmp_eq_u32 s56, 20480
  s_cselect_b32 s56, 0, s56
  ds_read_b64_tr_b16 v[56:57], v5 offset:0
  ds_read_b64_tr_b16 v[60:61], v5 offset:32
  ds_read_b64_tr_b16 v[58:59], v5 offset:1024
  ds_read_b64_tr_b16 v[62:63], v5 offset:1056
  ds_read_b64_tr_b16 v[64:65], v5 offset:2048
  ds_read_b64_tr_b16 v[68:69], v5 offset:2080
  ds_read_b64_tr_b16 v[66:67], v5 offset:3072
  ds_read_b64_tr_b16 v[70:71], v5 offset:3104
  s_add_u32 m0, s58, s55
  s_add_u32 s52, s54, 192
  buffer_load_dwordx4 v3, s[20:23], s52 offen lds
  s_add_u32 s52, s52, 16384
  s_add_u32 m0, m0, 1024
  s_nop 0
  buffer_load_dwordx4 v3, s[20:23], s52 offen lds
  s_add_u32 s52, s52, 16384
  s_add_u32 m0, m0, 1024
  s_nop 0
  buffer_load_dwordx4 v3, s[20:23], s52 offen lds
  s_add_u32 s52, s52, 16384
  s_add_u32 m0, m0, 1024
  s_nop 0
  buffer_load_dwordx4 v3, s[20:23], s52 offen lds
  s_add_u32 s55, s55, 4096
  s_cmp_eq_u32 s55, 20480
  s_cselect_b32 s55, 0, s55
  s_waitcnt lgkmcnt(0)
  v_mfma_f32_16x16x32_bf16 v[168:171], v[56:59], v[16:19], v[168:171]
  v_mfma_f32_16x16x32_bf16 v[172:175], v[56:59], v[20:23], v[172:175]
  v_mfma_f32_16x16x32_bf16 v[176:179], v[56:59], v[24:27], v[176:179]
  v_mfma_f32_16x16x32_bf16 v[180:183], v[56:59], v[28:31], v[180:183]
  v_mfma_f32_16x16x32_bf16 v[184:187], v[60:63], v[16:19], v[184:187]
  v_mfma_f32_16x16x32_bf16 v[188:191], v[60:63], v[20:23], v[188:191]
  v_mfma_f32_16x16x32_bf16 v[192:195], v[60:63], v[24:27], v[192:195]
  v_mfma_f32_16x16x32_bf16 v[196:199], v[60:63], v[28:31], v[196:199]
  v_mfma_f32_16x16x32_bf16 v[168:171], v[64:67], v[32:35], v[168:171]
  v_mfma_f32_16x16x32_bf16 v[172:175], v[64:67], v[36:39], v[172:175]
  v_mfma_f32_16x16x32_bf16 v[176:179], v[64:67], v[40:43], v[176:179]
  v_mfma_f32_16x16x32_bf16 v[180:183], v[64:67], v[44:47], v[180:183]
  v_mfma_f32_16x16x32_bf16 v[184:187], v[68:71], v[32:35], v[184:187]
  v_mfma_f32_16x16x32_bf16 v[188:191], v[68:71], v[36:39], v[188:191]
  v_mfma_f32_16x16x32_bf16 v[192:195], v[68:71], v[40:43], v[192:195]
  v_mfma_f32_16x16x32_bf16 v[196:199], v[68:71], v[44:47], v[196:199]
  s_add_u32 s57, s57, 8192
  s_cmp_lt_u32 s57, 0x10000
  s_cbranch_scc1 L_x_o
  s_nop 4
  s_nop 7
  s_lshl_b32 s52, s43, 17
  s_lshl_b32 s53, s3, 8
  s_add_u32 s52, s52, s53
  v_cvt_pk_bf16_f32 v72, v72, v73
  v_cvt_pk_bf16_f32 v73, v74, v75
  buffer_store_dwordx2 v[72:73], v7, s[24:27], s52 offen offset:0
  v_cvt_pk_bf16_f32 v88, v88, v89
  v_cvt_pk_bf16_f32 v89, v90, v91
  buffer_store_dwordx2 v[88:89], v7, s[24:27], s52 offen offset:32
  v_cvt_pk_bf16_f32 v104, v104, v105
  v_cvt_pk_bf16_f32 v105, v106, v107
  buffer_store_dwordx2 v[104:105], v7, s[24:27], s52 offen offset:64
  v_cvt_pk_bf16_f32 v120, v120, v121
  v_cvt_pk_bf16_f32 v121, v122, v123
  buffer_store_dwordx2 v[120:121], v7, s[24:27], s52 offen offset:96
  v_cvt_pk_bf16_f32 v136, v136, v137
  v_cvt_pk_bf16_f32 v137, v138, v139
  buffer_store_dwordx2 v[136:137], v7, s[24:27], s52 offen offset:128
  v_cvt_pk_bf16_f32 v152, v152, v153
  v_cvt_pk_bf16_f32 v153, v154, v155
  buffer_store_dwordx2 v[152:153], v7, s[24:27], s52 offen offset:160
  v_cvt_pk_bf16_f32 v168, v168, v169
  v_cvt_pk_bf16_f32 v169, v170, v171
  buffer_store_dwordx2 v[168:169], v7, s[24:27], s52 offen offset:192
  v_cvt_pk_bf16_f32 v184, v184, v185
  v_cvt_pk_bf16_f32 v185, v186, v187
  buffer_store_dwordx2 v[184:185], v7, s[24:27], s52 offen offset:224
  s_add_u32 s52, s52, 0x8000
  v_cvt_pk_bf16_f32 v76, v76, v77
  v_cvt_pk_bf16_f32 v77, v78, v79
  buffer_store_dwordx2 v[76:77], v7, s[24:27], s52 offen offset:0
  v_cvt_pk_bf16_f32 v92, v92, v93
  v_cvt_pk_bf16_f32 v93, v94, v95
  buffer_store_dwordx2 v[92:93], v7, s[24:27], s52 offen offset:32
  v_cvt_pk_bf16_f32 v108, v108, v109
  v_cvt_pk_bf16_f32 v109, v110, v111
  buffer_store_dwordx2 v[108:109], v7, s[24:27], s52 offen offset:64
  v_cvt_pk_bf16_f32 v124, v124, v125
  v_cvt_pk_bf16_f32 v125, v126, v127
  buffer_store_dwordx2 v[124:125], v7, s[24:27], s52 offen offset:96
  v_cvt_pk_bf16_f32 v140, v140, v141
  v_cvt_pk_bf16_f32 v141, v142, v143
  buffer_store_dwordx2 v[140:141], v7, s[24:27], s52 offen offset:128
  v_cvt_pk_bf16_f32 v156, v156, v157
  v_cvt_pk_bf16_f32 v157, v158, v159
  buffer_store_dwordx2 v[156:157], v7, s[24:27], s52 offen offset:160
  v_cvt_pk_bf16_f32 v172, v172, v173
  v_cvt_pk_bf16_f32 v173, v174, v175
  buffer_store_dwordx2 v[172:173], v7, s[24:27], s52 offen offset:192
  v_cvt_pk_bf16_f32 v188, v188, v189
  v_cvt_pk_bf16_f32 v189, v190, v191
  buffer_store_dwordx2 v[188:189], v7, s[24:27], s52 offen offset:224
  s_add_u32 s52, s52, 0x8000
  v_cvt_pk_bf16_f32 v80, v80, v81
  v_cvt_pk_bf16_f32 v81, v82, v83
  buffer_store_dwordx2 v[80:81], v7, s[24:27], s52 offen offset:0
  v_cvt_pk_bf16_f32 v96, v96, v97
  v_cvt_pk_bf16_f32 v97, v98, v99
  buffer_store_dwordx2 v[96:97], v7, s[24:27], s52 offen offset:32
  v_cvt_pk_bf16_f32 v112, v112, v113
  v_cvt_pk_bf16_f32 v113, v114, v115
  buffer_store_dwordx2 v[112:113], v7, s[24:27], s52 offen offset:64
  v_cvt_pk_bf16_f32 v128, v128, v129
  v_cvt_pk_bf16_f32 v129, v130, v131
  buffer_store_dwordx2 v[128:129], v7, s[24:27], s52 offen offset:96
  v_cvt_pk_bf16_f32 v144, v144, v145
  v_cvt_pk_bf16_f32 v145, v146, v147
  buffer_store_dwordx2 v[144:145], v7, s[24:27], s52 offen offset:128
  v_cvt_pk_bf16_f32 v160, v160, v161
  v_cvt_pk_bf16_f32 v161, v162, v163
  buffer_store_dwordx2 v[160:161], v7, s[24:27], s52 offen offset:160
  v_cvt_pk_bf16_f32 v176, v176, v177
  v_cvt_pk_bf16_f32 v177, v178, v179
  buffer_store_dwordx2 v[176:177], v7, s[24:27], s52 offen offset:192
  v_cvt_pk_bf16_f32 v192, v192, v193
  v_cvt_pk_bf16_f32 v193, v194, v195
  buffer_store_dwordx2 v[192:193], v7, s[24:27], s52 offen offset:224
  s_add_u32 s52, s52, 0x8000
  v_cvt_pk_bf16_f32 v84, v84, v85
  v_cvt_pk_bf16_f32 v85, v86, v87
  buffer_store_dwordx2 v[84:85], v7, s[24:27], s52 offen offset:0
  v_cvt_pk_bf16_f32 v100, v100, v101
  v_cvt_pk_bf16_f32 v101, v102, v103
  buffer_store_dwordx2 v[100:101], v7, s[24:27], s52 offen offset:32
  v_cvt_pk_bf16_f32 v116, v116, v117
  v_cvt_pk_bf16_f32 v117, v118, v119
  buffer_store_dwordx2 v[116:117], v7, s[24:27], s52 offen offset:64
  v_cvt_pk_bf16_f32 v132, v132, v133
  v_cvt_pk_bf16_f32 v133, v134, v135
  buffer_store_dwordx2 v[132:133], v7, s[24:27], s52 offen offset:96
  v_cvt_pk_bf16_f32 v148, v148, v149
  v_cvt_pk_bf16_f32 v149, v150, v151
  buffer_store_dwordx2 v[148:149], v7, s[24:27], s52 offen offset:128
  v_cvt_pk_bf16_f32 v164, v164, v165
  v_cvt_pk_bf16_f32 v165, v166, v167
  buffer_store_dwordx2 v[164:165], v7, s[24:27], s52 offen offset:160
  v_cvt_pk_bf16_f32 v180, v180, v181
  v_cvt_pk_bf16_f32 v181, v182, v183
  buffer_store_dwordx2 v[180:181], v7, s[24:27], s52 offen offset:192
  v_cvt_pk_bf16_f32 v196, v196, v197
  v_cvt_pk_bf16_f32 v197, v198, v199
  buffer_store_dwordx2 v[196:197], v7, s[24:27], s52 offen offset:224
  s_add_u32 s52, s52, 0x8000
  s_waitcnt vmcnt(0)
L_end:
  s_endpgm
L_code_end:
.section .rodata,"a"
.p2align 6
.amdhsa_kernel concat_heads__sliding_local_dilated__memory_aug_recurrent_mem_tr__prompt_kernel
  .amdhsa_next_free_vgpr 512
  .amdhsa_next_free_sgpr 102
  .amdhsa_accum_offset 256
  .amdhsa_group_segment_fixed_size 0
  .amdhsa_kernarg_size 104
  .amdhsa_user_sgpr_count 2
  .amdhsa_user_sgpr_kernarg_segment_ptr 1
  .amdhsa_system_sgpr_workgroup_id_x 1
.end_amdhsa_kernel
```
